```python
import torch

def _softmax(x, axis=-1):
    return torch.softmax(x, dim=axis)

def _gelu(x):
    return torch.nn.functional.gelu(x, approximate='tanh')

def _silu(x):
    return torch.nn.functional.silu(x)

def _sigmoid(x):
    return torch.sigmoid(x)

def _layernorm(x, axis=-1, eps=1e-05):
    m = x.mean(dim=axis, keepdim=True)
    v = x.var(dim=axis, keepdim=True, unbiased=False)
    return (x - m) / torch.sqrt(v + eps)

def _scatter_add(tgt, idx, src, axis=0):
    return tgt.clone().index_add_(axis, idx, src)

def _segment_sum(src, seg, n):
    out = torch.zeros((n,) + src.shape[1:], dtype=src.dtype)
    return out.index_add_(0, seg, src)

def _pad(x, pw):
    flat = tuple((v for pair in reversed(pw) for v in pair))
    return torch.nn.functional.pad(x, flat)
kernel_name = 'recurrent_scan__memory_aug_recurrent_mem_tr__glu_gated_glu__prompt'

def setup_inputs():

    _w = lambda a: (lambda t: t.to(torch.bfloat16) if t.is_floating_point() else t)(torch.as_tensor(a))

    def _A_setup():
        B, S, Dm = (1, 2048, 448)
        H, Dh = (16, 256)
        M, seg = (8, 32)
        seg = min(seg, S)
        S = S // seg * seg
        return {'x': _w((lambda *s: torch.randn(*s, dtype=torch.bfloat16) * 0.05)(B, S, Dm)), 'mem0': _w((lambda *s: torch.randn(*s, dtype=torch.bfloat16) * 0.2)(B, M, Dm)), 'Wq': _w((lambda *s: torch.randn(*s, dtype=torch.bfloat16) * 0.8)(Dm, H, Dh) * Dm ** (-0.5)), 'Wk': _w((lambda *s: torch.randn(*s, dtype=torch.bfloat16) * 0.8)(Dm, H, Dh) * Dm ** (-0.5)), 'Wv': _w((lambda *s: torch.randn(*s, dtype=torch.bfloat16) * 0.2)(Dm, H, Dh) * Dm ** (-0.5)), 'Wo': _w((lambda *s: torch.randn(*s, dtype=torch.bfloat16) * 0.2)(H, Dh, Dm) * (H * Dh) ** (-0.5)), 'seg_len': seg}
    _A_in = _A_setup()

    def _B_setup():
        B, S, D, F = (1, 2048, 448, 1792)
        return {'x': _w((lambda *s: torch.randn(*s, dtype=torch.bfloat16) * 0.05)(B, S, D)), 'w_gate': _w((lambda *s: torch.randn(*s, dtype=torch.bfloat16) * 0.2)(D, F)), 'w_up': _w((lambda *s: torch.randn(*s, dtype=torch.bfloat16) * 0.1)(D, F)), 'w_down': _w((lambda *s: torch.randn(*s, dtype=torch.bfloat16) * 0.1)(F, D))}
    _B_in = _B_setup()
    return {'A_x': _A_in['x'], 'A_mem0': _A_in['mem0'], 'A_Wq': _A_in['Wq'], 'A_Wk': _A_in['Wk'], 'A_Wv': _A_in['Wv'], 'A_Wo': _A_in['Wo'], 'A_seg_len': _A_in['seg_len'], 'B_x': _B_in['x'], 'B_w_gate': _B_in['w_gate'], 'B_w_up': _B_in['w_up'], 'B_w_down': _B_in['w_down']}

def reference(A_x, A_mem0, A_Wq, A_Wk, A_Wv, A_Wo, A_seg_len, B_x, B_w_gate, B_w_up, B_w_down):

    def _A_ref(x, mem0, Wq, Wk, Wv, Wo, seg_len):
        B, S, Dm = x.shape
        H, Dh = (Wq.shape[1], Wq.shape[2])
        M = mem0.shape[1]
        scale = Dh ** (-0.5)
        n_seg = S // seg_len
        L = M + seg_len
        idx = torch.arange(L)
        mask = (idx[:, None] < M) | (idx[:, None] >= idx[None, :])
        mem = mem0
        outs = []
        for s in range(n_seg):
            xs = x[:, s * seg_len:(s + 1) * seg_len, :].clone()
            h = torch.concatenate([mem, xs], axis=1)
            q = torch.einsum('btd,dhe->bhte', h, Wq)
            k = torch.einsum('btd,dhe->bhte', h, Wk)
            v = torch.einsum('btd,dhe->bhte', h, Wv)
            scores = torch.einsum('bhqe,bhke->bhqk', q, k) * scale
            scores = torch.where(mask[None, None], scores, -1000000000.0)
            p = _softmax(scores, axis=-1)
            o = torch.einsum('bhqk,bhke->bhqe', p, v)
            o = torch.einsum('bhte,hed->btd', o, Wo)
            mem = o[:, :M, :].clone()
            outs.append(o[:, M:, :])
        return torch.concatenate(outs, axis=1)

    def _B_ref(x, w_gate, w_up, w_down):
        g = torch.einsum('bsd,df->bsf', x, w_gate)
        u = torch.einsum('bsd,df->bsf', x, w_up)
        h = _sigmoid(g) * u
        return torch.einsum('bsf,fd->bsd', h, w_down)
    x = A_x
    xn = _layernorm(x, axis=-1)
    s = _A_ref(xn, A_mem0, A_Wq, A_Wk, A_Wv, A_Wo, A_seg_len)
    g = _silu(_B_ref(xn, B_w_gate, B_w_up, B_w_down))
    return x + s * g
```

```asm
; @launch grid=(256,1,1) block=(256,1,1) lds=163840
.amdgcn_target "amdgcn-amd-amdhsa--gfx950"
.text
.globl recurrent_scan__memory_aug_recurrent_mem_tr__glu_gated_glu__prompt_kernel
.p2align 8
.type recurrent_scan__memory_aug_recurrent_mem_tr__glu_gated_glu__prompt_kernel,@function
recurrent_scan__memory_aug_recurrent_mem_tr__glu_gated_glu__prompt_kernel:
  s_cmp_ge_u32 s2, 256
  s_cbranch_scc1 L_end
  s_load_dwordx4 s[16:19], s[0:1], 96
  s_getreg_b32 s10, hwreg(HW_REG_XCC_ID)
  s_and_b32 s10, s10, 7
  v_lshrrev_b32 v1, 6, v0
  s_lshl_b32 s14, s10, 5
  v_mov_b32 v2, s14
  v_readfirstlane_b32 s8, v1
  v_mov_b32 v3, 1
  s_waitcnt lgkmcnt(0)
  s_add_u32 s4, s18, 0
  s_addc_u32 s5, s19, 0
  s_and_b32 s5, s5, 0xffff
  s_mov_b32 s6, 268435456
  s_mov_b32 s7, 0x20000
  v_mov_b32 v4, 68386816
  v_mov_b32 v5, 0
  s_cmp_eq_u32 s8, 0
  s_cselect_b64 exec, 1, 0
  global_atomic_add v3, v2, v3, s[16:17] sc0 sc1
  s_or_b32 s14, s2, s8
  s_cmp_eq_u32 s14, 0
  s_cselect_b64 exec, 1, 0
  buffer_load_dword v5, v4, s[4:7], 0 offen sc1
  s_mov_b64 exec, -1
  s_mov_b64 s[14:15], s[16:17]
  s_waitcnt vmcnt(0)
  s_cmp_eq_u32 s8, 0
  s_cbranch_scc0 L_pro_norank
  s_mov_b64 exec, 1
  v_mov_b32 v2, 0
  ds_write_b32 v2, v3
  s_cmp_eq_u32 s2, 0
  s_cbranch_scc0 L_pro_noepoch
  v_add_u32 v5, 1, v5
  v_max_u32 v5, 1, v5
  v_mov_b32 v6, 4
  global_store_dword v6, v5, s[16:17] sc1
  buffer_store_dword v5, v4, s[4:7], 0 offen sc1
L_pro_noepoch:
  s_waitcnt lgkmcnt(0)
  s_mov_b64 exec, -1
L_pro_norank:
  s_barrier
  v_mov_b32 v2, 0
  ds_read_b32 v3, v2
  s_waitcnt lgkmcnt(0)
  v_readfirstlane_b32 s11, v3
  s_barrier
  s_cmp_ge_u32 s11, 32
  s_cbranch_scc1 L_fail
  s_cmp_eq_u32 s10, 0
  s_cbranch_scc1 L_ln_1
  s_mul_i32 s9, s11, 7
  s_add_u32 s9, s9, s10
  s_sub_u32 s9, s9, 1
  s_sub_u32 s76, s9, 160
  s_cmp_lt_u32 s9, 178
  s_cselect_b32 s76, 64, s76
  s_load_dwordx2 s[72:73], s[0:1], 0
  s_waitcnt lgkmcnt(0)
  s_and_b32 s73, s73, 0xffff
  s_mov_b32 s74, 1835008
  s_mov_b32 s75, 0x20000
  v_mbcnt_lo_u32_b32 v2, -1, 0
  v_mbcnt_hi_u32_b32 v2, -1, v2
  v_lshrrev_b32 v6, 3, v2
  v_and_b32 v7, 7, v2
  v_mul_u32_u24 v3, 896, v6
  v_lshl_add_u32 v3, v7, 4, v3
  s_lshl_b32 s30, s76, 2
  s_add_u32 s30, s30, s8
  s_mul_i32 s30, s30, 7168
  s_cmp_lt_u32 s76, 64
  s_cselect_b32 s30, s30, 0xf0000000
  buffer_load_dwordx4 a[0:3], v3, s[72:75], s30 offen offset:0 nt
  buffer_load_dwordx4 a[4:7], v3, s[72:75], s30 offen offset:128 nt
  buffer_load_dwordx4 a[8:11], v3, s[72:75], s30 offen offset:256 nt
  buffer_load_dwordx4 a[12:15], v3, s[72:75], s30 offen offset:384 nt
  buffer_load_dwordx4 a[16:19], v3, s[72:75], s30 offen offset:512 nt
  buffer_load_dwordx4 a[20:23], v3, s[72:75], s30 offen offset:640 nt
  buffer_load_dwordx4 a[24:27], v3, s[72:75], s30 offen offset:768 nt
  s_load_dwordx4 s[48:51], s[0:1], 16
  s_load_dwordx4 s[52:55], s[0:1], 32
  s_lshl_b32 s29, s10, 5
  s_add_u32 s29, s29, s11
  s_sub_u32 s29, s29, 32
  s_mul_i32 s18, s29, 4682
  s_lshr_b32 s18, s18, 16
  s_mul_i32 s31, s18, 14
  s_sub_u32 s29, s29, s31
  s_lshr_b32 s17, s29, 1
  s_and_b32 s25, s29, 1
  v_mbcnt_lo_u32_b32 v2, -1, 0
  v_mbcnt_hi_u32_b32 v2, -1, v2
  v_lshlrev_b32 v20, 4, v2
  v_lshrrev_b32 v3, 5, v2
  v_and_b32 v4, 31, v2
  v_xor_b32 v4, v4, v3
  v_lshlrev_b32 v4, 4, v4
  v_lshl_add_u32 v4, v3, 13, v4
  v_xor_b32 v8, 0, v4
  v_xor_b32 v9, 32, v4
  v_xor_b32 v10, 64, v4
  v_xor_b32 v11, 96, v4
  v_xor_b32 v12, 128, v4
  v_xor_b32 v13, 160, v4
  v_xor_b32 v14, 192, v4
  v_xor_b32 v15, 224, v4
  v_lshrrev_b32 v3, 3, v2
  v_mul_u32_u24 v3, 896, v3
  v_bfe_u32 v4, v2, 4, 1
  v_lshlrev_b32 v4, 1, v4
  v_and_b32 v5, 7, v2
  v_xor_b32 v4, v4, v5
  v_lshl_add_u32 v24, v4, 4, v3
  v_xor_b32 v4, 4, v4
  v_lshl_add_u32 v25, v4, 4, v3
  s_mul_i32 s30, s18, 229376
  s_lshl_b32 s31, s17, 7
  s_add_u32 s30, s30, s31
  s_mul_i32 s31, s8, 57344
  s_add_u32 s23, s30, s31
  s_lshl_b32 s27, s8, 13
  s_add_u32 s27, s27, 131072
  s_mov_b32 m0, s27
  s_waitcnt lgkmcnt(0)
  s_mov_b32 s32, s52
  s_and_b32 s33, s53, 0xffff
  s_mov_b32 s34, 3670016
  s_mov_b32 s35, 0x20000
  s_mov_b32 s36, s54
  s_and_b32 s37, s55, 0xffff
  s_mov_b32 s38, 3670016
  s_mov_b32 s39, 0x20000
  s_mov_b32 s40, s48
  s_and_b32 s41, s49, 0xffff
  s_mov_b32 s42, 3670016
  s_mov_b32 s43, 0x20000
  s_mov_b32 s44, s50
  s_and_b32 s45, s51, 0xffff
  s_mov_b32 s46, 3670016
  s_mov_b32 s47, 0x20000
  v_mov_b32 v30, 4
  global_load_dword v31, v30, s[14:15] sc1
  buffer_load_dwordx4 v24, s[36:39], s23 offen nt lds
  s_add_u32 s23, s23, 7168
  s_add_u32 m0, m0, 1024
  s_nop 0
  buffer_load_dwordx4 v25, s[36:39], s23 offen nt lds
  s_add_u32 s23, s23, 7168
  s_add_u32 m0, m0, 1024
  s_nop 0
  buffer_load_dwordx4 v24, s[36:39], s23 offen nt lds
  s_add_u32 s23, s23, 7168
  s_add_u32 m0, m0, 1024
  s_nop 0
  buffer_load_dwordx4 v25, s[36:39], s23 offen nt lds
  s_add_u32 s23, s23, 7168
  s_add_u32 m0, m0, 1024
  s_nop 0
  buffer_load_dwordx4 v24, s[36:39], s23 offen nt lds
  s_add_u32 s23, s23, 7168
  s_add_u32 m0, m0, 1024
  s_nop 0
  buffer_load_dwordx4 v25, s[36:39], s23 offen nt lds
  s_add_u32 s23, s23, 7168
  s_add_u32 m0, m0, 1024
  s_nop 0
  buffer_load_dwordx4 v24, s[36:39], s23 offen nt lds
  s_add_u32 s23, s23, 7168
  s_add_u32 m0, m0, 1024
  s_nop 0
  buffer_load_dwordx4 v25, s[36:39], s23 offen nt lds
  s_mul_i32 s30, s25, 7
  s_add_u32 s30, s30, s8
  s_lshl_b32 s30, s30, 18
  s_lshl_b32 s31, s18, 9
  s_add_u32 s56, s30, s31
  s_mul_i32 s30, s25, 7
  s_add_u32 s30, s30, s8
  s_add_u32 s30, s30, 4
  s_lshl_b32 s30, s30, 18
  s_lshl_b32 s31, s18, 9
  s_add_u32 s57, s30, s31
  s_cmp_eq_u32 s8, 3
  s_cselect_b32 s57, 0xf0000000, s57
  s_lshl_b32 s58, s8, 15
  s_mov_b32 m0, s58
  s_mov_b32 s28, 0
  s_mov_b32 s23, s56
L_fab2_2:
  s_add_u32 s30, s23, 0
  buffer_load_dwordx4 v8, s[32:35], s30 offen nt lds
  s_add_u32 m0, m0, 1024
  s_add_u32 s30, s23, 65536
  buffer_load_dwordx4 v9, s[32:35], s30 offen nt lds
  s_add_u32 m0, m0, 1024
  s_add_u32 s30, s23, 32768
  buffer_load_dwordx4 v10, s[32:35], s30 offen nt lds
  s_add_u32 m0, m0, 1024
  s_add_u32 s30, s23, 98304
  buffer_load_dwordx4 v11, s[32:35], s30 offen nt lds
  s_add_u32 m0, m0, 1024
  s_add_u32 s30, s23, 131072
  buffer_load_dwordx4 v12, s[32:35], s30 offen nt lds
  s_add_u32 m0, m0, 1024
  s_add_u32 s30, s23, 196608
  buffer_load_dwordx4 v13, s[32:35], s30 offen nt lds
  s_add_u32 m0, m0, 1024
  s_add_u32 s30, s23, 163840
  buffer_load_dwordx4 v14, s[32:35], s30 offen nt lds
  s_add_u32 m0, m0, 1024
  s_add_u32 s30, s23, 229376
  buffer_load_dwordx4 v15, s[32:35], s30 offen nt lds
  s_add_u32 m0, m0, 1024
  s_add_u32 s23, s56, 16384
  s_cmp_eq_u32 s28, 1
  s_cselect_b32 s23, s57, s23
  s_add_u32 s28, s28, 1
  s_cmp_lt_u32 s28, 3
  s_cbranch_scc1 L_fab2_2
  v_and_b32 v3, 15, v2
  v_lshrrev_b32 v4, 4, v2
  v_xor_b32 v5, v4, v3
  v_lshlrev_b32 v5, 4, v5
  v_lshl_add_u32 v5, v3, 9, v5
  v_xor_b32 v16, 0, v5
  v_xor_b32 v17, 64, v5
  v_xor_b32 v18, 128, v5
  v_xor_b32 v19, 192, v5
  v_lshrrev_b32 v5, 2, v3
  v_lshl_add_u32 v6, v4, 3, v5
  v_lshlrev_b32 v6, 7, v6
  v_and_b32 v7, 1, v3
  v_lshl_add_u32 v6, v7, 3, v6
  v_add_u32 v6, 131072, v6
  v_and_b32 v4, 1, v4
  v_lshlrev_b32 v4, 2, v4
  v_and_b32 v5, 2, v5
  v_or_b32 v4, v4, v5
  v_bfe_u32 v5, v3, 1, 1
  v_xor_b32 v4, v4, v5
  v_xor_b32 v5, 0, v4
  v_lshl_add_u32 v26, v5, 4, v6
  v_xor_b32 v5, 2, v4
  v_lshl_add_u32 v27, v5, 4, v6
  v_xor_b32 v5, 4, v4
  v_lshl_add_u32 v28, v5, 4, v6
  v_xor_b32 v5, 6, v4
  v_lshl_add_u32 v29, v5, 4, v6
  s_mul_i32 s30, s18, 28
  s_lshl_b32 s31, s17, 2
  s_add_u32 s30, s30, s31
  s_mul_i32 s30, s30, 14336
  s_mul_i32 s31, s25, 7
  s_add_u32 s31, s31, s8
  s_lshl_b32 s31, s31, 10
  s_add_u32 s30, s30, s31
  s_add_u32 s21, s30, 6422528
  s_mov_b32 s19, 1065353216
  s_mul_i32 s30, s18, 14
  s_lshl_b32 s31, s17, 1
  s_add_u32 s30, s30, s31
  s_add_u32 s30, s30, s25
  s_lshl_b32 s30, s30, 2
  s_add_u32 s30, s30, s8
  s_lshl_b32 s30, s30, 3
  s_add_u32 s26, s30, 68426752
  s_mov_b32 s22, 0
  s_waitcnt vmcnt(24)
  s_barrier
  ds_read_b64_tr_b16 v[128:129], v26 offset:0
  ds_read_b64_tr_b16 v[130:131], v26 offset:512
  ds_read_b64_tr_b16 v[132:133], v26 offset:4096
  ds_read_b64_tr_b16 v[134:135], v26 offset:4608
  ds_read_b64_tr_b16 v[136:137], v26 offset:8192
  ds_read_b64_tr_b16 v[138:139], v26 offset:8704
  ds_read_b64_tr_b16 v[140:141], v26 offset:12288
  ds_read_b64_tr_b16 v[142:143], v26 offset:12800
  ds_read_b64_tr_b16 v[144:145], v26 offset:16384
  ds_read_b64_tr_b16 v[146:147], v26 offset:16896
  ds_read_b64_tr_b16 v[148:149], v26 offset:20480
  ds_read_b64_tr_b16 v[150:151], v26 offset:20992
  ds_read_b64_tr_b16 v[152:153], v26 offset:24576
  ds_read_b64_tr_b16 v[154:155], v26 offset:25088
  ds_read_b64_tr_b16 v[156:157], v26 offset:28672
  ds_read_b64_tr_b16 v[158:159], v26 offset:29184
  ds_read_b64_tr_b16 v[160:161], v27 offset:0
  ds_read_b64_tr_b16 v[162:163], v27 offset:512
  ds_read_b64_tr_b16 v[164:165], v27 offset:4096
  ds_read_b64_tr_b16 v[166:167], v27 offset:4608
  ds_read_b64_tr_b16 v[168:169], v27 offset:8192
  ds_read_b64_tr_b16 v[170:171], v27 offset:8704
  ds_read_b64_tr_b16 v[172:173], v27 offset:12288
  ds_read_b64_tr_b16 v[174:175], v27 offset:12800
  ds_read_b64_tr_b16 v[176:177], v27 offset:16384
  ds_read_b64_tr_b16 v[178:179], v27 offset:16896
  ds_read_b64_tr_b16 v[180:181], v27 offset:20480
  ds_read_b64_tr_b16 v[182:183], v27 offset:20992
  ds_read_b64_tr_b16 v[184:185], v27 offset:24576
  ds_read_b64_tr_b16 v[186:187], v27 offset:25088
  ds_read_b64_tr_b16 v[188:189], v27 offset:28672
  ds_read_b64_tr_b16 v[190:191], v27 offset:29184
  ds_read_b64_tr_b16 v[192:193], v28 offset:0
  ds_read_b64_tr_b16 v[194:195], v28 offset:512
  ds_read_b64_tr_b16 v[196:197], v28 offset:4096
  ds_read_b64_tr_b16 v[198:199], v28 offset:4608
  ds_read_b64_tr_b16 v[200:201], v28 offset:8192
  ds_read_b64_tr_b16 v[202:203], v28 offset:8704
  ds_read_b64_tr_b16 v[204:205], v28 offset:12288
  ds_read_b64_tr_b16 v[206:207], v28 offset:12800
  ds_read_b64_tr_b16 v[208:209], v28 offset:16384
  ds_read_b64_tr_b16 v[210:211], v28 offset:16896
  ds_read_b64_tr_b16 v[212:213], v28 offset:20480
  ds_read_b64_tr_b16 v[214:215], v28 offset:20992
  ds_read_b64_tr_b16 v[216:217], v28 offset:24576
  ds_read_b64_tr_b16 v[218:219], v28 offset:25088
  ds_read_b64_tr_b16 v[220:221], v28 offset:28672
  ds_read_b64_tr_b16 v[222:223], v28 offset:29184
  ds_read_b64_tr_b16 v[224:225], v29 offset:0
  ds_read_b64_tr_b16 v[226:227], v29 offset:512
  ds_read_b64_tr_b16 v[228:229], v29 offset:4096
  ds_read_b64_tr_b16 v[230:231], v29 offset:4608
  ds_read_b64_tr_b16 v[232:233], v29 offset:8192
  ds_read_b64_tr_b16 v[234:235], v29 offset:8704
  ds_read_b64_tr_b16 v[236:237], v29 offset:12288
  ds_read_b64_tr_b16 v[238:239], v29 offset:12800
  ds_read_b64_tr_b16 v[240:241], v29 offset:16384
  ds_read_b64_tr_b16 v[242:243], v29 offset:16896
  ds_read_b64_tr_b16 v[244:245], v29 offset:20480
  ds_read_b64_tr_b16 v[246:247], v29 offset:20992
  ds_read_b64_tr_b16 v[248:249], v29 offset:24576
  ds_read_b64_tr_b16 v[250:251], v29 offset:25088
  ds_read_b64_tr_b16 v[252:253], v29 offset:28672
  ds_read_b64_tr_b16 v[254:255], v29 offset:29184
  v_add_u32 v16, s58, v16
  v_add_u32 v17, s58, v17
  v_add_u32 v18, s58, v18
  v_add_u32 v19, s58, v19
  s_lshl_b32 s29, s17, 2
  s_add_u32 s29, s29, s8
  s_mul_i32 s30, s29, 37
  s_lshr_b32 s30, s30, 8
  s_mul_i32 s31, s30, 7
  s_sub_u32 s29, s29, s31
  s_mul_i32 s30, s30, 112
  s_lshr_b32 s31, s29, 1
  s_lshl_b32 s31, s31, 5
  s_add_u32 s30, s30, s31
  s_and_b32 s31, s29, 1
  s_lshl_b32 s31, s31, 2
  s_add_u32 s30, s30, s31
  s_lshl_b32 s30, s30, 13
  s_lshl_b32 s31, s18, 9
  s_add_u32 s23, s30, s31
  s_mov_b32 s31, 16384
  s_cmp_eq_u32 s29, 6
  s_cselect_b32 s29, s31, 49152
  s_mov_b32 m0, s27
  s_waitcnt lgkmcnt(0)
  s_barrier
  buffer_load_dwordx4 v8, s[44:47], s23 offen nt lds
  s_add_u32 s23, s23, s31
  s_add_u32 m0, m0, 1024
  s_nop 0
  buffer_load_dwordx4 v9, s[44:47], s23 offen nt lds
  s_add_u32 s23, s23, s29
  s_add_u32 m0, m0, 1024
  s_nop 0
  buffer_load_dwordx4 v10, s[44:47], s23 offen nt lds
  s_add_u32 s23, s23, s31
  s_add_u32 m0, m0, 1024
  s_nop 0
  buffer_load_dwordx4 v11, s[44:47], s23 offen nt lds
  s_add_u32 s23, s23, s29
  s_add_u32 m0, m0, 1024
  s_nop 0
  buffer_load_dwordx4 v12, s[44:47], s23 offen nt lds
  s_add_u32 s23, s23, s31
  s_add_u32 m0, m0, 1024
  s_nop 0
  buffer_load_dwordx4 v13, s[44:47], s23 offen nt lds
  s_add_u32 s23, s23, s29
  s_add_u32 m0, m0, 1024
  s_nop 0
  buffer_load_dwordx4 v14, s[44:47], s23 offen nt lds
  s_add_u32 s23, s23, s31
  s_add_u32 m0, m0, 1024
  s_nop 0
  buffer_load_dwordx4 v15, s[44:47], s23 offen nt lds
  s_mov_b32 s24, 0
  s_mov_b32 s60, s32
  s_mov_b32 s61, s33
  s_mov_b32 s62, s34
  s_mov_b32 s63, s35
  s_mov_b32 s64, s40
  s_mov_b32 s65, s41
  s_mov_b32 s66, s42
  s_mov_b32 s67, s43
  s_mov_b32 s59, s57
  s_mov_b32 s27, s56
  s_nop 0
  s_mov_b32 s28, 0
  s_branch L_ep1_5
L_ep_3:
  global_load_dword v31, v30, s[14:15] sc1
  s_add_u32 s28, s28, 1
  s_cmp_gt_u32 s28, 2000000
  s_cbranch_scc1 L_fail
L_ep0_4:
  s_waitcnt vmcnt(0)
L_ep1_5:
  v_readfirstlane_b32 s12, v31
  s_nop 0
  s_cmp_eq_u32 s12, 0
  s_cbranch_scc1 L_ep_3
  s_not_b32 s13, s12
L_fabl_6:
  s_waitcnt vmcnt(24)
  s_cmp_eq_u32 s24, 0
  s_cbranch_scc1 L_fw_12
  s_waitcnt vmcnt(24)
L_fw_12:
  ds_read_b128 v[96:99], v16 offset:0
  ds_read_b128 v[100:103], v17 offset:0
  ds_read_b128 v[104:107], v18 offset:0
  s_add_u32 s30, s22, 24576
  s_and_b32 s30, s30, 0x7fff
  s_add_u32 m0, s30, s58
  ds_read_b128 v[108:111], v19 offset:0
  s_waitcnt lgkmcnt(3)
  v_mfma_f32_16x16x32_bf16 v[64:67], v[96:99], v[128:131], 0
  s_add_u32 s30, s59, 16384
  buffer_load_dwordx4 v8, s[60:63], s30 offen nt lds
  s_add_u32 m0, m0, 1024
  v_mfma_f32_16x16x32_bf16 v[72:75], v[96:99], v[160:163], 0
  v_mfma_f32_16x16x32_bf16 v[80:83], v[96:99], v[192:195], 0
  v_mfma_f32_16x16x32_bf16 v[88:91], v[96:99], v[224:227], 0
  ds_read_b128 v[96:99], v16 offset:256
  s_waitcnt lgkmcnt(3)
  v_mfma_f32_16x16x32_bf16 v[64:67], v[100:103], v[132:135], v[64:67]
  s_add_u32 s30, s59, 81920
  buffer_load_dwordx4 v9, s[60:63], s30 offen nt lds
  s_add_u32 m0, m0, 1024
  v_mfma_f32_16x16x32_bf16 v[72:75], v[100:103], v[164:167], v[72:75]
  v_mfma_f32_16x16x32_bf16 v[80:83], v[100:103], v[196:199], v[80:83]
  v_mfma_f32_16x16x32_bf16 v[88:91], v[100:103], v[228:231], v[88:91]
  ds_read_b128 v[100:103], v17 offset:256
  s_waitcnt lgkmcnt(3)
  v_mfma_f32_16x16x32_bf16 v[64:67], v[104:107], v[136:139], v[64:67]
  s_add_u32 s30, s59, 49152
  buffer_load_dwordx4 v10, s[60:63], s30 offen nt lds
  s_add_u32 m0, m0, 1024
  v_mfma_f32_16x16x32_bf16 v[72:75], v[104:107], v[168:171], v[72:75]
  v_mfma_f32_16x16x32_bf16 v[80:83], v[104:107], v[200:203], v[80:83]
  v_mfma_f32_16x16x32_bf16 v[88:91], v[104:107], v[232:235], v[88:91]
  ds_read_b128 v[104:107], v18 offset:256
  s_waitcnt lgkmcnt(3)
  v_mfma_f32_16x16x32_bf16 v[64:67], v[108:111], v[140:143], v[64:67]
  s_add_u32 s30, s59, 114688
  buffer_load_dwordx4 v11, s[60:63], s30 offen nt lds
  s_add_u32 m0, m0, 1024
  v_mfma_f32_16x16x32_bf16 v[72:75], v[108:111], v[172:175], v[72:75]
  v_mfma_f32_16x16x32_bf16 v[80:83], v[108:111], v[204:207], v[80:83]
  v_mfma_f32_16x16x32_bf16 v[88:91], v[108:111], v[236:239], v[88:91]
  ds_read_b128 v[108:111], v19 offset:256
  s_waitcnt lgkmcnt(3)
  v_mfma_f32_16x16x32_bf16 v[64:67], v[96:99], v[144:147], v[64:67]
  s_add_u32 s30, s59, 147456
  buffer_load_dwordx4 v12, s[60:63], s30 offen nt lds
  s_add_u32 m0, m0, 1024
  v_mfma_f32_16x16x32_bf16 v[72:75], v[96:99], v[176:179], v[72:75]
  v_mfma_f32_16x16x32_bf16 v[80:83], v[96:99], v[208:211], v[80:83]
  v_mfma_f32_16x16x32_bf16 v[88:91], v[96:99], v[240:243], v[88:91]
  s_waitcnt lgkmcnt(2)
  v_mfma_f32_16x16x32_bf16 v[64:67], v[100:103], v[148:151], v[64:67]
  s_add_u32 s30, s59, 212992
  buffer_load_dwordx4 v13, s[60:63], s30 offen nt lds
  s_add_u32 m0, m0, 1024
  v_mfma_f32_16x16x32_bf16 v[72:75], v[100:103], v[180:183], v[72:75]
  v_mfma_f32_16x16x32_bf16 v[80:83], v[100:103], v[212:215], v[80:83]
  v_mfma_f32_16x16x32_bf16 v[88:91], v[100:103], v[244:247], v[88:91]
  s_waitcnt lgkmcnt(1)
  v_mfma_f32_16x16x32_bf16 v[64:67], v[104:107], v[152:155], v[64:67]
  s_add_u32 s30, s59, 180224
  buffer_load_dwordx4 v14, s[60:63], s30 offen nt lds
  s_add_u32 m0, m0, 1024
  v_mfma_f32_16x16x32_bf16 v[72:75], v[104:107], v[184:187], v[72:75]
  v_mfma_f32_16x16x32_bf16 v[80:83], v[104:107], v[216:219], v[80:83]
  v_mfma_f32_16x16x32_bf16 v[88:91], v[104:107], v[248:251], v[88:91]
  s_waitcnt lgkmcnt(0)
  v_mfma_f32_16x16x32_bf16 v[64:67], v[108:111], v[156:159], v[64:67]
  s_add_u32 s30, s59, 245760
  buffer_load_dwordx4 v15, s[60:63], s30 offen nt lds
  s_add_u32 m0, m0, 1024
  v_mfma_f32_16x16x32_bf16 v[72:75], v[108:111], v[188:191], v[72:75]
  v_mfma_f32_16x16x32_bf16 v[80:83], v[108:111], v[220:223], v[80:83]
  v_mfma_f32_16x16x32_bf16 v[88:91], v[108:111], v[252:255], v[88:91]
  s_waitcnt vmcnt(24)
  s_cmp_eq_u32 s24, 0
  s_cbranch_scc1 L_fw_14
  s_waitcnt vmcnt(20)
L_fw_14:
  ds_read_b128 v[96:99], v16 offset:8192
  ds_read_b128 v[100:103], v17 offset:8192
  ds_read_b128 v[104:107], v18 offset:8192
  s_add_u32 s30, s22, 0
  s_and_b32 s30, s30, 0x7fff
  s_add_u32 m0, s30, s58
  ds_read_b128 v[108:111], v19 offset:8192
  s_waitcnt lgkmcnt(3)
  v_mfma_f32_16x16x32_bf16 v[68:71], v[96:99], v[128:131], 0
  s_add_u32 s30, s27, 0
  buffer_load_dwordx4 v8, s[64:67], s30 offen nt lds
  s_add_u32 m0, m0, 1024
  v_mfma_f32_16x16x32_bf16 v[76:79], v[96:99], v[160:163], 0
  v_mfma_f32_16x16x32_bf16 v[84:87], v[96:99], v[192:195], 0
  v_mfma_f32_16x16x32_bf16 v[92:95], v[96:99], v[224:227], 0
  ds_read_b128 v[96:99], v16 offset:8448
  s_waitcnt lgkmcnt(3)
  v_mfma_f32_16x16x32_bf16 v[68:71], v[100:103], v[132:135], v[68:71]
  s_add_u32 s30, s27, 65536
  buffer_load_dwordx4 v9, s[64:67], s30 offen nt lds
  s_add_u32 m0, m0, 1024
  v_mfma_f32_16x16x32_bf16 v[76:79], v[100:103], v[164:167], v[76:79]
  v_mfma_f32_16x16x32_bf16 v[84:87], v[100:103], v[196:199], v[84:87]
  v_mfma_f32_16x16x32_bf16 v[92:95], v[100:103], v[228:231], v[92:95]
  ds_read_b128 v[100:103], v17 offset:8448
  s_waitcnt lgkmcnt(3)
  v_mfma_f32_16x16x32_bf16 v[68:71], v[104:107], v[136:139], v[68:71]
  s_add_u32 s30, s27, 32768
  buffer_load_dwordx4 v10, s[64:67], s30 offen nt lds
  s_add_u32 m0, m0, 1024
  v_mfma_f32_16x16x32_bf16 v[76:79], v[104:107], v[168:171], v[76:79]
  v_mfma_f32_16x16x32_bf16 v[84:87], v[104:107], v[200:203], v[84:87]
  v_mfma_f32_16x16x32_bf16 v[92:95], v[104:107], v[232:235], v[92:95]
  ds_read_b128 v[104:107], v18 offset:8448
  s_waitcnt lgkmcnt(3)
  v_mfma_f32_16x16x32_bf16 v[68:71], v[108:111], v[140:143], v[68:71]
  s_add_u32 s30, s27, 98304
  buffer_load_dwordx4 v11, s[64:67], s30 offen nt lds
  s_add_u32 m0, m0, 1024
  v_mfma_f32_16x16x32_bf16 v[76:79], v[108:111], v[172:175], v[76:79]
  v_mfma_f32_16x16x32_bf16 v[84:87], v[108:111], v[204:207], v[84:87]
  v_mfma_f32_16x16x32_bf16 v[92:95], v[108:111], v[236:239], v[92:95]
  ds_read_b128 v[108:111], v19 offset:8448
  s_waitcnt lgkmcnt(3)
  v_mfma_f32_16x16x32_bf16 v[68:71], v[96:99], v[144:147], v[68:71]
  s_add_u32 s30, s27, 131072
  buffer_load_dwordx4 v12, s[64:67], s30 offen nt lds
  s_add_u32 m0, m0, 1024
  v_mfma_f32_16x16x32_bf16 v[76:79], v[96:99], v[176:179], v[76:79]
  v_mfma_f32_16x16x32_bf16 v[84:87], v[96:99], v[208:211], v[84:87]
  v_mfma_f32_16x16x32_bf16 v[92:95], v[96:99], v[240:243], v[92:95]
  s_waitcnt lgkmcnt(2)
  v_mfma_f32_16x16x32_bf16 v[68:71], v[100:103], v[148:151], v[68:71]
  s_add_u32 s30, s27, 196608
  buffer_load_dwordx4 v13, s[64:67], s30 offen nt lds
  s_add_u32 m0, m0, 1024
  v_mfma_f32_16x16x32_bf16 v[76:79], v[100:103], v[180:183], v[76:79]
  v_mfma_f32_16x16x32_bf16 v[84:87], v[100:103], v[212:215], v[84:87]
  v_mfma_f32_16x16x32_bf16 v[92:95], v[100:103], v[244:247], v[92:95]
  s_waitcnt lgkmcnt(1)
  v_mfma_f32_16x16x32_bf16 v[68:71], v[104:107], v[152:155], v[68:71]
  s_add_u32 s30, s27, 163840
  buffer_load_dwordx4 v14, s[64:67], s30 offen nt lds
  s_add_u32 m0, m0, 1024
  v_mfma_f32_16x16x32_bf16 v[76:79], v[104:107], v[184:187], v[76:79]
  v_mfma_f32_16x16x32_bf16 v[84:87], v[104:107], v[216:219], v[84:87]
  v_mfma_f32_16x16x32_bf16 v[92:95], v[104:107], v[248:251], v[92:95]
  s_waitcnt lgkmcnt(0)
  v_mfma_f32_16x16x32_bf16 v[68:71], v[108:111], v[156:159], v[68:71]
  s_add_u32 s30, s27, 229376
  buffer_load_dwordx4 v15, s[64:67], s30 offen nt lds
  s_add_u32 m0, m0, 1024
  v_mfma_f32_16x16x32_bf16 v[76:79], v[108:111], v[188:191], v[76:79]
  v_mfma_f32_16x16x32_bf16 v[84:87], v[108:111], v[220:223], v[84:87]
  v_mfma_f32_16x16x32_bf16 v[92:95], v[108:111], v[252:255], v[92:95]
  v_xor_b32 v16, 0x4000, v16
  v_xor_b32 v17, 0x4000, v17
  v_xor_b32 v18, 0x4000, v18
  v_xor_b32 v19, 0x4000, v19
  s_xor_b32 s22, s22, 0x4000
  s_cmp_eq_u32 s24, 0
  s_cbranch_scc1 L_fabe_10
  s_waitcnt vmcnt(16)
  v_mov_b32 v4, s12
  v_mov_b32 v5, s13
  v_mov_b32 v6, 0
  s_mov_b64 exec, 1
  buffer_store_dwordx2 v[4:5], v6, s[4:7], s26 offen offset:0 sc1
  s_mov_b64 exec, -1
  s_add_u32 s30, s26, 14336
  s_sub_u32 s31, s26, 21504
  s_cmp_eq_u32 s24, 2
  s_cselect_b32 s26, s31, s30
L_fabe_10:
  s_and_b32 s30, s24, 1
  s_lshl_b32 s30, s30, 2
  s_add_u32 s30, s30, s8
  s_cmp_eq_u32 s30, 7
  s_cselect_b32 s30, 0xf0000000, s21
  v_mul_f32 v64, s19, v64
  v_mul_f32 v65, s19, v65
  v_mul_f32 v66, s19, v66
  v_mul_f32 v67, s19, v67
  v_mul_f32 v68, s19, v68
  v_mul_f32 v69, s19, v69
  v_mul_f32 v70, s19, v70
  v_mul_f32 v71, s19, v71
  v_cvt_pk_bf16_f32 v40, v64, v65
  v_cvt_pk_bf16_f32 v41, v66, v67
  v_cvt_pk_bf16_f32 v42, v68, v69
  v_cvt_pk_bf16_f32 v43, v70, v71
  buffer_store_dwordx4 v[40:43], v20, s[4:7], s30 offen sc1
  v_mul_f32 v72, s19, v72
  v_mul_f32 v73, s19, v73
  v_mul_f32 v74, s19, v74
  v_mul_f32 v75, s19, v75
  v_mul_f32 v76, s19, v76
  v_mul_f32 v77, s19, v77
  v_mul_f32 v78, s19, v78
  v_mul_f32 v79, s19, v79
  v_cvt_pk_bf16_f32 v44, v72, v73
  v_cvt_pk_bf16_f32 v45, v74, v75
  v_cvt_pk_bf16_f32 v46, v76, v77
  v_cvt_pk_bf16_f32 v47, v78, v79
  s_add_u32 s30, s30, 14336
  buffer_store_dwordx4 v[44:47], v20, s[4:7], s30 offen sc1
  v_mul_f32 v80, s19, v80
  v_mul_f32 v81, s19, v81
  v_mul_f32 v82, s19, v82
  v_mul_f32 v83, s19, v83
  v_mul_f32 v84, s19, v84
  v_mul_f32 v85, s19, v85
  v_mul_f32 v86, s19, v86
  v_mul_f32 v87, s19, v87
  v_cvt_pk_bf16_f32 v48, v80, v81
  v_cvt_pk_bf16_f32 v49, v82, v83
  v_cvt_pk_bf16_f32 v50, v84, v85
  v_cvt_pk_bf16_f32 v51, v86, v87
  s_add_u32 s30, s30, 14336
  buffer_store_dwordx4 v[48:51], v20, s[4:7], s30 offen sc1
  v_mul_f32 v88, s19, v88
  v_mul_f32 v89, s19, v89
  v_mul_f32 v90, s19, v90
  v_mul_f32 v91, s19, v91
  v_mul_f32 v92, s19, v92
  v_mul_f32 v93, s19, v93
  v_mul_f32 v94, s19, v94
  v_mul_f32 v95, s19, v95
  v_cvt_pk_bf16_f32 v52, v88, v89
  v_cvt_pk_bf16_f32 v53, v90, v91
  v_cvt_pk_bf16_f32 v54, v92, v93
  v_cvt_pk_bf16_f32 v55, v94, v95
  s_add_u32 s30, s30, 14336
  buffer_store_dwordx4 v[52:55], v20, s[4:7], s30 offen sc1
  s_add_u32 s21, s21, 4096
  s_add_u32 s24, s24, 1
  s_cmp_eq_u32 s24, 1
  s_cbranch_scc0 L_fabk1_7
  s_mov_b32 s60, s40
  s_mov_b32 s61, s41
  s_mov_b32 s62, s42
  s_mov_b32 s63, s43
  s_mov_b32 s59, s56
  s_mov_b32 s27, s57
  s_branch L_fabl_6
L_fabk1_7:
  s_cmp_eq_u32 s24, 4
  s_cbranch_scc1 L_fablast_11
  s_cmp_eq_u32 s24, 3
  s_cselect_b32 s59, 0xf0000000, s57
  s_mov_b32 s27, 0xf0000000
  s_cbranch_scc1 L_fabl_6
  s_waitcnt vmcnt(41)
  s_barrier
  v_and_b32 v3, 15, v2
  v_lshrrev_b32 v4, 4, v2
  v_xor_b32 v5, v4, v3
  v_lshlrev_b32 v5, 4, v5
  v_lshl_add_u32 v5, v3, 9, v5
  v_add_u32 v5, 131072, v5
  v_xor_b32 v24, 0, v5
  v_xor_b32 v25, 64, v5
  v_xor_b32 v26, 128, v5
  v_xor_b32 v27, 192, v5
  ds_read_b128 v[128:131], v24 offset:0
  ds_read_b128 v[132:135], v25 offset:0
  ds_read_b128 v[136:139], v26 offset:0
  ds_read_b128 v[140:143], v27 offset:0
  ds_read_b128 v[144:147], v24 offset:256
  ds_read_b128 v[148:151], v25 offset:256
  ds_read_b128 v[152:155], v26 offset:256
  ds_read_b128 v[156:159], v27 offset:256
  ds_read_b128 v[160:163], v24 offset:8192
  ds_read_b128 v[164:167], v25 offset:8192
  ds_read_b128 v[168:171], v26 offset:8192
  ds_read_b128 v[172:175], v27 offset:8192
  ds_read_b128 v[176:179], v24 offset:8448
  ds_read_b128 v[180:183], v25 offset:8448
  ds_read_b128 v[184:187], v26 offset:8448
  ds_read_b128 v[188:191], v27 offset:8448
  ds_read_b128 v[192:195], v24 offset:16384
  ds_read_b128 v[196:199], v25 offset:16384
  ds_read_b128 v[200:203], v26 offset:16384
  ds_read_b128 v[204:207], v27 offset:16384
  ds_read_b128 v[208:211], v24 offset:16640
  ds_read_b128 v[212:215], v25 offset:16640
  ds_read_b128 v[216:219], v26 offset:16640
  ds_read_b128 v[220:223], v27 offset:16640
  ds_read_b128 v[224:227], v24 offset:24576
  ds_read_b128 v[228:231], v25 offset:24576
  ds_read_b128 v[232:235], v26 offset:24576
  ds_read_b128 v[236:239], v27 offset:24576
  ds_read_b128 v[240:243], v24 offset:24832
  ds_read_b128 v[244:247], v25 offset:24832
  ds_read_b128 v[248:251], v26 offset:24832
  ds_read_b128 v[252:255], v27 offset:24832
  s_sub_u32 s21, s21, 6430720
  s_mov_b32 s19, 1035512379
  s_waitcnt lgkmcnt(0)
  s_branch L_fabl_6
L_fablast_11:
  s_waitcnt vmcnt(0)
  v_mov_b32 v4, s12
  v_mov_b32 v5, s13
  v_mov_b32 v6, 0
  s_mov_b64 exec, 1
  buffer_store_dwordx2 v[4:5], v6, s[4:7], s26 offen offset:0 sc1
  s_mov_b64 exec, -1
  s_branch L_p0done
L_ln_1:
  s_sub_u32 s30, s11, 14
  s_cmp_lt_u32 s11, 30
  s_cselect_b32 s30, 64, s30
  s_cmp_lt_u32 s11, 16
  s_cselect_b32 s76, s11, s30
  s_load_dwordx2 s[72:73], s[0:1], 0
  s_waitcnt lgkmcnt(0)
  s_and_b32 s73, s73, 0xffff
  s_mov_b32 s74, 1835008
  s_mov_b32 s75, 0x20000
  v_mbcnt_lo_u32_b32 v2, -1, 0
  v_mbcnt_hi_u32_b32 v2, -1, v2
  v_lshrrev_b32 v6, 3, v2
  v_and_b32 v7, 7, v2
  v_mul_u32_u24 v3, 896, v6
  v_lshl_add_u32 v3, v7, 4, v3
  s_lshl_b32 s30, s76, 2
  s_add_u32 s30, s30, s8
  s_mul_i32 s30, s30, 7168
  s_cmp_lt_u32 s76, 64
  s_cselect_b32 s30, s30, 0xf0000000
  buffer_load_dwordx4 a[0:3], v3, s[72:75], s30 offen offset:0 nt
  buffer_load_dwordx4 a[4:7], v3, s[72:75], s30 offen offset:128 nt
  buffer_load_dwordx4 a[8:11], v3, s[72:75], s30 offen offset:256 nt
  buffer_load_dwordx4 a[12:15], v3, s[72:75], s30 offen offset:384 nt
  buffer_load_dwordx4 a[16:19], v3, s[72:75], s30 offen offset:512 nt
  buffer_load_dwordx4 a[20:23], v3, s[72:75], s30 offen offset:640 nt
  buffer_load_dwordx4 a[24:27], v3, s[72:75], s30 offen offset:768 nt
  v_mov_b32 v8, 4
  global_load_dword v9, v8, s[14:15] sc1
  v_mbcnt_lo_u32_b32 v2, -1, 0
  v_mbcnt_hi_u32_b32 v2, -1, v2
  v_lshlrev_b32 v5, 4, v2
  s_lshl_b32 s30, s11, 2
  s_add_u32 s27, s30, s8
  v_mov_b32 v16, -1
  v_mov_b32 v17, -1
  v_mov_b32 v18, -1
  v_mov_b32 v19, -1
  s_lshl_b32 s30, s27, 12
  s_add_u32 s31, s30, 66060288
  s_add_u32 s30, s30, 66584576
  s_cmp_lt_u32 s27, 2
  s_cselect_b32 s31, 0xf0000000, s31
  s_mul_i32 s29, s27, 5120
  s_add_u32 s29, s29, 67108864
  buffer_store_dwordx4 v[16:19], v5, s[4:7], s30 offen offset:0 sc1
  buffer_store_dwordx4 v[16:19], v5, s[4:7], s31 offen offset:0
  buffer_store_dwordx4 v[16:19], v5, s[4:7], s29 offen offset:0
  buffer_store_dwordx4 v[16:19], v5, s[4:7], s30 offen offset:1024 sc1
  buffer_store_dwordx4 v[16:19], v5, s[4:7], s31 offen offset:1024
  buffer_store_dwordx4 v[16:19], v5, s[4:7], s29 offen offset:1024
  buffer_store_dwordx4 v[16:19], v5, s[4:7], s30 offen offset:2048 sc1
  buffer_store_dwordx4 v[16:19], v5, s[4:7], s31 offen offset:2048
  buffer_store_dwordx4 v[16:19], v5, s[4:7], s29 offen offset:2048
  buffer_store_dwordx4 v[16:19], v5, s[4:7], s30 offen offset:3072 sc1
  buffer_store_dwordx4 v[16:19], v5, s[4:7], s31 offen offset:3072
  buffer_store_dwordx4 v[16:19], v5, s[4:7], s29 offen offset:3072
  s_add_u32 s29, s29, 4096
  buffer_store_dwordx4 v[16:19], v5, s[4:7], s29 offen
  s_cmp_lt_u32 s27, 7
  s_cbranch_scc0 L_nomem0_16
  s_load_dwordx2 s[36:37], s[0:1], 8
  s_waitcnt lgkmcnt(0)
  s_and_b32 s37, s37, 0xffff
  s_mov_b32 s38, 7168
  s_mov_b32 s39, 0x20000
  v_and_b32 v7, 7, v2
  v_mul_u32_u24 v6, 896, v7
  v_lshrrev_b32 v7, 3, v2
  v_lshl_add_u32 v6, v7, 4, v6
  s_lshl_b32 s30, s27, 7
  buffer_load_dwordx4 v[20:23], v6, s[36:39], s30 offen
  s_lshl_b32 s30, s27, 10
  s_add_u32 s30, s30, 66060288
  s_waitcnt vmcnt(0)
  v_min_u32 v20, -2, v20
  v_min_u32 v21, -2, v21
  v_min_u32 v22, -2, v22
  v_min_u32 v23, -2, v23
  buffer_store_dwordx4 v[20:23], v5, s[4:7], s30 offen
L_nomem0_16:
  s_lshl_b32 s30, s27, 3
  s_add_u32 s77, s30, 68354048
  s_waitcnt vmcnt(13)
  s_mov_b32 s28, 0
  s_branch L_ep1_19
L_ep_17:
  global_load_dword v9, v8, s[14:15] sc1
  s_add_u32 s28, s28, 1
  s_cmp_gt_u32 s28, 2000000
  s_cbranch_scc1 L_fail
L_ep0_18:
  s_waitcnt vmcnt(0)
L_ep1_19:
  v_readfirstlane_b32 s12, v9
  s_nop 0
  s_cmp_eq_u32 s12, 0
  s_cbranch_scc1 L_ep_17
  s_not_b32 s13, s12
  s_branch L_p0done
L_p0done:
  s_waitcnt lgkmcnt(0)
  s_barrier
  s_cmp_lt_u32 s76, 64
  s_cbranch_scc0 L_noln_21
  v_mbcnt_lo_u32_b32 v2, -1, 0
  v_mbcnt_hi_u32_b32 v2, -1, v2
  v_lshlrev_b32 v5, 4, v2
  v_lshrrev_b32 v6, 3, v2
  v_and_b32 v7, 7, v2
  v_mul_u32_u24 v4, 912, v6
  v_lshl_add_u32 v4, v7, 4, v4
  s_mul_i32 s30, s8, 7296
  v_add_u32 v4, s30, v4
  s_mov_b32 s20, 991054117
  s_mov_b32 s21, 925353388
  s_mov_b32 s22, 0xffff0000
  v_accvgpr_read_b32 v49, a0
  v_lshlrev_b32 v48, 16, v49
  v_and_b32 v49, s22, v49
  v_accvgpr_read_b32 v51, a1
  v_lshlrev_b32 v50, 16, v51
  v_and_b32 v51, s22, v51
  v_accvgpr_read_b32 v53, a2
  v_lshlrev_b32 v52, 16, v53
  v_and_b32 v53, s22, v53
  v_accvgpr_read_b32 v55, a3
  v_lshlrev_b32 v54, 16, v55
  v_and_b32 v55, s22, v55
  v_accvgpr_read_b32 v57, a4
  v_lshlrev_b32 v56, 16, v57
  v_and_b32 v57, s22, v57
  v_accvgpr_read_b32 v59, a5
  v_lshlrev_b32 v58, 16, v59
  v_and_b32 v59, s22, v59
  v_accvgpr_read_b32 v61, a6
  v_lshlrev_b32 v60, 16, v61
  v_and_b32 v61, s22, v61
  v_accvgpr_read_b32 v63, a7
  v_lshlrev_b32 v62, 16, v63
  v_and_b32 v63, s22, v63
  v_accvgpr_read_b32 v65, a8
  v_lshlrev_b32 v64, 16, v65
  v_and_b32 v65, s22, v65
  v_accvgpr_read_b32 v67, a9
  v_lshlrev_b32 v66, 16, v67
  v_and_b32 v67, s22, v67
  v_accvgpr_read_b32 v69, a10
  v_lshlrev_b32 v68, 16, v69
  v_and_b32 v69, s22, v69
  v_accvgpr_read_b32 v71, a11
  v_lshlrev_b32 v70, 16, v71
  v_and_b32 v71, s22, v71
  v_accvgpr_read_b32 v73, a12
  v_lshlrev_b32 v72, 16, v73
  v_and_b32 v73, s22, v73
  v_accvgpr_read_b32 v75, a13
  v_lshlrev_b32 v74, 16, v75
  v_and_b32 v75, s22, v75
  v_accvgpr_read_b32 v77, a14
  v_lshlrev_b32 v76, 16, v77
  v_and_b32 v77, s22, v77
  v_accvgpr_read_b32 v79, a15
  v_lshlrev_b32 v78, 16, v79
  v_and_b32 v79, s22, v79
  v_accvgpr_read_b32 v81, a16
  v_lshlrev_b32 v80, 16, v81
  v_and_b32 v81, s22, v81
  v_accvgpr_read_b32 v83, a17
  v_lshlrev_b32 v82, 16, v83
  v_and_b32 v83, s22, v83
  v_accvgpr_read_b32 v85, a18
  v_lshlrev_b32 v84, 16, v85
  v_and_b32 v85, s22, v85
  v_accvgpr_read_b32 v87, a19
  v_lshlrev_b32 v86, 16, v87
  v_and_b32 v87, s22, v87
  v_accvgpr_read_b32 v89, a20
  v_lshlrev_b32 v88, 16, v89
  v_and_b32 v89, s22, v89
  v_accvgpr_read_b32 v91, a21
  v_lshlrev_b32 v90, 16, v91
  v_and_b32 v91, s22, v91
  v_accvgpr_read_b32 v93, a22
  v_lshlrev_b32 v92, 16, v93
  v_and_b32 v93, s22, v93
  v_accvgpr_read_b32 v95, a23
  v_lshlrev_b32 v94, 16, v95
  v_and_b32 v95, s22, v95
  v_accvgpr_read_b32 v97, a24
  v_lshlrev_b32 v96, 16, v97
  v_and_b32 v97, s22, v97
  v_accvgpr_read_b32 v99, a25
  v_lshlrev_b32 v98, 16, v99
  v_and_b32 v99, s22, v99
  v_accvgpr_read_b32 v101, a26
  v_lshlrev_b32 v100, 16, v101
  v_and_b32 v101, s22, v101
  v_accvgpr_read_b32 v103, a27
  v_lshlrev_b32 v102, 16, v103
  v_and_b32 v103, s22, v103
  v_pk_add_f32 v[110:111], v[48:49], v[50:51]
  v_pk_add_f32 v[112:113], v[52:53], v[54:55]
  v_pk_add_f32 v[110:111], v[110:111], v[56:57]
  v_pk_add_f32 v[112:113], v[112:113], v[58:59]
  v_pk_add_f32 v[110:111], v[110:111], v[60:61]
  v_pk_add_f32 v[112:113], v[112:113], v[62:63]
  v_pk_add_f32 v[110:111], v[110:111], v[64:65]
  v_pk_add_f32 v[112:113], v[112:113], v[66:67]
  v_pk_add_f32 v[110:111], v[110:111], v[68:69]
  v_pk_add_f32 v[112:113], v[112:113], v[70:71]
  v_pk_add_f32 v[110:111], v[110:111], v[72:73]
  v_pk_add_f32 v[112:113], v[112:113], v[74:75]
  v_pk_add_f32 v[110:111], v[110:111], v[76:77]
  v_pk_add_f32 v[112:113], v[112:113], v[78:79]
  v_pk_add_f32 v[110:111], v[110:111], v[80:81]
  v_pk_add_f32 v[112:113], v[112:113], v[82:83]
  v_pk_add_f32 v[110:111], v[110:111], v[84:85]
  v_pk_add_f32 v[112:113], v[112:113], v[86:87]
  v_pk_add_f32 v[110:111], v[110:111], v[88:89]
  v_pk_add_f32 v[112:113], v[112:113], v[90:91]
  v_pk_add_f32 v[110:111], v[110:111], v[92:93]
  v_pk_add_f32 v[112:113], v[112:113], v[94:95]
  v_pk_add_f32 v[110:111], v[110:111], v[96:97]
  v_pk_add_f32 v[112:113], v[112:113], v[98:99]
  v_pk_add_f32 v[110:111], v[110:111], v[100:101]
  v_pk_add_f32 v[112:113], v[112:113], v[102:103]
  v_pk_add_f32 v[110:111], v[110:111], v[112:113]
  v_add_f32 v114, v110, v111
  s_nop 1
  v_add_f32_dpp v114, v114, v114 quad_perm:[1,0,3,2] row_mask:0xf bank_mask:0xf
  s_nop 1
  v_add_f32_dpp v114, v114, v114 quad_perm:[2,3,0,1] row_mask:0xf bank_mask:0xf
  s_nop 1
  v_add_f32_dpp v114, v114, v114 row_half_mirror row_mask:0xf bank_mask:0xf
  v_mul_f32 v114, s20, v114
  v_mov_b32 v115, v114
  v_mov_b32 v110, 0
  v_mov_b32 v111, 0
  v_mov_b32 v112, 0
  v_mov_b32 v113, 0
  v_pk_add_f32 v[120:121], v[48:49], v[114:115] neg_lo:[0,1] neg_hi:[0,1]
  v_pk_fma_f32 v[110:111], v[120:121], v[120:121], v[110:111]
  v_pk_add_f32 v[122:123], v[50:51], v[114:115] neg_lo:[0,1] neg_hi:[0,1]
  v_pk_fma_f32 v[112:113], v[122:123], v[122:123], v[112:113]
  v_pk_add_f32 v[120:121], v[52:53], v[114:115] neg_lo:[0,1] neg_hi:[0,1]
  v_pk_fma_f32 v[110:111], v[120:121], v[120:121], v[110:111]
  v_pk_add_f32 v[122:123], v[54:55], v[114:115] neg_lo:[0,1] neg_hi:[0,1]
  v_pk_fma_f32 v[112:113], v[122:123], v[122:123], v[112:113]
  v_pk_add_f32 v[120:121], v[56:57], v[114:115] neg_lo:[0,1] neg_hi:[0,1]
  v_pk_fma_f32 v[110:111], v[120:121], v[120:121], v[110:111]
  v_pk_add_f32 v[122:123], v[58:59], v[114:115] neg_lo:[0,1] neg_hi:[0,1]
  v_pk_fma_f32 v[112:113], v[122:123], v[122:123], v[112:113]
  v_pk_add_f32 v[120:121], v[60:61], v[114:115] neg_lo:[0,1] neg_hi:[0,1]
  v_pk_fma_f32 v[110:111], v[120:121], v[120:121], v[110:111]
  v_pk_add_f32 v[122:123], v[62:63], v[114:115] neg_lo:[0,1] neg_hi:[0,1]
  v_pk_fma_f32 v[112:113], v[122:123], v[122:123], v[112:113]
  v_pk_add_f32 v[120:121], v[64:65], v[114:115] neg_lo:[0,1] neg_hi:[0,1]
  v_pk_fma_f32 v[110:111], v[120:121], v[120:121], v[110:111]
  v_pk_add_f32 v[122:123], v[66:67], v[114:115] neg_lo:[0,1] neg_hi:[0,1]
  v_pk_fma_f32 v[112:113], v[122:123], v[122:123], v[112:113]
  v_pk_add_f32 v[120:121], v[68:69], v[114:115] neg_lo:[0,1] neg_hi:[0,1]
  v_pk_fma_f32 v[110:111], v[120:121], v[120:121], v[110:111]
  v_pk_add_f32 v[122:123], v[70:71], v[114:115] neg_lo:[0,1] neg_hi:[0,1]
  v_pk_fma_f32 v[112:113], v[122:123], v[122:123], v[112:113]
  v_pk_add_f32 v[120:121], v[72:73], v[114:115] neg_lo:[0,1] neg_hi:[0,1]
  v_pk_fma_f32 v[110:111], v[120:121], v[120:121], v[110:111]
  v_pk_add_f32 v[122:123], v[74:75], v[114:115] neg_lo:[0,1] neg_hi:[0,1]
  v_pk_fma_f32 v[112:113], v[122:123], v[122:123], v[112:113]
  v_pk_add_f32 v[120:121], v[76:77], v[114:115] neg_lo:[0,1] neg_hi:[0,1]
  v_pk_fma_f32 v[110:111], v[120:121], v[120:121], v[110:111]
  v_pk_add_f32 v[122:123], v[78:79], v[114:115] neg_lo:[0,1] neg_hi:[0,1]
  v_pk_fma_f32 v[112:113], v[122:123], v[122:123], v[112:113]
  v_pk_add_f32 v[120:121], v[80:81], v[114:115] neg_lo:[0,1] neg_hi:[0,1]
  v_pk_fma_f32 v[110:111], v[120:121], v[120:121], v[110:111]
  v_pk_add_f32 v[122:123], v[82:83], v[114:115] neg_lo:[0,1] neg_hi:[0,1]
  v_pk_fma_f32 v[112:113], v[122:123], v[122:123], v[112:113]
  v_pk_add_f32 v[120:121], v[84:85], v[114:115] neg_lo:[0,1] neg_hi:[0,1]
  v_pk_fma_f32 v[110:111], v[120:121], v[120:121], v[110:111]
  v_pk_add_f32 v[122:123], v[86:87], v[114:115] neg_lo:[0,1] neg_hi:[0,1]
  v_pk_fma_f32 v[112:113], v[122:123], v[122:123], v[112:113]
  v_pk_add_f32 v[120:121], v[88:89], v[114:115] neg_lo:[0,1] neg_hi:[0,1]
  v_pk_fma_f32 v[110:111], v[120:121], v[120:121], v[110:111]
  v_pk_add_f32 v[122:123], v[90:91], v[114:115] neg_lo:[0,1] neg_hi:[0,1]
  v_pk_fma_f32 v[112:113], v[122:123], v[122:123], v[112:113]
  v_pk_add_f32 v[120:121], v[92:93], v[114:115] neg_lo:[0,1] neg_hi:[0,1]
  v_pk_fma_f32 v[110:111], v[120:121], v[120:121], v[110:111]
  v_pk_add_f32 v[122:123], v[94:95], v[114:115] neg_lo:[0,1] neg_hi:[0,1]
  v_pk_fma_f32 v[112:113], v[122:123], v[122:123], v[112:113]
  v_pk_add_f32 v[120:121], v[96:97], v[114:115] neg_lo:[0,1] neg_hi:[0,1]
  v_pk_fma_f32 v[110:111], v[120:121], v[120:121], v[110:111]
  v_pk_add_f32 v[122:123], v[98:99], v[114:115] neg_lo:[0,1] neg_hi:[0,1]
  v_pk_fma_f32 v[112:113], v[122:123], v[122:123], v[112:113]
  v_pk_add_f32 v[120:121], v[100:101], v[114:115] neg_lo:[0,1] neg_hi:[0,1]
  v_pk_fma_f32 v[110:111], v[120:121], v[120:121], v[110:111]
  v_pk_add_f32 v[122:123], v[102:103], v[114:115] neg_lo:[0,1] neg_hi:[0,1]
  v_pk_fma_f32 v[112:113], v[122:123], v[122:123], v[112:113]
  v_pk_add_f32 v[110:111], v[110:111], v[112:113]
  v_add_f32 v118, v110, v111
  s_nop 1
  v_add_f32_dpp v118, v118, v118 quad_perm:[1,0,3,2] row_mask:0xf bank_mask:0xf
  s_nop 1
  v_add_f32_dpp v118, v118, v118 quad_perm:[2,3,0,1] row_mask:0xf bank_mask:0xf
  s_nop 1
  v_add_f32_dpp v118, v118, v118 row_half_mirror row_mask:0xf bank_mask:0xf
  v_mul_f32 v118, s20, v118
  v_cvt_pk_bf16_f32 v118, v118, v118
  v_and_b32 v118, s22, v118
  v_add_f32 v118, s21, v118
  v_cvt_pk_bf16_f32 v118, v118, v118
  v_and_b32 v118, s22, v118
  v_sqrt_f32 v118, v118
  s_nop 0
  v_cvt_pk_bf16_f32 v118, v118, v118
  v_and_b32 v118, s22, v118
  v_rcp_f32 v118, v118
  v_mov_b32 v116, v114
  v_cvt_pk_bf16_f32 v116, v116, v116
  v_and_b32 v116, s22, v116
  v_mov_b32 v117, v116
  v_mov_b32 v119, v118
  v_pk_add_f32 v[48:49], v[48:49], v[116:117] neg_lo:[0,1] neg_hi:[0,1]
  v_cvt_pk_bf16_f32 v120, v48, v49
  v_lshlrev_b32 v48, 16, v120
  v_and_b32 v49, s22, v120
  v_pk_mul_f32 v[48:49], v[48:49], v[118:119]
  v_cvt_pk_bf16_f32 v16, v48, v49
  v_pk_add_f32 v[50:51], v[50:51], v[116:117] neg_lo:[0,1] neg_hi:[0,1]
  v_cvt_pk_bf16_f32 v121, v50, v51
  v_lshlrev_b32 v50, 16, v121
  v_and_b32 v51, s22, v121
  v_pk_mul_f32 v[50:51], v[50:51], v[118:119]
  v_cvt_pk_bf16_f32 v17, v50, v51
  v_pk_add_f32 v[52:53], v[52:53], v[116:117] neg_lo:[0,1] neg_hi:[0,1]
  v_cvt_pk_bf16_f32 v120, v52, v53
  v_lshlrev_b32 v52, 16, v120
  v_and_b32 v53, s22, v120
  v_pk_mul_f32 v[52:53], v[52:53], v[118:119]
  v_cvt_pk_bf16_f32 v18, v52, v53
  v_pk_add_f32 v[54:55], v[54:55], v[116:117] neg_lo:[0,1] neg_hi:[0,1]
  v_cvt_pk_bf16_f32 v121, v54, v55
  v_lshlrev_b32 v54, 16, v121
  v_and_b32 v55, s22, v121
  v_pk_mul_f32 v[54:55], v[54:55], v[118:119]
  v_cvt_pk_bf16_f32 v19, v54, v55
  v_pk_add_f32 v[56:57], v[56:57], v[116:117] neg_lo:[0,1] neg_hi:[0,1]
  v_cvt_pk_bf16_f32 v120, v56, v57
  v_lshlrev_b32 v56, 16, v120
  v_and_b32 v57, s22, v120
  v_pk_mul_f32 v[56:57], v[56:57], v[118:119]
  v_cvt_pk_bf16_f32 v20, v56, v57
  v_pk_add_f32 v[58:59], v[58:59], v[116:117] neg_lo:[0,1] neg_hi:[0,1]
  v_cvt_pk_bf16_f32 v121, v58, v59
  v_lshlrev_b32 v58, 16, v121
  v_and_b32 v59, s22, v121
  v_pk_mul_f32 v[58:59], v[58:59], v[118:119]
  v_cvt_pk_bf16_f32 v21, v58, v59
  v_pk_add_f32 v[60:61], v[60:61], v[116:117] neg_lo:[0,1] neg_hi:[0,1]
  v_cvt_pk_bf16_f32 v120, v60, v61
  v_lshlrev_b32 v60, 16, v120
  v_and_b32 v61, s22, v120
  v_pk_mul_f32 v[60:61], v[60:61], v[118:119]
  v_cvt_pk_bf16_f32 v22, v60, v61
  v_pk_add_f32 v[62:63], v[62:63], v[116:117] neg_lo:[0,1] neg_hi:[0,1]
  v_cvt_pk_bf16_f32 v121, v62, v63
  v_lshlrev_b32 v62, 16, v121
  v_and_b32 v63, s22, v121
  v_pk_mul_f32 v[62:63], v[62:63], v[118:119]
  v_cvt_pk_bf16_f32 v23, v62, v63
  v_pk_add_f32 v[64:65], v[64:65], v[116:117] neg_lo:[0,1] neg_hi:[0,1]
  v_cvt_pk_bf16_f32 v120, v64, v65
  v_lshlrev_b32 v64, 16, v120
  v_and_b32 v65, s22, v120
  v_pk_mul_f32 v[64:65], v[64:65], v[118:119]
  v_cvt_pk_bf16_f32 v24, v64, v65
  v_pk_add_f32 v[66:67], v[66:67], v[116:117] neg_lo:[0,1] neg_hi:[0,1]
  v_cvt_pk_bf16_f32 v121, v66, v67
  v_lshlrev_b32 v66, 16, v121
  v_and_b32 v67, s22, v121
  v_pk_mul_f32 v[66:67], v[66:67], v[118:119]
  v_cvt_pk_bf16_f32 v25, v66, v67
  v_pk_add_f32 v[68:69], v[68:69], v[116:117] neg_lo:[0,1] neg_hi:[0,1]
  v_cvt_pk_bf16_f32 v120, v68, v69
  v_lshlrev_b32 v68, 16, v120
  v_and_b32 v69, s22, v120
  v_pk_mul_f32 v[68:69], v[68:69], v[118:119]
  v_cvt_pk_bf16_f32 v26, v68, v69
  v_pk_add_f32 v[70:71], v[70:71], v[116:117] neg_lo:[0,1] neg_hi:[0,1]
  v_cvt_pk_bf16_f32 v121, v70, v71
  v_lshlrev_b32 v70, 16, v121
  v_and_b32 v71, s22, v121
  v_pk_mul_f32 v[70:71], v[70:71], v[118:119]
  v_cvt_pk_bf16_f32 v27, v70, v71
  v_pk_add_f32 v[72:73], v[72:73], v[116:117] neg_lo:[0,1] neg_hi:[0,1]
  v_cvt_pk_bf16_f32 v120, v72, v73
  v_lshlrev_b32 v72, 16, v120
  v_and_b32 v73, s22, v120
  v_pk_mul_f32 v[72:73], v[72:73], v[118:119]
  v_cvt_pk_bf16_f32 v28, v72, v73
  v_pk_add_f32 v[74:75], v[74:75], v[116:117] neg_lo:[0,1] neg_hi:[0,1]
  v_cvt_pk_bf16_f32 v121, v74, v75
  v_lshlrev_b32 v74, 16, v121
  v_and_b32 v75, s22, v121
  v_pk_mul_f32 v[74:75], v[74:75], v[118:119]
  v_cvt_pk_bf16_f32 v29, v74, v75
  v_pk_add_f32 v[76:77], v[76:77], v[116:117] neg_lo:[0,1] neg_hi:[0,1]
  v_cvt_pk_bf16_f32 v120, v76, v77
  v_lshlrev_b32 v76, 16, v120
  v_and_b32 v77, s22, v120
  v_pk_mul_f32 v[76:77], v[76:77], v[118:119]
  v_cvt_pk_bf16_f32 v30, v76, v77
  v_pk_add_f32 v[78:79], v[78:79], v[116:117] neg_lo:[0,1] neg_hi:[0,1]
  v_cvt_pk_bf16_f32 v121, v78, v79
  v_lshlrev_b32 v78, 16, v121
  v_and_b32 v79, s22, v121
  v_pk_mul_f32 v[78:79], v[78:79], v[118:119]
  v_cvt_pk_bf16_f32 v31, v78, v79
  v_pk_add_f32 v[80:81], v[80:81], v[116:117] neg_lo:[0,1] neg_hi:[0,1]
  v_cvt_pk_bf16_f32 v120, v80, v81
  v_lshlrev_b32 v80, 16, v120
  v_and_b32 v81, s22, v120
  v_pk_mul_f32 v[80:81], v[80:81], v[118:119]
  v_cvt_pk_bf16_f32 v32, v80, v81
  v_pk_add_f32 v[82:83], v[82:83], v[116:117] neg_lo:[0,1] neg_hi:[0,1]
  v_cvt_pk_bf16_f32 v121, v82, v83
  v_lshlrev_b32 v82, 16, v121
  v_and_b32 v83, s22, v121
  v_pk_mul_f32 v[82:83], v[82:83], v[118:119]
  v_cvt_pk_bf16_f32 v33, v82, v83
  v_pk_add_f32 v[84:85], v[84:85], v[116:117] neg_lo:[0,1] neg_hi:[0,1]
  v_cvt_pk_bf16_f32 v120, v84, v85
  v_lshlrev_b32 v84, 16, v120
  v_and_b32 v85, s22, v120
  v_pk_mul_f32 v[84:85], v[84:85], v[118:119]
  v_cvt_pk_bf16_f32 v34, v84, v85
  v_pk_add_f32 v[86:87], v[86:87], v[116:117] neg_lo:[0,1] neg_hi:[0,1]
  v_cvt_pk_bf16_f32 v121, v86, v87
  v_lshlrev_b32 v86, 16, v121
  v_and_b32 v87, s22, v121
  v_pk_mul_f32 v[86:87], v[86:87], v[118:119]
  v_cvt_pk_bf16_f32 v35, v86, v87
  v_pk_add_f32 v[88:89], v[88:89], v[116:117] neg_lo:[0,1] neg_hi:[0,1]
  v_cvt_pk_bf16_f32 v120, v88, v89
  v_lshlrev_b32 v88, 16, v120
  v_and_b32 v89, s22, v120
  v_pk_mul_f32 v[88:89], v[88:89], v[118:119]
  v_cvt_pk_bf16_f32 v36, v88, v89
  v_pk_add_f32 v[90:91], v[90:91], v[116:117] neg_lo:[0,1] neg_hi:[0,1]
  v_cvt_pk_bf16_f32 v121, v90, v91
  v_lshlrev_b32 v90, 16, v121
  v_and_b32 v91, s22, v121
  v_pk_mul_f32 v[90:91], v[90:91], v[118:119]
  v_cvt_pk_bf16_f32 v37, v90, v91
  v_pk_add_f32 v[92:93], v[92:93], v[116:117] neg_lo:[0,1] neg_hi:[0,1]
  v_cvt_pk_bf16_f32 v120, v92, v93
  v_lshlrev_b32 v92, 16, v120
  v_and_b32 v93, s22, v120
  v_pk_mul_f32 v[92:93], v[92:93], v[118:119]
  v_cvt_pk_bf16_f32 v38, v92, v93
  v_pk_add_f32 v[94:95], v[94:95], v[116:117] neg_lo:[0,1] neg_hi:[0,1]
  v_cvt_pk_bf16_f32 v121, v94, v95
  v_lshlrev_b32 v94, 16, v121
  v_and_b32 v95, s22, v121
  v_pk_mul_f32 v[94:95], v[94:95], v[118:119]
  v_cvt_pk_bf16_f32 v39, v94, v95
  v_pk_add_f32 v[96:97], v[96:97], v[116:117] neg_lo:[0,1] neg_hi:[0,1]
  v_cvt_pk_bf16_f32 v120, v96, v97
  v_lshlrev_b32 v96, 16, v120
  v_and_b32 v97, s22, v120
  v_pk_mul_f32 v[96:97], v[96:97], v[118:119]
  v_cvt_pk_bf16_f32 v40, v96, v97
  v_pk_add_f32 v[98:99], v[98:99], v[116:117] neg_lo:[0,1] neg_hi:[0,1]
  v_cvt_pk_bf16_f32 v121, v98, v99
  v_lshlrev_b32 v98, 16, v121
  v_and_b32 v99, s22, v121
  v_pk_mul_f32 v[98:99], v[98:99], v[118:119]
  v_cvt_pk_bf16_f32 v41, v98, v99
  v_pk_add_f32 v[100:101], v[100:101], v[116:117] neg_lo:[0,1] neg_hi:[0,1]
  v_cvt_pk_bf16_f32 v120, v100, v101
  v_lshlrev_b32 v100, 16, v120
  v_and_b32 v101, s22, v120
  v_pk_mul_f32 v[100:101], v[100:101], v[118:119]
  v_cvt_pk_bf16_f32 v42, v100, v101
  v_pk_add_f32 v[102:103], v[102:103], v[116:117] neg_lo:[0,1] neg_hi:[0,1]
  v_cvt_pk_bf16_f32 v121, v102, v103
  v_lshlrev_b32 v102, 16, v121
  v_and_b32 v103, s22, v121
  v_pk_mul_f32 v[102:103], v[102:103], v[118:119]
  v_cvt_pk_bf16_f32 v43, v102, v103
  ds_write_b128 v4, v[16:19] offset:0
  ds_write_b128 v4, v[20:23] offset:128
  ds_write_b128 v4, v[24:27] offset:256
  ds_write_b128 v4, v[28:31] offset:384
  ds_write_b128 v4, v[32:35] offset:512
  ds_write_b128 v4, v[36:39] offset:640
  ds_write_b128 v4, v[40:43] offset:768
  v_and_b32 v6, 15, v2
  v_lshrrev_b32 v7, 4, v2
  s_lshr_b32 s20, s8, 1
  s_and_b32 s21, s8, 1
  v_lshrrev_b32 v10, 3, v6
  v_lshlrev_b32 v10, 4, v10
  v_bfe_u32 v11, v6, 1, 1
  v_lshl_add_u32 v10, v11, 3, v10
  v_bfe_u32 v11, v6, 2, 1
  v_lshl_add_u32 v10, v11, 2, v10
  v_and_b32 v11, 1, v6
  v_add_u32 v10, v10, v11
  s_lshl_b32 s30, s21, 1
  v_add_u32 v10, s30, v10
  v_mul_u32_u24 v10, 912, v10
  v_lshrrev_b32 v11, 1, v7
  v_lshl_add_u32 v10, v11, 5, v10
  v_and_b32 v11, 1, v7
  v_lshl_add_u32 v10, v11, 3, v10
  s_mul_i32 s30, s20, 448
  v_add_u32 v10, s30, v10
  v_mul_u32_u24 v11, 912, v6
  s_mul_i32 s30, s8, 224
  v_add_u32 v11, s30, v11
  v_lshl_add_u32 v12, v7, 3, v11
  v_lshl_add_u32 v11, v7, 4, v11
  s_lshl_b32 s30, s76, 1
  s_add_u32 s30, s30, s21
  s_mul_i32 s30, s30, 14
  s_mul_i32 s31, s20, 7
  s_add_u32 s30, s30, s31
  s_lshl_b32 s30, s30, 10
  s_add_u32 s20, s30, 14680064
  s_lshl_b32 s30, s76, 2
  s_add_u32 s30, s30, s8
  s_mul_i32 s31, s30, 7168
  s_add_u32 s21, s31, 12845056
  s_lshl_b32 s30, s30, 3
  s_add_u32 s22, s30, 68173824
  s_waitcnt lgkmcnt(0)
  s_barrier
  ds_read2_b32 v[16:17], v10 offset0:0 offset1:4
  ds_read2_b32 v[18:19], v10 offset0:1 offset1:5
  ds_read2_b32 v[20:21], v10 offset0:16 offset1:20
  ds_read2_b32 v[22:23], v10 offset0:17 offset1:21
  ds_read2_b32 v[24:25], v10 offset0:32 offset1:36
  ds_read2_b32 v[26:27], v10 offset0:33 offset1:37
  ds_read2_b32 v[28:29], v10 offset0:48 offset1:52
  ds_read2_b32 v[30:31], v10 offset0:49 offset1:53
  ds_read2_b32 v[32:33], v10 offset0:64 offset1:68
  ds_read2_b32 v[34:35], v10 offset0:65 offset1:69
  ds_read2_b32 v[36:37], v10 offset0:80 offset1:84
  ds_read2_b32 v[38:39], v10 offset0:81 offset1:85
  ds_read2_b32 v[40:41], v10 offset0:96 offset1:100
  ds_read2_b32 v[42:43], v10 offset0:97 offset1:101
  ds_read_b128 v[48:51], v11 offset:0
  ds_read_b128 v[52:55], v11 offset:64
  ds_read_b128 v[56:59], v11 offset:128
  ds_read_b64 v[72:73], v12 offset:192
  ds_read_b128 v[60:63], v11 offset:14592
  ds_read_b128 v[64:67], v11 offset:14656
  ds_read_b128 v[68:71], v11 offset:14720
  ds_read_b64 v[74:75], v12 offset:14784
  s_add_u32 s30, s20, 4096
  s_add_u32 s31, s21, 4096
  s_waitcnt lgkmcnt(8)
  buffer_store_dwordx4 v[16:19], v5, s[4:7], s20 offen offset:0 sc1
  buffer_store_dwordx4 v[20:23], v5, s[4:7], s20 offen offset:1024 sc1
  buffer_store_dwordx4 v[24:27], v5, s[4:7], s20 offen offset:2048 sc1
  buffer_store_dwordx4 v[28:31], v5, s[4:7], s20 offen offset:3072 sc1
  buffer_store_dwordx4 v[32:35], v5, s[4:7], s30 offen offset:0 sc1
  buffer_store_dwordx4 v[36:39], v5, s[4:7], s30 offen offset:1024 sc1
  buffer_store_dwordx4 v[40:43], v5, s[4:7], s30 offen offset:2048 sc1
  s_waitcnt lgkmcnt(0)
  buffer_store_dwordx4 v[48:51], v5, s[4:7], s21 offen offset:0 sc1
  buffer_store_dwordx4 v[52:55], v5, s[4:7], s21 offen offset:1024 sc1
  buffer_store_dwordx4 v[56:59], v5, s[4:7], s21 offen offset:2048 sc1
  buffer_store_dwordx4 v[60:63], v5, s[4:7], s21 offen offset:3072 sc1
  buffer_store_dwordx4 v[64:67], v5, s[4:7], s31 offen offset:0 sc1
  buffer_store_dwordx4 v[68:71], v5, s[4:7], s31 offen offset:1024 sc1
  buffer_store_dwordx4 v[72:75], v5, s[4:7], s31 offen offset:2048 sc1
  s_barrier
  s_waitcnt vmcnt(0)
  v_mov_b32 v8, s12
  v_mov_b32 v9, s13
  v_mov_b32 v10, 0
  s_mov_b64 exec, 1
  buffer_store_dwordx2 v[8:9], v10, s[4:7], s22 offen offset:0 sc1
  s_mov_b64 exec, -1
L_noln_21:
  s_cmp_eq_u32 s10, 0
  s_cbranch_scc0 L_wk_22
  s_cmp_lt_u32 s11, 16
  s_cbranch_scc1 L_rx_23
  s_cmp_lt_u32 s11, 30
  s_cbranch_scc1 L_ry_24
  v_mov_b32 v4, s12
  v_mov_b32 v5, s13
  v_mov_b32 v6, 0
  s_mov_b64 exec, 1
  buffer_store_dwordx2 v[4:5], v6, s[4:7], s77 offen offset:0 sc1
  s_mov_b64 exec, -1
  v_mbcnt_lo_u32_b32 v2, -1, 0
  v_mbcnt_hi_u32_b32 v2, -1, v2
  v_lshlrev_b32 v3, 4, v2
  s_lshl_b32 s30, s8, 10
  v_add_u32 v4, s30, v3
  s_add_u32 s30, s8, 4
  s_min_u32 s30, s30, 6
  s_lshl_b32 s30, s30, 10
  v_add_u32 v5, s30, v3
  s_mov_b32 s16, 66060288
  s_mov_b32 s20, 0
  s_cmp_eq_u32 s11, 31
  s_cbranch_scc1 L_h1_25
  s_mov_b32 s28, 0
  s_mov_b32 s29, 68354048
  s_branch L_wl0_29
L_wl_28:
  s_sleep 8
L_wl0_29:
  buffer_load_dwordx4 v[24:27], v3, s[4:7], s29 offen offset:0 sc1
  s_add_u32 s28, s28, 1
  s_cmp_gt_u32 s28, 2000000
  s_cbranch_scc1 L_fail
  s_waitcnt vmcnt(0)
  v_xor_b32 v24, s12, v24
  v_xor_b32 v25, s13, v25
  v_xor_b32 v26, s12, v26
  v_xor_b32 v27, s13, v27
  v_or_b32 v24, v24, v25
  v_or3_b32 v24, v24, v26, v27
  v_cmp_ne_u32 vcc, 0, v24
  s_cbranch_vccnz L_wl_28
  s_mov_b32 s17, 66584576
  s_mul_i32 s30, s8, 3072
  s_min_u32 s30, s30, 7168
  s_add_u32 s18, s30, 67108864
  buffer_load_dwordx4 v[16:19], v3, s[4:7], s18 offen offset:0 sc1
  buffer_load_dwordx4 v[16:19], v3, s[4:7], s18 offen offset:1024 sc1
  buffer_load_dwordx4 v[16:19], v3, s[4:7], s18 offen offset:2048 sc1
  s_add_u32 s30, s16, 16384
  buffer_load_dwordx4 v[16:19], v4, s[4:7], s30 offen sc1
  buffer_load_dwordx4 v[16:19], v5, s[4:7], s30 offen sc1
  s_add_u32 s18, s18, 10240
L_h0l_26:
  s_mov_b32 s28, 0
  s_branch L_pollin_31
L_poll_30:
  s_sleep 2
L_pollin_31:
  buffer_load_dwordx4 v[8:11], v4, s[4:7], s16 offen offset:0 sc1
  buffer_load_dwordx4 v[12:15], v5, s[4:7], s16 offen offset:0 sc1
  s_add_u32 s28, s28, 1
  s_cmp_gt_u32 s28, 400000
  s_cbranch_scc1 L_fail
  s_waitcnt vmcnt(0)
  v_max_u32 v24, v8, v12
  v_cmp_eq_u32 vcc, -1, v24
  s_cbranch_vccnz L_poll_30
  buffer_store_dwordx4 v[8:11], v4, s[4:7], s17 offen sc1
  buffer_store_dwordx4 v[12:15], v5, s[4:7], s17 offen sc1
  buffer_load_dwordx4 v[16:19], v3, s[4:7], s18 offen offset:0 sc1
  buffer_load_dwordx4 v[16:19], v3, s[4:7], s18 offen offset:1024 sc1
  buffer_load_dwordx4 v[16:19], v3, s[4:7], s18 offen offset:2048 sc1
  s_add_u32 s30, s16, 16384
  buffer_load_dwordx4 v[16:19], v4, s[4:7], s30 offen sc1
  buffer_load_dwordx4 v[16:19], v5, s[4:7], s30 offen sc1
  s_add_u32 s18, s18, 10240
  s_add_u32 s16, s16, 8192
  s_add_u32 s17, s17, 8192
  s_add_u32 s20, s20, 1
  s_cmp_lt_u32 s20, 63
  s_cbranch_scc1 L_h0l_26
  s_branch L_fin_20
L_h1_25:
  s_mov_b32 s28, 0
  s_mov_b32 s29, 68173824
  s_branch L_wl0_33
L_wl_32:
  s_sleep 8
L_wl0_33:
  buffer_load_dwordx4 v[24:27], v3, s[4:7], s29 offen offset:0 sc1
  buffer_load_dwordx4 v[28:31], v3, s[4:7], s29 offen offset:1024 sc1
  s_add_u32 s28, s28, 1
  s_cmp_gt_u32 s28, 2000000
  s_cbranch_scc1 L_fail
  s_waitcnt vmcnt(0)
  v_xor_b32 v24, s12, v24
  v_xor_b32 v25, s13, v25
  v_xor_b32 v26, s12, v26
  v_xor_b32 v27, s13, v27
  v_xor_b32 v28, s12, v28
  v_xor_b32 v29, s13, v29
  v_xor_b32 v30, s12, v30
  v_xor_b32 v31, s13, v31
  v_or_b32 v24, v24, v25
  v_or3_b32 v24, v24, v26, v27
  v_or3_b32 v24, v24, v28, v29
  v_or3_b32 v24, v24, v30, v31
  v_cmp_ne_u32 vcc, 0, v24
  s_cbranch_vccnz L_wl_32
  s_mul_i32 s30, s8, 7168
  s_add_u32 s19, s30, 12845056
  s_add_u32 s30, s19, 4096
  buffer_load_dwordx4 v[16:19], v3, s[4:7], s19 offen offset:0 sc1
  buffer_load_dwordx4 v[16:19], v3, s[4:7], s19 offen offset:1024 sc1
  buffer_load_dwordx4 v[16:19], v3, s[4:7], s19 offen offset:2048 sc1
  buffer_load_dwordx4 v[16:19], v3, s[4:7], s19 offen offset:3072 sc1
  buffer_load_dwordx4 v[16:19], v3, s[4:7], s30 offen offset:0 sc1
  buffer_load_dwordx4 v[16:19], v3, s[4:7], s30 offen offset:1024 sc1
  buffer_load_dwordx4 v[16:19], v3, s[4:7], s30 offen offset:2048 sc1
  s_add_u32 s19, s19, 28672
  s_add_u32 s30, s19, 4096
  buffer_load_dwordx4 v[16:19], v3, s[4:7], s19 offen offset:0 sc1
  buffer_load_dwordx4 v[16:19], v3, s[4:7], s19 offen offset:1024 sc1
  buffer_load_dwordx4 v[16:19], v3, s[4:7], s19 offen offset:2048 sc1
  buffer_load_dwordx4 v[16:19], v3, s[4:7], s19 offen offset:3072 sc1
  buffer_load_dwordx4 v[16:19], v3, s[4:7], s30 offen offset:0 sc1
  buffer_load_dwordx4 v[16:19], v3, s[4:7], s30 offen offset:1024 sc1
  buffer_load_dwordx4 v[16:19], v3, s[4:7], s30 offen offset:2048 sc1
  s_add_u32 s19, s19, 28672
L_h1l_27:
  s_mov_b32 s28, 0
  s_branch L_pollin_35
L_poll_34:
  s_sleep 2
L_pollin_35:
  buffer_load_dwordx4 v[8:11], v4, s[4:7], s16 offen offset:0 sc1
  s_add_u32 s28, s28, 1
  s_cmp_gt_u32 s28, 400000
  s_cbranch_scc1 L_fail
  s_waitcnt vmcnt(0)
  v_cmp_eq_u32 vcc, -1, v8
  s_cbranch_vccnz L_poll_34
  s_add_u32 s30, s19, 4096
  buffer_load_dwordx4 v[16:19], v3, s[4:7], s19 offen offset:0 sc1
  buffer_load_dwordx4 v[16:19], v3, s[4:7], s19 offen offset:1024 sc1
  buffer_load_dwordx4 v[16:19], v3, s[4:7], s19 offen offset:2048 sc1
  buffer_load_dwordx4 v[16:19], v3, s[4:7], s19 offen offset:3072 sc1
  buffer_load_dwordx4 v[16:19], v3, s[4:7], s30 offen offset:0 sc1
  buffer_load_dwordx4 v[16:19], v3, s[4:7], s30 offen offset:1024 sc1
  buffer_load_dwordx4 v[16:19], v3, s[4:7], s30 offen offset:2048 sc1
  s_add_u32 s19, s19, 28672
  s_add_u32 s16, s16, 8192
  s_add_u32 s20, s20, 1
  s_cmp_lt_u32 s20, 62
  s_cbranch_scc1 L_h1l_27
  s_branch L_fin_20
  s_branch L_end
L_wk_22:
  s_cmp_lt_u32 s9, 32
  s_cbranch_scc1 L_VW_36
  s_cmp_lt_u32 s9, 60
  s_cbranch_scc1 L_GU_37
  s_cmp_lt_u32 s9, 108
  s_cbranch_scc1 L_TW_38
  s_cmp_lt_u32 s9, 140
  s_cbranch_scc1 L_UW_39
  s_cmp_lt_u32 s9, 168
  s_cbranch_scc1 L_GD_40
  s_cmp_lt_u32 s9, 224
  s_cbranch_scc1 L_F_41
  s_branch L_end
L_VW_36:
  s_lshr_b32 s16, s9, 1
  s_and_b32 s17, s9, 1
  v_mbcnt_lo_u32_b32 v83, -1, 0
  v_mbcnt_hi_u32_b32 v83, -1, v83
  v_lshlrev_b32 v80, 4, v83
  v_lshlrev_b32 v82, 3, v83
  v_mov_b32 v84, s12
  v_mov_b32 v85, s13
  v_cmp_eq_u32 vcc, 0, v83
  v_mov_b32 v86, 0x80000000
  s_nop 0
  v_cndmask_b32 v86, v86, 0, vcc
  s_mov_b32 s29, 68173824
  s_mov_b32 s28, 0
  s_branch L_wf0_43
L_wf_42:
  s_sleep 2
L_wf0_43:
  buffer_load_dwordx2 v[88:89], v82, s[4:7], s29 offen offset:0 sc1
  s_add_u32 s28, s28, 1
  s_cmp_gt_u32 s28, 2000000
  s_cbranch_scc1 L_fail
  s_waitcnt vmcnt(0)
  v_xor_b32 v88, s12, v88
  v_xor_b32 v89, s13, v89
  v_or_b32 v88, v88, v89
  v_cmp_ne_u32 vcc, 0, v88
  s_cbranch_vccnz L_wf_42
  s_mul_i32 s30, s17, 28672
  s_mul_i32 s19, s8, 7168
  s_add_u32 s30, s30, s19
  s_add_u32 s18, s30, 14680064
  v_mov_b32 v81, v80
  s_mov_b32 m0, s19
  s_nop 0
  buffer_load_dwordx4 v80, s[4:7], s18 offen offset:0 sc1 lds
  buffer_load_dwordx4 v80, s[4:7], s18 offen offset:1024 sc1 lds
  buffer_load_dwordx4 v80, s[4:7], s18 offen offset:2048 sc1 lds
  buffer_load_dwordx4 v80, s[4:7], s18 offen offset:3072 sc1 lds
  s_add_u32 m0, s19, 4096
  s_add_u32 s30, s18, 4096
  buffer_load_dwordx4 v80, s[4:7], s30 offen offset:0 sc1 lds
  buffer_load_dwordx4 v80, s[4:7], s30 offen offset:1024 sc1 lds
  buffer_load_dwordx4 v80, s[4:7], s30 offen offset:2048 sc1 lds
  s_lshl_b32 s30, s17, 4
  s_add_u32 s30, s30, s16
  s_lshl_b32 s31, s30, 2
  s_add_u32 s31, s31, s8
  s_lshl_b32 s31, s31, 3
  s_add_u32 s21, s31, 68190208
  s_mul_i32 s30, s30, 28672
  s_mul_i32 s31, s8, 7168
  s_add_u32 s30, s30, s31
  s_add_u32 s20, s30, 16777216
  s_mov_b32 s22, 0xf0000000
  s_add_u32 s23, s16, 16
  s_mul_i32 s26, s23, 448
  s_add_u32 s26, s26, 68419584
  s_mov_b32 exec_lo, 0xffffffff
  s_mov_b32 exec_hi, 0xffffff
  s_mov_b32 s28, 0
  s_branch L_wf0_45
L_wf_44:
  s_sleep 2
L_wf0_45:
  buffer_load_dwordx2 v[88:89], v82, s[4:7], s26 offen offset:0 sc1
  s_add_u32 s28, s28, 1
  s_cmp_gt_u32 s28, 2000000
  s_cbranch_scc1 L_fail
  s_waitcnt vmcnt(0)
  v_xor_b32 v88, s12, v88
  v_xor_b32 v89, s13, v89
  v_or_b32 v88, v88, v89
  v_cmp_ne_u32 vcc, 0, v88
  s_cbranch_vccnz L_wf_44
  s_mov_b64 exec, -1
  s_mul_i32 s31, s23, 401408
  s_mul_i32 s30, s8, 100352
  s_add_u32 s31, s31, s30
  s_add_u32 s27, s31, 0
  s_add_u32 s26, s26, 14336
  s_add_u32 s30, s27, 0
  buffer_load_dwordx4 a[0:3], v80, s[4:7], s30 offen sc1
  s_add_u32 s30, s27, 14336
  buffer_load_dwordx4 a[56:59], v80, s[4:7], s30 offen sc1
  s_add_u32 s30, s27, 28672
  buffer_load_dwordx4 a[112:115], v80, s[4:7], s30 offen sc1
  s_add_u32 s30, s27, 43008
  buffer_load_dwordx4 a[168:171], v80, s[4:7], s30 offen sc1
  s_add_u32 s30, s27, 57344
  buffer_load_dwordx4 a[224:227], v80, s[4:7], s30 offen sc1
  s_add_u32 s30, s27, 71680
  buffer_load_dwordx4 v[144:147], v80, s[4:7], s30 offen sc1
  s_add_u32 s30, s27, 86016
  buffer_load_dwordx4 v[200:203], v80, s[4:7], s30 offen sc1
  s_add_u32 s30, s27, 1024
  buffer_load_dwordx4 a[4:7], v80, s[4:7], s30 offen sc1
  s_add_u32 s30, s27, 15360
  buffer_load_dwordx4 a[60:63], v80, s[4:7], s30 offen sc1
  s_add_u32 s30, s27, 29696
  buffer_load_dwordx4 a[116:119], v80, s[4:7], s30 offen sc1
  s_add_u32 s30, s27, 44032
  buffer_load_dwordx4 a[172:175], v80, s[4:7], s30 offen sc1
  s_add_u32 s30, s27, 58368
  buffer_load_dwordx4 a[228:231], v80, s[4:7], s30 offen sc1
  s_add_u32 s30, s27, 72704
  buffer_load_dwordx4 v[148:151], v80, s[4:7], s30 offen sc1
  s_add_u32 s30, s27, 87040
  buffer_load_dwordx4 v[204:207], v80, s[4:7], s30 offen sc1
  s_add_u32 s30, s27, 2048
  buffer_load_dwordx4 a[8:11], v80, s[4:7], s30 offen sc1
  s_add_u32 s30, s27, 16384
  buffer_load_dwordx4 a[64:67], v80, s[4:7], s30 offen sc1
  s_add_u32 s30, s27, 30720
  buffer_load_dwordx4 a[120:123], v80, s[4:7], s30 offen sc1
  s_add_u32 s30, s27, 45056
  buffer_load_dwordx4 a[176:179], v80, s[4:7], s30 offen sc1
  s_add_u32 s30, s27, 59392
  buffer_load_dwordx4 a[232:235], v80, s[4:7], s30 offen sc1
  s_add_u32 s30, s27, 73728
  buffer_load_dwordx4 v[152:155], v80, s[4:7], s30 offen sc1
  s_add_u32 s30, s27, 88064
  buffer_load_dwordx4 v[208:211], v80, s[4:7], s30 offen sc1
  s_add_u32 s30, s27, 3072
  buffer_load_dwordx4 a[12:15], v80, s[4:7], s30 offen sc1
  s_add_u32 s30, s27, 17408
  buffer_load_dwordx4 a[68:71], v80, s[4:7], s30 offen sc1
  s_add_u32 s30, s27, 31744
  buffer_load_dwordx4 a[124:127], v80, s[4:7], s30 offen sc1
  s_add_u32 s30, s27, 46080
  buffer_load_dwordx4 a[180:183], v80, s[4:7], s30 offen sc1
  s_add_u32 s30, s27, 60416
  buffer_load_dwordx4 a[236:239], v80, s[4:7], s30 offen sc1
  s_add_u32 s30, s27, 74752
  buffer_load_dwordx4 v[156:159], v80, s[4:7], s30 offen sc1
  s_add_u32 s30, s27, 89088
  buffer_load_dwordx4 v[212:215], v80, s[4:7], s30 offen sc1
  buffer_load_dwordx2 v[88:89], v82, s[4:7], s26 offen sc1
  s_add_u32 s30, s27, 7168
  buffer_load_dwordx4 a[28:31], v80, s[4:7], s30 offen sc1
  s_add_u32 s30, s27, 21504
  buffer_load_dwordx4 a[84:87], v80, s[4:7], s30 offen sc1
  s_add_u32 s30, s27, 35840
  buffer_load_dwordx4 a[140:143], v80, s[4:7], s30 offen sc1
  s_add_u32 s30, s27, 50176
  buffer_load_dwordx4 a[196:199], v80, s[4:7], s30 offen sc1
  s_add_u32 s30, s27, 64512
  buffer_load_dwordx4 a[252:255], v80, s[4:7], s30 offen sc1
  s_add_u32 s30, s27, 78848
  buffer_load_dwordx4 v[172:175], v80, s[4:7], s30 offen sc1
  s_add_u32 s30, s27, 93184
  buffer_load_dwordx4 v[228:231], v80, s[4:7], s30 offen sc1
  s_add_u32 s30, s27, 8192
  buffer_load_dwordx4 a[32:35], v80, s[4:7], s30 offen sc1
  s_add_u32 s30, s27, 22528
  buffer_load_dwordx4 a[88:91], v80, s[4:7], s30 offen sc1
  s_add_u32 s30, s27, 36864
  buffer_load_dwordx4 a[144:147], v80, s[4:7], s30 offen sc1
  s_add_u32 s30, s27, 51200
  buffer_load_dwordx4 a[200:203], v80, s[4:7], s30 offen sc1
  s_add_u32 s30, s27, 65536
  buffer_load_dwordx4 v[120:123], v80, s[4:7], s30 offen sc1
  s_add_u32 s30, s27, 79872
  buffer_load_dwordx4 v[176:179], v80, s[4:7], s30 offen sc1
  s_add_u32 s30, s27, 94208
  buffer_load_dwordx4 v[232:235], v80, s[4:7], s30 offen sc1
  s_add_u32 s30, s27, 9216
  buffer_load_dwordx4 a[36:39], v80, s[4:7], s30 offen sc1
  s_add_u32 s30, s27, 23552
  buffer_load_dwordx4 a[92:95], v80, s[4:7], s30 offen sc1
  s_add_u32 s30, s27, 37888
  buffer_load_dwordx4 a[148:151], v80, s[4:7], s30 offen sc1
  s_add_u32 s30, s27, 52224
  buffer_load_dwordx4 a[204:207], v80, s[4:7], s30 offen sc1
  s_add_u32 s30, s27, 66560
  buffer_load_dwordx4 v[124:127], v80, s[4:7], s30 offen sc1
  s_add_u32 s30, s27, 80896
  buffer_load_dwordx4 v[180:183], v80, s[4:7], s30 offen sc1
  s_add_u32 s30, s27, 95232
  buffer_load_dwordx4 v[236:239], v80, s[4:7], s30 offen sc1
  s_add_u32 s30, s27, 10240
  buffer_load_dwordx4 a[40:43], v80, s[4:7], s30 offen sc1
  s_add_u32 s30, s27, 24576
  buffer_load_dwordx4 a[96:99], v80, s[4:7], s30 offen sc1
  s_add_u32 s30, s27, 38912
  buffer_load_dwordx4 a[152:155], v80, s[4:7], s30 offen sc1
  s_add_u32 s30, s27, 53248
  buffer_load_dwordx4 a[208:211], v80, s[4:7], s30 offen sc1
  s_add_u32 s30, s27, 67584
  buffer_load_dwordx4 v[128:131], v80, s[4:7], s30 offen sc1
  s_add_u32 s30, s27, 81920
  buffer_load_dwordx4 v[184:187], v80, s[4:7], s30 offen sc1
  s_add_u32 s30, s27, 96256
  buffer_load_dwordx4 v[240:243], v80, s[4:7], s30 offen sc1
  s_waitcnt vmcnt(28)
  s_mov_b32 exec_lo, 0xffffffff
  s_mov_b32 exec_hi, 0xffffff
  v_xor_b32 v88, s12, v88
  v_xor_b32 v89, s13, v89
  v_or_b32 v88, v88, v89
  v_cmp_ne_u32 vcc, 0, v88
  s_mov_b64 exec, -1
  s_cbranch_vccz L_fok_46
  s_mov_b32 exec_lo, 0xffffffff
  s_mov_b32 exec_hi, 0xffffff
  s_mov_b32 s28, 0
  s_branch L_wf0_48
L_wf_47:
  s_sleep 1
L_wf0_48:
  buffer_load_dwordx2 v[88:89], v82, s[4:7], s26 offen offset:0 sc1
  s_add_u32 s28, s28, 1
  s_cmp_gt_u32 s28, 2000000
  s_cbranch_scc1 L_fail
  s_waitcnt vmcnt(0)
  v_xor_b32 v88, s12, v88
  v_xor_b32 v89, s13, v89
  v_or_b32 v88, v88, v89
  v_cmp_ne_u32 vcc, 0, v88
  s_cbranch_vccnz L_wf_47
  s_mov_b64 exec, -1
L_fok_46:
  s_add_u32 s30, s27, 4096
  buffer_load_dwordx4 a[16:19], v80, s[4:7], s30 offen sc1
  s_add_u32 s30, s27, 18432
  buffer_load_dwordx4 a[72:75], v80, s[4:7], s30 offen sc1
  s_add_u32 s30, s27, 32768
  buffer_load_dwordx4 a[128:131], v80, s[4:7], s30 offen sc1
  s_add_u32 s30, s27, 47104
  buffer_load_dwordx4 a[184:187], v80, s[4:7], s30 offen sc1
  s_add_u32 s30, s27, 61440
  buffer_load_dwordx4 a[240:243], v80, s[4:7], s30 offen sc1
  s_add_u32 s30, s27, 75776
  buffer_load_dwordx4 v[160:163], v80, s[4:7], s30 offen sc1
  s_add_u32 s30, s27, 90112
  buffer_load_dwordx4 v[216:219], v80, s[4:7], s30 offen sc1
  s_add_u32 s30, s27, 5120
  buffer_load_dwordx4 a[20:23], v80, s[4:7], s30 offen sc1
  s_add_u32 s30, s27, 19456
  buffer_load_dwordx4 a[76:79], v80, s[4:7], s30 offen sc1
  s_add_u32 s30, s27, 33792
  buffer_load_dwordx4 a[132:135], v80, s[4:7], s30 offen sc1
  s_add_u32 s30, s27, 48128
  buffer_load_dwordx4 a[188:191], v80, s[4:7], s30 offen sc1
  s_add_u32 s30, s27, 62464
  buffer_load_dwordx4 a[244:247], v80, s[4:7], s30 offen sc1
  s_add_u32 s30, s27, 76800
  buffer_load_dwordx4 v[164:167], v80, s[4:7], s30 offen sc1
  s_add_u32 s30, s27, 91136
  buffer_load_dwordx4 v[220:223], v80, s[4:7], s30 offen sc1
  s_add_u32 s30, s27, 6144
  buffer_load_dwordx4 a[24:27], v80, s[4:7], s30 offen sc1
  s_add_u32 s30, s27, 20480
  buffer_load_dwordx4 a[80:83], v80, s[4:7], s30 offen sc1
  s_add_u32 s30, s27, 34816
  buffer_load_dwordx4 a[136:139], v80, s[4:7], s30 offen sc1
  s_add_u32 s30, s27, 49152
  buffer_load_dwordx4 a[192:195], v80, s[4:7], s30 offen sc1
  s_add_u32 s30, s27, 63488
  buffer_load_dwordx4 a[248:251], v80, s[4:7], s30 offen sc1
  s_add_u32 s30, s27, 77824
  buffer_load_dwordx4 v[168:171], v80, s[4:7], s30 offen sc1
  s_add_u32 s30, s27, 92160
  buffer_load_dwordx4 v[224:227], v80, s[4:7], s30 offen sc1
  s_add_u32 s30, s27, 11264
  buffer_load_dwordx4 a[44:47], v80, s[4:7], s30 offen sc1
  s_add_u32 s30, s27, 25600
  buffer_load_dwordx4 a[100:103], v80, s[4:7], s30 offen sc1
  s_add_u32 s30, s27, 39936
  buffer_load_dwordx4 a[156:159], v80, s[4:7], s30 offen sc1
  s_add_u32 s30, s27, 54272
  buffer_load_dwordx4 a[212:215], v80, s[4:7], s30 offen sc1
  s_add_u32 s30, s27, 68608
  buffer_load_dwordx4 v[132:135], v80, s[4:7], s30 offen sc1
  s_add_u32 s30, s27, 82944
  buffer_load_dwordx4 v[188:191], v80, s[4:7], s30 offen sc1
  s_add_u32 s30, s27, 97280
  buffer_load_dwordx4 v[244:247], v80, s[4:7], s30 offen sc1
  s_add_u32 s30, s27, 12288
  buffer_load_dwordx4 a[48:51], v80, s[4:7], s30 offen sc1
  s_add_u32 s30, s27, 26624
  buffer_load_dwordx4 a[104:107], v80, s[4:7], s30 offen sc1
  s_add_u32 s30, s27, 40960
  buffer_load_dwordx4 a[160:163], v80, s[4:7], s30 offen sc1
  s_add_u32 s30, s27, 55296
  buffer_load_dwordx4 a[216:219], v80, s[4:7], s30 offen sc1
  s_add_u32 s30, s27, 69632
  buffer_load_dwordx4 v[136:139], v80, s[4:7], s30 offen sc1
  s_add_u32 s30, s27, 83968
  buffer_load_dwordx4 v[192:195], v80, s[4:7], s30 offen sc1
  s_add_u32 s30, s27, 98304
  buffer_load_dwordx4 v[248:251], v80, s[4:7], s30 offen sc1
  s_add_u32 s30, s27, 13312
  buffer_load_dwordx4 a[52:55], v80, s[4:7], s30 offen sc1
  s_add_u32 s30, s27, 27648
  buffer_load_dwordx4 a[108:111], v80, s[4:7], s30 offen sc1
  s_add_u32 s30, s27, 41984
  buffer_load_dwordx4 a[164:167], v80, s[4:7], s30 offen sc1
  s_add_u32 s30, s27, 56320
  buffer_load_dwordx4 a[220:223], v80, s[4:7], s30 offen sc1
  s_add_u32 s30, s27, 70656
  buffer_load_dwordx4 v[140:143], v80, s[4:7], s30 offen sc1
  s_add_u32 s30, s27, 84992
  buffer_load_dwordx4 v[196:199], v80, s[4:7], s30 offen sc1
  s_add_u32 s30, s27, 99328
  buffer_load_dwordx4 v[252:255], v80, s[4:7], s30 offen sc1
  s_branch L_vw1_49
L_vw_50:
  s_waitcnt vmcnt(8)
L_vw1_49:
  s_barrier
  s_add_u32 s30, s17, 2
  s_add_u32 s31, s18, 57344
  s_cmp_lt_u32 s30, 64
  s_cselect_b32 s18, s31, 0xf0000000
  s_add_u32 s31, s19, 28672
  s_sub_u32 s30, s19, 28672
  s_cmp_ge_u32 s19, 28672
  s_cselect_b32 s19, s30, s31
  ds_read_b128 v[56:59], v81 offset:0
  ds_read_b128 v[60:63], v81 offset:14336
  ds_read_b128 v[64:67], v81 offset:1024
  ds_read_b128 v[68:71], v81 offset:15360
  ds_read_b128 v[72:75], v81 offset:2048
  ds_read_b128 v[76:79], v81 offset:16384
  s_waitcnt lgkmcnt(4) vmcnt(63)
  v_mfma_f32_16x16x32_bf16 v[0:3], v[56:59], a[0:3], 0
  s_mov_b32 m0, s19
  s_nop 0
  buffer_load_dwordx4 v80, s[4:7], s18 offen offset:0 sc1 lds
  v_mfma_f32_16x16x32_bf16 v[4:7], v[60:63], a[0:3], 0
  v_mfma_f32_16x16x32_bf16 v[8:11], v[56:59], a[56:59], 0
  v_mfma_f32_16x16x32_bf16 v[12:15], v[60:63], a[56:59], 0
  v_mfma_f32_16x16x32_bf16 v[16:19], v[56:59], a[112:115], 0
  v_mfma_f32_16x16x32_bf16 v[20:23], v[60:63], a[112:115], 0
  v_mfma_f32_16x16x32_bf16 v[24:27], v[56:59], a[168:171], 0
  v_mfma_f32_16x16x32_bf16 v[28:31], v[60:63], a[168:171], 0
  v_mfma_f32_16x16x32_bf16 v[32:35], v[56:59], a[224:227], 0
  v_mfma_f32_16x16x32_bf16 v[36:39], v[60:63], a[224:227], 0
  v_mfma_f32_16x16x32_bf16 v[40:43], v[56:59], v[144:147], 0
  v_mfma_f32_16x16x32_bf16 v[44:47], v[60:63], v[144:147], 0
  v_mfma_f32_16x16x32_bf16 v[48:51], v[56:59], v[200:203], 0
  v_mfma_f32_16x16x32_bf16 v[52:55], v[60:63], v[200:203], 0
  ds_read_b128 v[56:59], v81 offset:3072
  ds_read_b128 v[60:63], v81 offset:17408
  s_waitcnt lgkmcnt(4) vmcnt(63)
  v_mfma_f32_16x16x32_bf16 v[0:3], v[64:67], a[4:7], v[0:3]
  buffer_load_dwordx4 v80, s[4:7], s18 offen offset:1024 sc1 lds
  v_mfma_f32_16x16x32_bf16 v[4:7], v[68:71], a[4:7], v[4:7]
  v_mfma_f32_16x16x32_bf16 v[8:11], v[64:67], a[60:63], v[8:11]
  v_mfma_f32_16x16x32_bf16 v[12:15], v[68:71], a[60:63], v[12:15]
  v_mfma_f32_16x16x32_bf16 v[16:19], v[64:67], a[116:119], v[16:19]
  v_mfma_f32_16x16x32_bf16 v[20:23], v[68:71], a[116:119], v[20:23]
  v_mfma_f32_16x16x32_bf16 v[24:27], v[64:67], a[172:175], v[24:27]
  v_mfma_f32_16x16x32_bf16 v[28:31], v[68:71], a[172:175], v[28:31]
  v_mfma_f32_16x16x32_bf16 v[32:35], v[64:67], a[228:231], v[32:35]
  v_mfma_f32_16x16x32_bf16 v[36:39], v[68:71], a[228:231], v[36:39]
  v_mfma_f32_16x16x32_bf16 v[40:43], v[64:67], v[148:151], v[40:43]
  v_mfma_f32_16x16x32_bf16 v[44:47], v[68:71], v[148:151], v[44:47]
  v_mfma_f32_16x16x32_bf16 v[48:51], v[64:67], v[204:207], v[48:51]
  v_mfma_f32_16x16x32_bf16 v[52:55], v[68:71], v[204:207], v[52:55]
  ds_read_b128 v[64:67], v81 offset:7168
  ds_read_b128 v[68:71], v81 offset:21504
  s_waitcnt lgkmcnt(4) vmcnt(63)
  v_mfma_f32_16x16x32_bf16 v[0:3], v[72:75], a[8:11], v[0:3]
  buffer_load_dwordx4 v80, s[4:7], s18 offen offset:2048 sc1 lds
  v_mfma_f32_16x16x32_bf16 v[4:7], v[76:79], a[8:11], v[4:7]
  v_mfma_f32_16x16x32_bf16 v[8:11], v[72:75], a[64:67], v[8:11]
  v_mfma_f32_16x16x32_bf16 v[12:15], v[76:79], a[64:67], v[12:15]
  v_mfma_f32_16x16x32_bf16 v[16:19], v[72:75], a[120:123], v[16:19]
  v_mfma_f32_16x16x32_bf16 v[20:23], v[76:79], a[120:123], v[20:23]
  v_mfma_f32_16x16x32_bf16 v[24:27], v[72:75], a[176:179], v[24:27]
  v_mfma_f32_16x16x32_bf16 v[28:31], v[76:79], a[176:179], v[28:31]
  v_mfma_f32_16x16x32_bf16 v[32:35], v[72:75], a[232:235], v[32:35]
  v_mfma_f32_16x16x32_bf16 v[36:39], v[76:79], a[232:235], v[36:39]
  v_mfma_f32_16x16x32_bf16 v[40:43], v[72:75], v[152:155], v[40:43]
  v_mfma_f32_16x16x32_bf16 v[44:47], v[76:79], v[152:155], v[44:47]
  v_mfma_f32_16x16x32_bf16 v[48:51], v[72:75], v[208:211], v[48:51]
  v_mfma_f32_16x16x32_bf16 v[52:55], v[76:79], v[208:211], v[52:55]
  ds_read_b128 v[72:75], v81 offset:8192
  ds_read_b128 v[76:79], v81 offset:22528
  s_waitcnt lgkmcnt(4) vmcnt(63)
  v_mfma_f32_16x16x32_bf16 v[0:3], v[56:59], a[12:15], v[0:3]
  buffer_load_dwordx4 v80, s[4:7], s18 offen offset:3072 sc1 lds
  v_mfma_f32_16x16x32_bf16 v[4:7], v[60:63], a[12:15], v[4:7]
  v_mfma_f32_16x16x32_bf16 v[8:11], v[56:59], a[68:71], v[8:11]
  v_mfma_f32_16x16x32_bf16 v[12:15], v[60:63], a[68:71], v[12:15]
  v_mfma_f32_16x16x32_bf16 v[16:19], v[56:59], a[124:127], v[16:19]
  v_mfma_f32_16x16x32_bf16 v[20:23], v[60:63], a[124:127], v[20:23]
  v_mfma_f32_16x16x32_bf16 v[24:27], v[56:59], a[180:183], v[24:27]
  v_mfma_f32_16x16x32_bf16 v[28:31], v[60:63], a[180:183], v[28:31]
  v_mfma_f32_16x16x32_bf16 v[32:35], v[56:59], a[236:239], v[32:35]
  v_mfma_f32_16x16x32_bf16 v[36:39], v[60:63], a[236:239], v[36:39]
  v_mfma_f32_16x16x32_bf16 v[40:43], v[56:59], v[156:159], v[40:43]
  v_mfma_f32_16x16x32_bf16 v[44:47], v[60:63], v[156:159], v[44:47]
  v_mfma_f32_16x16x32_bf16 v[48:51], v[56:59], v[212:215], v[48:51]
  v_mfma_f32_16x16x32_bf16 v[52:55], v[60:63], v[212:215], v[52:55]
  ds_read_b128 v[56:59], v81 offset:9216
  ds_read_b128 v[60:63], v81 offset:23552
  s_waitcnt lgkmcnt(4) vmcnt(63)
  v_mfma_f32_16x16x32_bf16 v[0:3], v[64:67], a[28:31], v[0:3]
  s_add_u32 m0, s19, 4096
  s_add_u32 s30, s18, 4096
  buffer_load_dwordx4 v80, s[4:7], s30 offen offset:0 sc1 lds
  v_mfma_f32_16x16x32_bf16 v[4:7], v[68:71], a[28:31], v[4:7]
  v_mfma_f32_16x16x32_bf16 v[8:11], v[64:67], a[84:87], v[8:11]
  v_mfma_f32_16x16x32_bf16 v[12:15], v[68:71], a[84:87], v[12:15]
  v_mfma_f32_16x16x32_bf16 v[16:19], v[64:67], a[140:143], v[16:19]
  v_mfma_f32_16x16x32_bf16 v[20:23], v[68:71], a[140:143], v[20:23]
  v_mfma_f32_16x16x32_bf16 v[24:27], v[64:67], a[196:199], v[24:27]
  v_mfma_f32_16x16x32_bf16 v[28:31], v[68:71], a[196:199], v[28:31]
  v_mfma_f32_16x16x32_bf16 v[32:35], v[64:67], a[252:255], v[32:35]
  v_mfma_f32_16x16x32_bf16 v[36:39], v[68:71], a[252:255], v[36:39]
  v_mfma_f32_16x16x32_bf16 v[40:43], v[64:67], v[172:175], v[40:43]
  v_mfma_f32_16x16x32_bf16 v[44:47], v[68:71], v[172:175], v[44:47]
  v_mfma_f32_16x16x32_bf16 v[48:51], v[64:67], v[228:231], v[48:51]
  v_mfma_f32_16x16x32_bf16 v[52:55], v[68:71], v[228:231], v[52:55]
  ds_read_b128 v[64:67], v81 offset:10240
  ds_read_b128 v[68:71], v81 offset:24576
  s_waitcnt lgkmcnt(4) vmcnt(61)
  v_mfma_f32_16x16x32_bf16 v[0:3], v[72:75], a[32:35], v[0:3]
  buffer_load_dwordx4 v80, s[4:7], s30 offen offset:1024 sc1 lds
  v_mfma_f32_16x16x32_bf16 v[4:7], v[76:79], a[32:35], v[4:7]
  v_mfma_f32_16x16x32_bf16 v[8:11], v[72:75], a[88:91], v[8:11]
  v_mfma_f32_16x16x32_bf16 v[12:15], v[76:79], a[88:91], v[12:15]
  v_mfma_f32_16x16x32_bf16 v[16:19], v[72:75], a[144:147], v[16:19]
  v_mfma_f32_16x16x32_bf16 v[20:23], v[76:79], a[144:147], v[20:23]
  v_mfma_f32_16x16x32_bf16 v[24:27], v[72:75], a[200:203], v[24:27]
  v_mfma_f32_16x16x32_bf16 v[28:31], v[76:79], a[200:203], v[28:31]
  v_mfma_f32_16x16x32_bf16 v[32:35], v[72:75], v[120:123], v[32:35]
  v_mfma_f32_16x16x32_bf16 v[36:39], v[76:79], v[120:123], v[36:39]
  v_mfma_f32_16x16x32_bf16 v[40:43], v[72:75], v[176:179], v[40:43]
  v_mfma_f32_16x16x32_bf16 v[44:47], v[76:79], v[176:179], v[44:47]
  v_mfma_f32_16x16x32_bf16 v[48:51], v[72:75], v[232:235], v[48:51]
  v_mfma_f32_16x16x32_bf16 v[52:55], v[76:79], v[232:235], v[52:55]
  ds_read_b128 v[72:75], v81 offset:4096
  ds_read_b128 v[76:79], v81 offset:18432
  s_waitcnt lgkmcnt(4) vmcnt(55)
  v_mfma_f32_16x16x32_bf16 v[0:3], v[56:59], a[36:39], v[0:3]
  buffer_load_dwordx4 v80, s[4:7], s30 offen offset:2048 sc1 lds
  v_mfma_f32_16x16x32_bf16 v[4:7], v[60:63], a[36:39], v[4:7]
  v_mfma_f32_16x16x32_bf16 v[8:11], v[56:59], a[92:95], v[8:11]
  v_mfma_f32_16x16x32_bf16 v[12:15], v[60:63], a[92:95], v[12:15]
  v_mfma_f32_16x16x32_bf16 v[16:19], v[56:59], a[148:151], v[16:19]
  v_mfma_f32_16x16x32_bf16 v[20:23], v[60:63], a[148:151], v[20:23]
  v_mfma_f32_16x16x32_bf16 v[24:27], v[56:59], a[204:207], v[24:27]
  v_mfma_f32_16x16x32_bf16 v[28:31], v[60:63], a[204:207], v[28:31]
  v_mfma_f32_16x16x32_bf16 v[32:35], v[56:59], v[124:127], v[32:35]
  v_mfma_f32_16x16x32_bf16 v[36:39], v[60:63], v[124:127], v[36:39]
  v_mfma_f32_16x16x32_bf16 v[40:43], v[56:59], v[180:183], v[40:43]
  v_mfma_f32_16x16x32_bf16 v[44:47], v[60:63], v[180:183], v[44:47]
  v_mfma_f32_16x16x32_bf16 v[48:51], v[56:59], v[236:239], v[48:51]
  v_mfma_f32_16x16x32_bf16 v[52:55], v[60:63], v[236:239], v[52:55]
  ds_read_b128 v[56:59], v81 offset:5120
  ds_read_b128 v[60:63], v81 offset:19456
  s_waitcnt lgkmcnt(4) vmcnt(49)
  v_mfma_f32_16x16x32_bf16 v[0:3], v[64:67], a[40:43], v[0:3]
  v_mfma_f32_16x16x32_bf16 v[4:7], v[68:71], a[40:43], v[4:7]
  v_mfma_f32_16x16x32_bf16 v[8:11], v[64:67], a[96:99], v[8:11]
  v_mfma_f32_16x16x32_bf16 v[12:15], v[68:71], a[96:99], v[12:15]
  v_mfma_f32_16x16x32_bf16 v[16:19], v[64:67], a[152:155], v[16:19]
  v_mfma_f32_16x16x32_bf16 v[20:23], v[68:71], a[152:155], v[20:23]
  v_mfma_f32_16x16x32_bf16 v[24:27], v[64:67], a[208:211], v[24:27]
  v_mfma_f32_16x16x32_bf16 v[28:31], v[68:71], a[208:211], v[28:31]
  v_mfma_f32_16x16x32_bf16 v[32:35], v[64:67], v[128:131], v[32:35]
  v_mfma_f32_16x16x32_bf16 v[36:39], v[68:71], v[128:131], v[36:39]
  v_mfma_f32_16x16x32_bf16 v[40:43], v[64:67], v[184:187], v[40:43]
  v_mfma_f32_16x16x32_bf16 v[44:47], v[68:71], v[184:187], v[44:47]
  v_mfma_f32_16x16x32_bf16 v[48:51], v[64:67], v[240:243], v[48:51]
  v_mfma_f32_16x16x32_bf16 v[52:55], v[68:71], v[240:243], v[52:55]
  ds_read_b128 v[64:67], v81 offset:6144
  ds_read_b128 v[68:71], v81 offset:20480
  s_waitcnt lgkmcnt(4) vmcnt(42)
  v_mfma_f32_16x16x32_bf16 v[0:3], v[72:75], a[16:19], v[0:3]
  v_mfma_f32_16x16x32_bf16 v[4:7], v[76:79], a[16:19], v[4:7]
  v_mfma_f32_16x16x32_bf16 v[8:11], v[72:75], a[72:75], v[8:11]
  v_mfma_f32_16x16x32_bf16 v[12:15], v[76:79], a[72:75], v[12:15]
  v_mfma_f32_16x16x32_bf16 v[16:19], v[72:75], a[128:131], v[16:19]
  v_mfma_f32_16x16x32_bf16 v[20:23], v[76:79], a[128:131], v[20:23]
  v_mfma_f32_16x16x32_bf16 v[24:27], v[72:75], a[184:187], v[24:27]
  v_mfma_f32_16x16x32_bf16 v[28:31], v[76:79], a[184:187], v[28:31]
  v_mfma_f32_16x16x32_bf16 v[32:35], v[72:75], a[240:243], v[32:35]
  v_mfma_f32_16x16x32_bf16 v[36:39], v[76:79], a[240:243], v[36:39]
  v_mfma_f32_16x16x32_bf16 v[40:43], v[72:75], v[160:163], v[40:43]
  v_mfma_f32_16x16x32_bf16 v[44:47], v[76:79], v[160:163], v[44:47]
  v_mfma_f32_16x16x32_bf16 v[48:51], v[72:75], v[216:219], v[48:51]
  v_mfma_f32_16x16x32_bf16 v[52:55], v[76:79], v[216:219], v[52:55]
  ds_read_b128 v[72:75], v81 offset:11264
  ds_read_b128 v[76:79], v81 offset:25600
  s_waitcnt lgkmcnt(4) vmcnt(35)
  v_mfma_f32_16x16x32_bf16 v[0:3], v[56:59], a[20:23], v[0:3]
  v_mfma_f32_16x16x32_bf16 v[4:7], v[60:63], a[20:23], v[4:7]
  v_mfma_f32_16x16x32_bf16 v[8:11], v[56:59], a[76:79], v[8:11]
  v_mfma_f32_16x16x32_bf16 v[12:15], v[60:63], a[76:79], v[12:15]
  v_mfma_f32_16x16x32_bf16 v[16:19], v[56:59], a[132:135], v[16:19]
  v_mfma_f32_16x16x32_bf16 v[20:23], v[60:63], a[132:135], v[20:23]
  v_mfma_f32_16x16x32_bf16 v[24:27], v[56:59], a[188:191], v[24:27]
  v_mfma_f32_16x16x32_bf16 v[28:31], v[60:63], a[188:191], v[28:31]
  v_mfma_f32_16x16x32_bf16 v[32:35], v[56:59], a[244:247], v[32:35]
  v_mfma_f32_16x16x32_bf16 v[36:39], v[60:63], a[244:247], v[36:39]
  v_mfma_f32_16x16x32_bf16 v[40:43], v[56:59], v[164:167], v[40:43]
  v_mfma_f32_16x16x32_bf16 v[44:47], v[60:63], v[164:167], v[44:47]
  v_mfma_f32_16x16x32_bf16 v[48:51], v[56:59], v[220:223], v[48:51]
  v_mfma_f32_16x16x32_bf16 v[52:55], v[60:63], v[220:223], v[52:55]
  ds_read_b128 v[56:59], v81 offset:12288
  ds_read_b128 v[60:63], v81 offset:26624
  s_waitcnt lgkmcnt(4) vmcnt(28)
  v_mfma_f32_16x16x32_bf16 v[0:3], v[64:67], a[24:27], v[0:3]
  v_mfma_f32_16x16x32_bf16 v[4:7], v[68:71], a[24:27], v[4:7]
  v_mfma_f32_16x16x32_bf16 v[8:11], v[64:67], a[80:83], v[8:11]
  v_mfma_f32_16x16x32_bf16 v[12:15], v[68:71], a[80:83], v[12:15]
  v_mfma_f32_16x16x32_bf16 v[16:19], v[64:67], a[136:139], v[16:19]
  v_mfma_f32_16x16x32_bf16 v[20:23], v[68:71], a[136:139], v[20:23]
  v_mfma_f32_16x16x32_bf16 v[24:27], v[64:67], a[192:195], v[24:27]
  v_mfma_f32_16x16x32_bf16 v[28:31], v[68:71], a[192:195], v[28:31]
  v_mfma_f32_16x16x32_bf16 v[32:35], v[64:67], a[248:251], v[32:35]
  v_mfma_f32_16x16x32_bf16 v[36:39], v[68:71], a[248:251], v[36:39]
  v_mfma_f32_16x16x32_bf16 v[40:43], v[64:67], v[168:171], v[40:43]
  v_mfma_f32_16x16x32_bf16 v[44:47], v[68:71], v[168:171], v[44:47]
  v_mfma_f32_16x16x32_bf16 v[48:51], v[64:67], v[224:227], v[48:51]
  v_mfma_f32_16x16x32_bf16 v[52:55], v[68:71], v[224:227], v[52:55]
  ds_read_b128 v[64:67], v81 offset:13312
  ds_read_b128 v[68:71], v81 offset:27648
  s_waitcnt lgkmcnt(4) vmcnt(21)
  v_mfma_f32_16x16x32_bf16 v[0:3], v[72:75], a[44:47], v[0:3]
  v_mfma_f32_16x16x32_bf16 v[4:7], v[76:79], a[44:47], v[4:7]
  v_mfma_f32_16x16x32_bf16 v[8:11], v[72:75], a[100:103], v[8:11]
  v_mfma_f32_16x16x32_bf16 v[12:15], v[76:79], a[100:103], v[12:15]
  v_mfma_f32_16x16x32_bf16 v[16:19], v[72:75], a[156:159], v[16:19]
  v_mfma_f32_16x16x32_bf16 v[20:23], v[76:79], a[156:159], v[20:23]
  v_mfma_f32_16x16x32_bf16 v[24:27], v[72:75], a[212:215], v[24:27]
  v_mfma_f32_16x16x32_bf16 v[28:31], v[76:79], a[212:215], v[28:31]
  v_mfma_f32_16x16x32_bf16 v[32:35], v[72:75], v[132:135], v[32:35]
  v_mfma_f32_16x16x32_bf16 v[36:39], v[76:79], v[132:135], v[36:39]
  v_mfma_f32_16x16x32_bf16 v[40:43], v[72:75], v[188:191], v[40:43]
  v_mfma_f32_16x16x32_bf16 v[44:47], v[76:79], v[188:191], v[44:47]
  v_mfma_f32_16x16x32_bf16 v[48:51], v[72:75], v[244:247], v[48:51]
  v_mfma_f32_16x16x32_bf16 v[52:55], v[76:79], v[244:247], v[52:55]
  s_waitcnt lgkmcnt(2) vmcnt(14)
  v_mfma_f32_16x16x32_bf16 v[0:3], v[56:59], a[48:51], v[0:3]
  v_mfma_f32_16x16x32_bf16 v[4:7], v[60:63], a[48:51], v[4:7]
  v_mfma_f32_16x16x32_bf16 v[8:11], v[56:59], a[104:107], v[8:11]
  v_mfma_f32_16x16x32_bf16 v[12:15], v[60:63], a[104:107], v[12:15]
  v_mfma_f32_16x16x32_bf16 v[16:19], v[56:59], a[160:163], v[16:19]
  v_mfma_f32_16x16x32_bf16 v[20:23], v[60:63], a[160:163], v[20:23]
  v_mfma_f32_16x16x32_bf16 v[24:27], v[56:59], a[216:219], v[24:27]
  v_mfma_f32_16x16x32_bf16 v[28:31], v[60:63], a[216:219], v[28:31]
  v_mfma_f32_16x16x32_bf16 v[32:35], v[56:59], v[136:139], v[32:35]
  v_mfma_f32_16x16x32_bf16 v[36:39], v[60:63], v[136:139], v[36:39]
  v_mfma_f32_16x16x32_bf16 v[40:43], v[56:59], v[192:195], v[40:43]
  v_mfma_f32_16x16x32_bf16 v[44:47], v[60:63], v[192:195], v[44:47]
  v_mfma_f32_16x16x32_bf16 v[48:51], v[56:59], v[248:251], v[48:51]
  v_mfma_f32_16x16x32_bf16 v[52:55], v[60:63], v[248:251], v[52:55]
  s_waitcnt lgkmcnt(0) vmcnt(7)
  v_mfma_f32_16x16x32_bf16 v[0:3], v[64:67], a[52:55], v[0:3]
  s_waitcnt vmcnt(7)
  buffer_store_dwordx2 v[84:85], v86, s[4:7], s22 offen sc1
  v_mfma_f32_16x16x32_bf16 v[4:7], v[68:71], a[52:55], v[4:7]
  v_mfma_f32_16x16x32_bf16 v[8:11], v[64:67], a[108:111], v[8:11]
  v_mfma_f32_16x16x32_bf16 v[12:15], v[68:71], a[108:111], v[12:15]
  v_mfma_f32_16x16x32_bf16 v[16:19], v[64:67], a[164:167], v[16:19]
  v_mfma_f32_16x16x32_bf16 v[20:23], v[68:71], a[164:167], v[20:23]
  v_mfma_f32_16x16x32_bf16 v[24:27], v[64:67], a[220:223], v[24:27]
  v_mfma_f32_16x16x32_bf16 v[28:31], v[68:71], a[220:223], v[28:31]
  v_mfma_f32_16x16x32_bf16 v[32:35], v[64:67], v[140:143], v[32:35]
  v_mfma_f32_16x16x32_bf16 v[36:39], v[68:71], v[140:143], v[36:39]
  v_mfma_f32_16x16x32_bf16 v[40:43], v[64:67], v[196:199], v[40:43]
  v_mfma_f32_16x16x32_bf16 v[44:47], v[68:71], v[196:199], v[44:47]
  v_mfma_f32_16x16x32_bf16 v[48:51], v[64:67], v[252:255], v[48:51]
  v_mfma_f32_16x16x32_bf16 v[52:55], v[68:71], v[252:255], v[52:55]
  s_cmp_ge_u32 s19, 28672
  s_cselect_b32 s31, 28672, 0
  v_add_u32 v81, s31, v80
  s_add_u32 s30, s20, 4096
  v_cvt_pk_bf16_f32 v0, v0, v1
  v_cvt_pk_bf16_f32 v1, v2, v3
  v_cvt_pk_bf16_f32 v2, v4, v5
  v_cvt_pk_bf16_f32 v3, v6, v7
  buffer_store_dwordx4 v[0:3], v80, s[4:7], s20 offen offset:0 sc1
  v_cvt_pk_bf16_f32 v8, v8, v9
  v_cvt_pk_bf16_f32 v9, v10, v11
  v_cvt_pk_bf16_f32 v10, v12, v13
  v_cvt_pk_bf16_f32 v11, v14, v15
  buffer_store_dwordx4 v[8:11], v80, s[4:7], s20 offen offset:1024 sc1
  v_cvt_pk_bf16_f32 v16, v16, v17
  v_cvt_pk_bf16_f32 v17, v18, v19
  v_cvt_pk_bf16_f32 v18, v20, v21
  v_cvt_pk_bf16_f32 v19, v22, v23
  buffer_store_dwordx4 v[16:19], v80, s[4:7], s20 offen offset:2048 sc1
  v_cvt_pk_bf16_f32 v24, v24, v25
  v_cvt_pk_bf16_f32 v25, v26, v27
  v_cvt_pk_bf16_f32 v26, v28, v29
  v_cvt_pk_bf16_f32 v27, v30, v31
  buffer_store_dwordx4 v[24:27], v80, s[4:7], s20 offen offset:3072 sc1
  v_cvt_pk_bf16_f32 v32, v32, v33
  v_cvt_pk_bf16_f32 v33, v34, v35
  v_cvt_pk_bf16_f32 v34, v36, v37
  v_cvt_pk_bf16_f32 v35, v38, v39
  buffer_store_dwordx4 v[32:35], v80, s[4:7], s30 offen offset:0 sc1
  v_cvt_pk_bf16_f32 v40, v40, v41
  v_cvt_pk_bf16_f32 v41, v42, v43
  v_cvt_pk_bf16_f32 v42, v44, v45
  v_cvt_pk_bf16_f32 v43, v46, v47
  buffer_store_dwordx4 v[40:43], v80, s[4:7], s30 offen offset:1024 sc1
  v_cvt_pk_bf16_f32 v48, v48, v49
  v_cvt_pk_bf16_f32 v49, v50, v51
  v_cvt_pk_bf16_f32 v50, v52, v53
  v_cvt_pk_bf16_f32 v51, v54, v55
  buffer_store_dwordx4 v[48:51], v80, s[4:7], s30 offen offset:2048 sc1
  s_mov_b32 s22, s21
  s_cmp_lt_u32 s17, 6
  s_cbranch_scc0 L_vwnf_51
  s_waitcnt vmcnt(0)
  buffer_store_dwordx2 v[84:85], v86, s[4:7], s22 offen sc1
  s_cmp_lt_u32 s17, 2
  s_cbranch_scc0 L_vwnf_51
  s_mov_b32 s28, 0
  s_mov_b32 s29, 68173824
  s_branch L_wl0_53
L_wl_52:
  s_sleep 2
L_wl0_53:
  buffer_load_dwordx4 v[88:91], v80, s[4:7], s29 offen offset:0 sc1
  buffer_load_dwordx4 v[92:95], v80, s[4:7], s29 offen offset:1024 sc1
  s_add_u32 s28, s28, 1
  s_cmp_gt_u32 s28, 2000000
  s_cbranch_scc1 L_fail
  s_waitcnt vmcnt(0)
  v_xor_b32 v88, s12, v88
  v_xor_b32 v89, s13, v89
  v_xor_b32 v90, s12, v90
  v_xor_b32 v91, s13, v91
  v_xor_b32 v92, s12, v92
  v_xor_b32 v93, s13, v93
  v_xor_b32 v94, s12, v94
  v_xor_b32 v95, s13, v95
  v_or_b32 v88, v88, v89
  v_or3_b32 v88, v88, v90, v91
  v_or3_b32 v88, v88, v92, v93
  v_or3_b32 v88, v88, v94, v95
  v_cmp_ne_u32 vcc, 0, v88
  s_cbranch_vccnz L_wl_52
L_vwnf_51:
  s_add_u32 s21, s21, 1024
  s_add_u32 s20, s20, 917504
  s_add_u32 s17, s17, 2
  s_cmp_lt_u32 s17, 64
  s_cbranch_scc1 L_vw_50
  s_waitcnt vmcnt(0)
  buffer_store_dwordx2 v[84:85], v86, s[4:7], s22 offen sc1
  s_branch L_fin_20
L_GU_37:
  s_sub_u32 s9, s9, 32
  s_mul_i32 s17, s9, 4682
  s_lshr_b32 s17, s17, 16
  s_mul_i32 s30, s17, 14
  s_sub_u32 s16, s9, s30
  s_load_dwordx2 s[32:33], s[0:1], 64
  s_waitcnt lgkmcnt(0)
  s_and_b32 s33, s33, 0xffff
  s_mov_b32 s34, 1605632
  s_mov_b32 s35, 0x20000
  s_load_dwordx2 s[36:37], s[0:1], 72
  s_waitcnt lgkmcnt(0)
  s_and_b32 s37, s37, 0xffff
  s_mov_b32 s38, 1605632
  s_mov_b32 s39, 0x20000
  v_mbcnt_lo_u32_b32 v59, -1, 0
  v_mbcnt_hi_u32_b32 v59, -1, v59
  v_lshlrev_b32 v56, 4, v59
  v_lshlrev_b32 v58, 3, v59
  v_mov_b32 v60, s12
  v_mov_b32 v61, s13
  v_cmp_eq_u32 vcc, 0, v59
  v_mov_b32 v62, 0x80000000
  s_nop 0
  v_cndmask_b32 v62, v62, 0, vcc
  v_lshrrev_b32 v76, 4, v59
  v_mul_u32_u24 v77, 3584, v76
  v_and_b32 v76, 1, v76
  v_lshlrev_b32 v76, 1, v76
  v_and_b32 v78, 15, v59
  v_xor_b32 v76, v76, v78
  v_xor_b32 v78, 0, v76
  v_lshl_add_u32 v68, v78, 4, v77
  v_xor_b32 v78, 4, v76
  v_lshl_add_u32 v69, v78, 4, v77
  v_xor_b32 v78, 8, v76
  v_lshl_add_u32 v70, v78, 4, v77
  v_xor_b32 v78, 12, v76
  v_lshl_add_u32 v71, v78, 4, v77
  v_and_b32 v79, 15, v59
  v_lshrrev_b32 v80, 4, v59
  v_lshrrev_b32 v76, 1, v80
  v_lshlrev_b32 v76, 4, v76
  v_and_b32 v80, 1, v80
  v_lshlrev_b32 v80, 2, v80
  v_and_b32 v77, 8, v79
  v_or_b32 v80, v80, v77
  v_bfe_u32 v77, v79, 2, 1
  v_add3_u32 v76, v76, v80, v77
  v_lshl_add_u32 v80, v77, 1, v80
  v_lshlrev_b32 v76, 8, v76
  v_and_b32 v77, 1, v79
  v_lshl_add_u32 v76, v77, 3, v76
  v_add_u32 v76, 57344, v76
  v_bfe_u32 v77, v79, 1, 1
  s_lshl_b32 s30, s8, 2
  v_or_b32 v77, s30, v77
  v_xor_b32 v77, v77, v80
  v_lshl_add_u32 v72, v77, 4, v76
  v_xor_b32 v77, 2, v77
  v_lshl_add_u32 v73, v77, 4, v76
  v_add_u32 v74, 0x8000, v72
  v_add_u32 v75, 0x8000, v73
  s_mul_i32 s20, s8, 57344
  s_lshl_b32 s31, s16, 8
  s_add_u32 s20, s20, s31
  s_lshl_b32 s21, s8, 12
  s_add_u32 s21, s21, 57344
  s_mov_b32 s29, 68192256
  s_mov_b32 s28, 0
  s_branch L_wf0_55
L_wf_54:
  s_sleep 8
L_wf0_55:
  buffer_load_dwordx2 v[0:1], v58, s[4:7], s29 offen offset:0 sc1
  s_add_u32 s28, s28, 1
  s_cmp_gt_u32 s28, 2000000
  s_cbranch_scc1 L_fail
  s_waitcnt vmcnt(0)
  v_xor_b32 v0, s12, v0
  v_xor_b32 v1, s13, v1
  v_or_b32 v0, v0, v1
  v_cmp_ne_u32 vcc, 0, v0
  s_cbranch_vccnz L_wf_54
  s_add_u32 m0, s21, 0
  s_add_u32 s30, s20, 0
  buffer_load_dwordx4 v68, s[32:35], s30 offen nt lds
  s_add_u32 m0, s21, 1024
  s_add_u32 s30, s20, 14336
  buffer_load_dwordx4 v69, s[32:35], s30 offen nt lds
  s_add_u32 m0, s21, 2048
  s_add_u32 s30, s20, 28672
  buffer_load_dwordx4 v70, s[32:35], s30 offen nt lds
  s_add_u32 m0, s21, 3072
  s_add_u32 s30, s20, 43008
  buffer_load_dwordx4 v71, s[32:35], s30 offen nt lds
  s_add_u32 m0, s21, 16384
  s_add_u32 s30, s20, 0
  buffer_load_dwordx4 v68, s[36:39], s30 offen nt lds
  s_add_u32 m0, s21, 17408
  s_add_u32 s30, s20, 14336
  buffer_load_dwordx4 v69, s[36:39], s30 offen nt lds
  s_add_u32 m0, s21, 18432
  s_add_u32 s30, s20, 28672
  buffer_load_dwordx4 v70, s[36:39], s30 offen nt lds
  s_add_u32 m0, s21, 19456
  s_add_u32 s30, s20, 43008
  buffer_load_dwordx4 v71, s[36:39], s30 offen nt lds
  s_waitcnt vmcnt(0) lgkmcnt(0)
  s_barrier
  s_add_u32 m0, s21, 32768
  s_add_u32 s30, s20, 229376
  buffer_load_dwordx4 v68, s[32:35], s30 offen nt lds
  s_add_u32 m0, s21, 33792
  s_add_u32 s30, s20, 243712
  buffer_load_dwordx4 v69, s[32:35], s30 offen nt lds
  s_add_u32 m0, s21, 34816
  s_add_u32 s30, s20, 258048
  buffer_load_dwordx4 v70, s[32:35], s30 offen nt lds
  s_add_u32 m0, s21, 35840
  s_add_u32 s30, s20, 272384
  buffer_load_dwordx4 v71, s[32:35], s30 offen nt lds
  s_add_u32 m0, s21, 49152
  s_add_u32 s30, s20, 229376
  buffer_load_dwordx4 v68, s[36:39], s30 offen nt lds
  s_add_u32 m0, s21, 50176
  s_add_u32 s30, s20, 243712
  buffer_load_dwordx4 v69, s[36:39], s30 offen nt lds
  s_add_u32 m0, s21, 51200
  s_add_u32 s30, s20, 258048
  buffer_load_dwordx4 v70, s[36:39], s30 offen nt lds
  s_add_u32 m0, s21, 52224
  s_add_u32 s30, s20, 272384
  buffer_load_dwordx4 v71, s[36:39], s30 offen nt lds
  ds_read_b64_tr_b16 a[0:1], v72 offset:0
  ds_read_b64_tr_b16 a[2:3], v72 offset:512
  ds_read_b64_tr_b16 a[56:57], v73 offset:0
  ds_read_b64_tr_b16 a[58:59], v73 offset:512
  ds_read_b64_tr_b16 a[112:113], v72 offset:16384
  ds_read_b64_tr_b16 a[114:115], v72 offset:16896
  ds_read_b64_tr_b16 a[168:169], v73 offset:16384
  ds_read_b64_tr_b16 a[170:171], v73 offset:16896
  ds_read_b64_tr_b16 a[4:5], v72 offset:8192
  ds_read_b64_tr_b16 a[6:7], v72 offset:8704
  ds_read_b64_tr_b16 a[60:61], v73 offset:8192
  ds_read_b64_tr_b16 a[62:63], v73 offset:8704
  ds_read_b64_tr_b16 a[116:117], v72 offset:24576
  ds_read_b64_tr_b16 a[118:119], v72 offset:25088
  ds_read_b64_tr_b16 a[172:173], v73 offset:24576
  ds_read_b64_tr_b16 a[174:175], v73 offset:25088
  s_waitcnt vmcnt(0) lgkmcnt(0)
  s_barrier
  s_add_u32 m0, s21, 0
  s_add_u32 s30, s20, 458752
  buffer_load_dwordx4 v68, s[32:35], s30 offen nt lds
  s_add_u32 m0, s21, 1024
  s_add_u32 s30, s20, 473088
  buffer_load_dwordx4 v69, s[32:35], s30 offen nt lds
  s_add_u32 m0, s21, 2048
  s_add_u32 s30, s20, 487424
  buffer_load_dwordx4 v70, s[32:35], s30 offen nt lds
  s_add_u32 m0, s21, 3072
  s_add_u32 s30, s20, 501760
  buffer_load_dwordx4 v71, s[32:35], s30 offen nt lds
  s_add_u32 m0, s21, 16384
  s_add_u32 s30, s20, 458752
  buffer_load_dwordx4 v68, s[36:39], s30 offen nt lds
  s_add_u32 m0, s21, 17408
  s_add_u32 s30, s20, 473088
  buffer_load_dwordx4 v69, s[36:39], s30 offen nt lds
  s_add_u32 m0, s21, 18432
  s_add_u32 s30, s20, 487424
  buffer_load_dwordx4 v70, s[36:39], s30 offen nt lds
  s_add_u32 m0, s21, 19456
  s_add_u32 s30, s20, 501760
  buffer_load_dwordx4 v71, s[36:39], s30 offen nt lds
  ds_read_b64_tr_b16 a[8:9], v74 offset:0
  ds_read_b64_tr_b16 a[10:11], v74 offset:512
  ds_read_b64_tr_b16 a[64:65], v75 offset:0
  ds_read_b64_tr_b16 a[66:67], v75 offset:512
  ds_read_b64_tr_b16 a[120:121], v74 offset:16384
  ds_read_b64_tr_b16 a[122:123], v74 offset:16896
  ds_read_b64_tr_b16 a[176:177], v75 offset:16384
  ds_read_b64_tr_b16 a[178:179], v75 offset:16896
  ds_read_b64_tr_b16 a[12:13], v74 offset:8192
  ds_read_b64_tr_b16 a[14:15], v74 offset:8704
  ds_read_b64_tr_b16 a[68:69], v75 offset:8192
  ds_read_b64_tr_b16 a[70:71], v75 offset:8704
  ds_read_b64_tr_b16 a[124:125], v74 offset:24576
  ds_read_b64_tr_b16 a[126:127], v74 offset:25088
  ds_read_b64_tr_b16 a[180:181], v75 offset:24576
  ds_read_b64_tr_b16 a[182:183], v75 offset:25088
  s_waitcnt vmcnt(0) lgkmcnt(0)
  s_barrier
  s_add_u32 m0, s21, 32768
  s_add_u32 s30, s20, 688128
  buffer_load_dwordx4 v68, s[32:35], s30 offen nt lds
  s_add_u32 m0, s21, 33792
  s_add_u32 s30, s20, 702464
  buffer_load_dwordx4 v69, s[32:35], s30 offen nt lds
  s_add_u32 m0, s21, 34816
  s_add_u32 s30, s20, 716800
  buffer_load_dwordx4 v70, s[32:35], s30 offen nt lds
  s_add_u32 m0, s21, 35840
  s_add_u32 s30, s20, 731136
  buffer_load_dwordx4 v71, s[32:35], s30 offen nt lds
  s_add_u32 m0, s21, 49152
  s_add_u32 s30, s20, 688128
  buffer_load_dwordx4 v68, s[36:39], s30 offen nt lds
  s_add_u32 m0, s21, 50176
  s_add_u32 s30, s20, 702464
  buffer_load_dwordx4 v69, s[36:39], s30 offen nt lds
  s_add_u32 m0, s21, 51200
  s_add_u32 s30, s20, 716800
  buffer_load_dwordx4 v70, s[36:39], s30 offen nt lds
  s_add_u32 m0, s21, 52224
  s_add_u32 s30, s20, 731136
  buffer_load_dwordx4 v71, s[36:39], s30 offen nt lds
  ds_read_b64_tr_b16 a[16:17], v72 offset:0
  ds_read_b64_tr_b16 a[18:19], v72 offset:512
  ds_read_b64_tr_b16 a[72:73], v73 offset:0
  ds_read_b64_tr_b16 a[74:75], v73 offset:512
  ds_read_b64_tr_b16 a[128:129], v72 offset:16384
  ds_read_b64_tr_b16 a[130:131], v72 offset:16896
  ds_read_b64_tr_b16 a[184:185], v73 offset:16384
  ds_read_b64_tr_b16 a[186:187], v73 offset:16896
  ds_read_b64_tr_b16 a[20:21], v72 offset:8192
  ds_read_b64_tr_b16 a[22:23], v72 offset:8704
  ds_read_b64_tr_b16 a[76:77], v73 offset:8192
  ds_read_b64_tr_b16 a[78:79], v73 offset:8704
  ds_read_b64_tr_b16 a[132:133], v72 offset:24576
  ds_read_b64_tr_b16 a[134:135], v72 offset:25088
  ds_read_b64_tr_b16 a[188:189], v73 offset:24576
  ds_read_b64_tr_b16 a[190:191], v73 offset:25088
  s_waitcnt vmcnt(0) lgkmcnt(0)
  s_barrier
  s_add_u32 m0, s21, 0
  s_add_u32 s30, s20, 917504
  buffer_load_dwordx4 v68, s[32:35], s30 offen nt lds
  s_add_u32 m0, s21, 1024
  s_add_u32 s30, s20, 931840
  buffer_load_dwordx4 v69, s[32:35], s30 offen nt lds
  s_add_u32 m0, s21, 2048
  s_add_u32 s30, s20, 946176
  buffer_load_dwordx4 v70, s[32:35], s30 offen nt lds
  s_add_u32 m0, s21, 3072
  s_add_u32 s30, s20, 960512
  buffer_load_dwordx4 v71, s[32:35], s30 offen nt lds
  s_add_u32 m0, s21, 16384
  s_add_u32 s30, s20, 917504
  buffer_load_dwordx4 v68, s[36:39], s30 offen nt lds
  s_add_u32 m0, s21, 17408
  s_add_u32 s30, s20, 931840
  buffer_load_dwordx4 v69, s[36:39], s30 offen nt lds
  s_add_u32 m0, s21, 18432
  s_add_u32 s30, s20, 946176
  buffer_load_dwordx4 v70, s[36:39], s30 offen nt lds
  s_add_u32 m0, s21, 19456
  s_add_u32 s30, s20, 960512
  buffer_load_dwordx4 v71, s[36:39], s30 offen nt lds
  ds_read_b64_tr_b16 a[24:25], v74 offset:0
  ds_read_b64_tr_b16 a[26:27], v74 offset:512
  ds_read_b64_tr_b16 a[80:81], v75 offset:0
  ds_read_b64_tr_b16 a[82:83], v75 offset:512
  ds_read_b64_tr_b16 a[136:137], v74 offset:16384
  ds_read_b64_tr_b16 a[138:139], v74 offset:16896
  ds_read_b64_tr_b16 a[192:193], v75 offset:16384
  ds_read_b64_tr_b16 a[194:195], v75 offset:16896
  ds_read_b64_tr_b16 a[28:29], v74 offset:8192
  ds_read_b64_tr_b16 a[30:31], v74 offset:8704
  ds_read_b64_tr_b16 a[84:85], v75 offset:8192
  ds_read_b64_tr_b16 a[86:87], v75 offset:8704
  ds_read_b64_tr_b16 a[140:141], v74 offset:24576
  ds_read_b64_tr_b16 a[142:143], v74 offset:25088
  ds_read_b64_tr_b16 a[196:197], v75 offset:24576
  ds_read_b64_tr_b16 a[198:199], v75 offset:25088
  s_waitcnt vmcnt(0) lgkmcnt(0)
  s_barrier
  s_add_u32 m0, s21, 32768
  s_add_u32 s30, s20, 1146880
  buffer_load_dwordx4 v68, s[32:35], s30 offen nt lds
  s_add_u32 m0, s21, 33792
  s_add_u32 s30, s20, 1161216
  buffer_load_dwordx4 v69, s[32:35], s30 offen nt lds
  s_add_u32 m0, s21, 34816
  s_add_u32 s30, s20, 1175552
  buffer_load_dwordx4 v70, s[32:35], s30 offen nt lds
  s_add_u32 m0, s21, 35840
  s_add_u32 s30, s20, 1189888
  buffer_load_dwordx4 v71, s[32:35], s30 offen nt lds
  s_add_u32 m0, s21, 49152
  s_add_u32 s30, s20, 1146880
  buffer_load_dwordx4 v68, s[36:39], s30 offen nt lds
  s_add_u32 m0, s21, 50176
  s_add_u32 s30, s20, 1161216
  buffer_load_dwordx4 v69, s[36:39], s30 offen nt lds
  s_add_u32 m0, s21, 51200
  s_add_u32 s30, s20, 1175552
  buffer_load_dwordx4 v70, s[36:39], s30 offen nt lds
  s_add_u32 m0, s21, 52224
  s_add_u32 s30, s20, 1189888
  buffer_load_dwordx4 v71, s[36:39], s30 offen nt lds
  ds_read_b64_tr_b16 a[32:33], v72 offset:0
  ds_read_b64_tr_b16 a[34:35], v72 offset:512
  ds_read_b64_tr_b16 a[88:89], v73 offset:0
  ds_read_b64_tr_b16 a[90:91], v73 offset:512
  ds_read_b64_tr_b16 a[144:145], v72 offset:16384
  ds_read_b64_tr_b16 a[146:147], v72 offset:16896
  ds_read_b64_tr_b16 a[200:201], v73 offset:16384
  ds_read_b64_tr_b16 a[202:203], v73 offset:16896
  ds_read_b64_tr_b16 a[36:37], v72 offset:8192
  ds_read_b64_tr_b16 a[38:39], v72 offset:8704
  ds_read_b64_tr_b16 a[92:93], v73 offset:8192
  ds_read_b64_tr_b16 a[94:95], v73 offset:8704
  ds_read_b64_tr_b16 a[148:149], v72 offset:24576
  ds_read_b64_tr_b16 a[150:151], v72 offset:25088
  ds_read_b64_tr_b16 a[204:205], v73 offset:24576
  ds_read_b64_tr_b16 a[206:207], v73 offset:25088
  s_waitcnt vmcnt(0) lgkmcnt(0)
  s_barrier
  s_add_u32 m0, s21, 0
  s_add_u32 s30, s20, 1376256
  buffer_load_dwordx4 v68, s[32:35], s30 offen nt lds
  s_add_u32 m0, s21, 1024
  s_add_u32 s30, s20, 1390592
  buffer_load_dwordx4 v69, s[32:35], s30 offen nt lds
  s_add_u32 m0, s21, 2048
  s_add_u32 s30, s20, 1404928
  buffer_load_dwordx4 v70, s[32:35], s30 offen nt lds
  s_add_u32 m0, s21, 3072
  s_add_u32 s30, s20, 1419264
  buffer_load_dwordx4 v71, s[32:35], s30 offen nt lds
  s_add_u32 m0, s21, 16384
  s_add_u32 s30, s20, 1376256
  buffer_load_dwordx4 v68, s[36:39], s30 offen nt lds
  s_add_u32 m0, s21, 17408
  s_add_u32 s30, s20, 1390592
  buffer_load_dwordx4 v69, s[36:39], s30 offen nt lds
  s_add_u32 m0, s21, 18432
  s_add_u32 s30, s20, 1404928
  buffer_load_dwordx4 v70, s[36:39], s30 offen nt lds
  s_add_u32 m0, s21, 19456
  s_add_u32 s30, s20, 1419264
  buffer_load_dwordx4 v71, s[36:39], s30 offen nt lds
  ds_read_b64_tr_b16 a[40:41], v74 offset:0
  ds_read_b64_tr_b16 a[42:43], v74 offset:512
  ds_read_b64_tr_b16 a[96:97], v75 offset:0
  ds_read_b64_tr_b16 a[98:99], v75 offset:512
  ds_read_b64_tr_b16 a[152:153], v74 offset:16384
  ds_read_b64_tr_b16 a[154:155], v74 offset:16896
  ds_read_b64_tr_b16 a[208:209], v75 offset:16384
  ds_read_b64_tr_b16 a[210:211], v75 offset:16896
  ds_read_b64_tr_b16 a[44:45], v74 offset:8192
  ds_read_b64_tr_b16 a[46:47], v74 offset:8704
  ds_read_b64_tr_b16 a[100:101], v75 offset:8192
  ds_read_b64_tr_b16 a[102:103], v75 offset:8704
  ds_read_b64_tr_b16 a[156:157], v74 offset:24576
  ds_read_b64_tr_b16 a[158:159], v74 offset:25088
  ds_read_b64_tr_b16 a[212:213], v75 offset:24576
  ds_read_b64_tr_b16 a[214:215], v75 offset:25088
  s_waitcnt vmcnt(0) lgkmcnt(0)
  s_barrier
  ds_read_b64_tr_b16 a[48:49], v72 offset:0
  ds_read_b64_tr_b16 a[50:51], v72 offset:512
  ds_read_b64_tr_b16 a[104:105], v73 offset:0
  ds_read_b64_tr_b16 a[106:107], v73 offset:512
  ds_read_b64_tr_b16 a[160:161], v72 offset:16384
  ds_read_b64_tr_b16 a[162:163], v72 offset:16896
  ds_read_b64_tr_b16 a[216:217], v73 offset:16384
  ds_read_b64_tr_b16 a[218:219], v73 offset:16896
  ds_read_b64_tr_b16 a[52:53], v72 offset:8192
  ds_read_b64_tr_b16 a[54:55], v72 offset:8704
  ds_read_b64_tr_b16 a[108:109], v73 offset:8192
  ds_read_b64_tr_b16 a[110:111], v73 offset:8704
  ds_read_b64_tr_b16 a[164:165], v72 offset:24576
  ds_read_b64_tr_b16 a[166:167], v72 offset:25088
  ds_read_b64_tr_b16 a[220:221], v73 offset:24576
  ds_read_b64_tr_b16 a[222:223], v73 offset:25088
  s_mov_b32 s28, 0
  s_mov_b32 s29, 68173824
  s_branch L_wl0_57
L_wl_56:
  s_sleep 2
L_wl0_57:
  buffer_load_dwordx4 v[0:3], v56, s[4:7], s29 offen offset:0 sc1
  buffer_load_dwordx4 v[4:7], v56, s[4:7], s29 offen offset:1024 sc1
  s_add_u32 s28, s28, 1
  s_cmp_gt_u32 s28, 2000000
  s_cbranch_scc1 L_fail
  s_waitcnt vmcnt(0)
  v_xor_b32 v0, s12, v0
  v_xor_b32 v1, s13, v1
  v_xor_b32 v2, s12, v2
  v_xor_b32 v3, s13, v3
  v_xor_b32 v4, s12, v4
  v_xor_b32 v5, s13, v5
  v_xor_b32 v6, s12, v6
  v_xor_b32 v7, s13, v7
  v_or_b32 v0, v0, v1
  v_or3_b32 v0, v0, v2, v3
  v_or3_b32 v0, v0, v4, v5
  v_or3_b32 v0, v0, v6, v7
  v_cmp_ne_u32 vcc, 0, v0
  s_cbranch_vccnz L_wl_56
  s_mul_i32 s30, s17, 28672
  s_mul_i32 s19, s8, 7168
  s_add_u32 s30, s30, s19
  s_add_u32 s18, s30, 14680064
  v_mov_b32 v57, v56
  s_mov_b32 m0, s19
  s_nop 0
  buffer_load_dwordx4 v56, s[4:7], s18 offen offset:0 sc1 lds
  buffer_load_dwordx4 v56, s[4:7], s18 offen offset:1024 sc1 lds
  buffer_load_dwordx4 v56, s[4:7], s18 offen offset:2048 sc1 lds
  buffer_load_dwordx4 v56, s[4:7], s18 offen offset:3072 sc1 lds
  s_add_u32 m0, s19, 4096
  s_add_u32 s30, s18, 4096
  buffer_load_dwordx4 v56, s[4:7], s30 offen offset:0 sc1 lds
  buffer_load_dwordx4 v56, s[4:7], s30 offen offset:1024 sc1 lds
  buffer_load_dwordx4 v56, s[4:7], s30 offen offset:2048 sc1 lds
  s_lshl_b32 s31, s16, 2
  s_add_u32 s31, s31, s8
  s_mul_i32 s30, s17, 56
  s_add_u32 s29, s30, s31
  s_lshl_b32 s29, s29, 3
  s_add_u32 s21, s29, 68288512
  s_lshl_b32 s30, s30, 1
  s_add_u32 s30, s30, s31
  s_lshl_b32 s30, s30, 10
  s_add_u32 s20, s30, 53477376
  s_mov_b32 s22, 0xf0000000
  s_mov_b32 s23, 3216550459
  s_mov_b32 s24, 0xffff0000
  s_waitcnt vmcnt(0) lgkmcnt(0)
L_gu_58:
  s_waitcnt vmcnt(3)
  s_barrier
  s_add_u32 s30, s17, 2
  s_add_u32 s31, s18, 57344
  s_cmp_lt_u32 s30, 64
  s_cselect_b32 s18, s31, 0xf0000000
  s_add_u32 s31, s19, 28672
  s_sub_u32 s30, s19, 28672
  s_cmp_ge_u32 s19, 28672
  s_cselect_b32 s19, s30, s31
  ds_read_b128 v[32:35], v57 offset:0
  ds_read_b128 v[36:39], v57 offset:14336
  ds_read_b128 v[40:43], v57 offset:1024
  ds_read_b128 v[44:47], v57 offset:15360
  ds_read_b128 v[48:51], v57 offset:2048
  ds_read_b128 v[52:55], v57 offset:16384
  s_waitcnt lgkmcnt(4)
  v_mfma_f32_16x16x32_bf16 v[0:3], a[0:3], v[32:35], 0
  s_mov_b32 m0, s19
  s_nop 0
  buffer_load_dwordx4 v56, s[4:7], s18 offen offset:0 sc1 lds
  v_mfma_f32_16x16x32_bf16 v[16:19], a[0:3], v[36:39], 0
  v_mfma_f32_16x16x32_bf16 v[4:7], a[56:59], v[32:35], 0
  v_mfma_f32_16x16x32_bf16 v[20:23], a[56:59], v[36:39], 0
  v_mfma_f32_16x16x32_bf16 v[8:11], a[112:115], v[32:35], 0
  v_mfma_f32_16x16x32_bf16 v[24:27], a[112:115], v[36:39], 0
  v_mfma_f32_16x16x32_bf16 v[12:15], a[168:171], v[32:35], 0
  v_mfma_f32_16x16x32_bf16 v[28:31], a[168:171], v[36:39], 0
  ds_read_b128 v[32:35], v57 offset:3072
  ds_read_b128 v[36:39], v57 offset:17408
  s_waitcnt lgkmcnt(4)
  v_mfma_f32_16x16x32_bf16 v[0:3], a[4:7], v[40:43], v[0:3]
  buffer_load_dwordx4 v56, s[4:7], s18 offen offset:1024 sc1 lds
  v_mfma_f32_16x16x32_bf16 v[16:19], a[4:7], v[44:47], v[16:19]
  v_mfma_f32_16x16x32_bf16 v[4:7], a[60:63], v[40:43], v[4:7]
  v_mfma_f32_16x16x32_bf16 v[20:23], a[60:63], v[44:47], v[20:23]
  v_mfma_f32_16x16x32_bf16 v[8:11], a[116:119], v[40:43], v[8:11]
  v_mfma_f32_16x16x32_bf16 v[24:27], a[116:119], v[44:47], v[24:27]
  v_mfma_f32_16x16x32_bf16 v[12:15], a[172:175], v[40:43], v[12:15]
  v_mfma_f32_16x16x32_bf16 v[28:31], a[172:175], v[44:47], v[28:31]
  ds_read_b128 v[40:43], v57 offset:4096
  ds_read_b128 v[44:47], v57 offset:18432
  s_waitcnt lgkmcnt(4)
  v_mfma_f32_16x16x32_bf16 v[0:3], a[8:11], v[48:51], v[0:3]
  buffer_load_dwordx4 v56, s[4:7], s18 offen offset:2048 sc1 lds
  v_mfma_f32_16x16x32_bf16 v[16:19], a[8:11], v[52:55], v[16:19]
  v_mfma_f32_16x16x32_bf16 v[4:7], a[64:67], v[48:51], v[4:7]
  v_mfma_f32_16x16x32_bf16 v[20:23], a[64:67], v[52:55], v[20:23]
  v_mfma_f32_16x16x32_bf16 v[8:11], a[120:123], v[48:51], v[8:11]
  v_mfma_f32_16x16x32_bf16 v[24:27], a[120:123], v[52:55], v[24:27]
  v_mfma_f32_16x16x32_bf16 v[12:15], a[176:179], v[48:51], v[12:15]
  v_mfma_f32_16x16x32_bf16 v[28:31], a[176:179], v[52:55], v[28:31]
  ds_read_b128 v[48:51], v57 offset:5120
  ds_read_b128 v[52:55], v57 offset:19456
  s_waitcnt lgkmcnt(4)
  v_mfma_f32_16x16x32_bf16 v[0:3], a[12:15], v[32:35], v[0:3]
  buffer_load_dwordx4 v56, s[4:7], s18 offen offset:3072 sc1 lds
  v_mfma_f32_16x16x32_bf16 v[16:19], a[12:15], v[36:39], v[16:19]
  v_mfma_f32_16x16x32_bf16 v[4:7], a[68:71], v[32:35], v[4:7]
  v_mfma_f32_16x16x32_bf16 v[20:23], a[68:71], v[36:39], v[20:23]
  v_mfma_f32_16x16x32_bf16 v[8:11], a[124:127], v[32:35], v[8:11]
  v_mfma_f32_16x16x32_bf16 v[24:27], a[124:127], v[36:39], v[24:27]
  v_mfma_f32_16x16x32_bf16 v[12:15], a[180:183], v[32:35], v[12:15]
  v_mfma_f32_16x16x32_bf16 v[28:31], a[180:183], v[36:39], v[28:31]
  ds_read_b128 v[32:35], v57 offset:6144
  ds_read_b128 v[36:39], v57 offset:20480
  s_waitcnt lgkmcnt(4)
  v_mfma_f32_16x16x32_bf16 v[0:3], a[16:19], v[40:43], v[0:3]
  s_add_u32 m0, s19, 4096
  s_add_u32 s30, s18, 4096
  buffer_load_dwordx4 v56, s[4:7], s30 offen offset:0 sc1 lds
  v_mfma_f32_16x16x32_bf16 v[16:19], a[16:19], v[44:47], v[16:19]
  v_mfma_f32_16x16x32_bf16 v[4:7], a[72:75], v[40:43], v[4:7]
  v_mfma_f32_16x16x32_bf16 v[20:23], a[72:75], v[44:47], v[20:23]
  v_mfma_f32_16x16x32_bf16 v[8:11], a[128:131], v[40:43], v[8:11]
  v_mfma_f32_16x16x32_bf16 v[24:27], a[128:131], v[44:47], v[24:27]
  v_mfma_f32_16x16x32_bf16 v[12:15], a[184:187], v[40:43], v[12:15]
  v_mfma_f32_16x16x32_bf16 v[28:31], a[184:187], v[44:47], v[28:31]
  ds_read_b128 v[40:43], v57 offset:7168
  ds_read_b128 v[44:47], v57 offset:21504
  s_waitcnt lgkmcnt(4)
  v_mfma_f32_16x16x32_bf16 v[0:3], a[20:23], v[48:51], v[0:3]
  buffer_load_dwordx4 v56, s[4:7], s30 offen offset:1024 sc1 lds
  v_mfma_f32_16x16x32_bf16 v[16:19], a[20:23], v[52:55], v[16:19]
  v_mfma_f32_16x16x32_bf16 v[4:7], a[76:79], v[48:51], v[4:7]
  v_mfma_f32_16x16x32_bf16 v[20:23], a[76:79], v[52:55], v[20:23]
  v_mfma_f32_16x16x32_bf16 v[8:11], a[132:135], v[48:51], v[8:11]
  v_mfma_f32_16x16x32_bf16 v[24:27], a[132:135], v[52:55], v[24:27]
  v_mfma_f32_16x16x32_bf16 v[12:15], a[188:191], v[48:51], v[12:15]
  v_mfma_f32_16x16x32_bf16 v[28:31], a[188:191], v[52:55], v[28:31]
  ds_read_b128 v[48:51], v57 offset:8192
  ds_read_b128 v[52:55], v57 offset:22528
  s_waitcnt lgkmcnt(4)
  v_mfma_f32_16x16x32_bf16 v[0:3], a[24:27], v[32:35], v[0:3]
  buffer_load_dwordx4 v56, s[4:7], s30 offen offset:2048 sc1 lds
  v_mfma_f32_16x16x32_bf16 v[16:19], a[24:27], v[36:39], v[16:19]
  v_mfma_f32_16x16x32_bf16 v[4:7], a[80:83], v[32:35], v[4:7]
  v_mfma_f32_16x16x32_bf16 v[20:23], a[80:83], v[36:39], v[20:23]
  v_mfma_f32_16x16x32_bf16 v[8:11], a[136:139], v[32:35], v[8:11]
  v_mfma_f32_16x16x32_bf16 v[24:27], a[136:139], v[36:39], v[24:27]
  v_mfma_f32_16x16x32_bf16 v[12:15], a[192:195], v[32:35], v[12:15]
  v_mfma_f32_16x16x32_bf16 v[28:31], a[192:195], v[36:39], v[28:31]
  ds_read_b128 v[32:35], v57 offset:9216
  ds_read_b128 v[36:39], v57 offset:23552
  s_waitcnt lgkmcnt(4)
  v_mfma_f32_16x16x32_bf16 v[0:3], a[28:31], v[40:43], v[0:3]
  v_mfma_f32_16x16x32_bf16 v[16:19], a[28:31], v[44:47], v[16:19]
  v_mfma_f32_16x16x32_bf16 v[4:7], a[84:87], v[40:43], v[4:7]
  v_mfma_f32_16x16x32_bf16 v[20:23], a[84:87], v[44:47], v[20:23]
  v_mfma_f32_16x16x32_bf16 v[8:11], a[140:143], v[40:43], v[8:11]
  v_mfma_f32_16x16x32_bf16 v[24:27], a[140:143], v[44:47], v[24:27]
  v_mfma_f32_16x16x32_bf16 v[12:15], a[196:199], v[40:43], v[12:15]
  v_mfma_f32_16x16x32_bf16 v[28:31], a[196:199], v[44:47], v[28:31]
  ds_read_b128 v[40:43], v57 offset:10240
  ds_read_b128 v[44:47], v57 offset:24576
  s_waitcnt lgkmcnt(4)
  v_mfma_f32_16x16x32_bf16 v[0:3], a[32:35], v[48:51], v[0:3]
  v_mfma_f32_16x16x32_bf16 v[16:19], a[32:35], v[52:55], v[16:19]
  v_mfma_f32_16x16x32_bf16 v[4:7], a[88:91], v[48:51], v[4:7]
  v_mfma_f32_16x16x32_bf16 v[20:23], a[88:91], v[52:55], v[20:23]
  v_mfma_f32_16x16x32_bf16 v[8:11], a[144:147], v[48:51], v[8:11]
  v_mfma_f32_16x16x32_bf16 v[24:27], a[144:147], v[52:55], v[24:27]
  v_mfma_f32_16x16x32_bf16 v[12:15], a[200:203], v[48:51], v[12:15]
  v_mfma_f32_16x16x32_bf16 v[28:31], a[200:203], v[52:55], v[28:31]
  ds_read_b128 v[48:51], v57 offset:11264
  ds_read_b128 v[52:55], v57 offset:25600
  s_waitcnt lgkmcnt(4)
  v_mfma_f32_16x16x32_bf16 v[0:3], a[36:39], v[32:35], v[0:3]
  v_mfma_f32_16x16x32_bf16 v[16:19], a[36:39], v[36:39], v[16:19]
  v_mfma_f32_16x16x32_bf16 v[4:7], a[92:95], v[32:35], v[4:7]
  v_mfma_f32_16x16x32_bf16 v[20:23], a[92:95], v[36:39], v[20:23]
  v_mfma_f32_16x16x32_bf16 v[8:11], a[148:151], v[32:35], v[8:11]
  v_mfma_f32_16x16x32_bf16 v[24:27], a[148:151], v[36:39], v[24:27]
  v_mfma_f32_16x16x32_bf16 v[12:15], a[204:207], v[32:35], v[12:15]
  v_mfma_f32_16x16x32_bf16 v[28:31], a[204:207], v[36:39], v[28:31]
  ds_read_b128 v[32:35], v57 offset:12288
  ds_read_b128 v[36:39], v57 offset:26624
  s_waitcnt lgkmcnt(4)
  v_mfma_f32_16x16x32_bf16 v[0:3], a[40:43], v[40:43], v[0:3]
  s_waitcnt vmcnt(7)
  buffer_store_dwordx2 v[60:61], v62, s[4:7], s22 offen sc1
  v_mfma_f32_16x16x32_bf16 v[16:19], a[40:43], v[44:47], v[16:19]
  v_mfma_f32_16x16x32_bf16 v[4:7], a[96:99], v[40:43], v[4:7]
  v_mfma_f32_16x16x32_bf16 v[20:23], a[96:99], v[44:47], v[20:23]
  v_mfma_f32_16x16x32_bf16 v[8:11], a[152:155], v[40:43], v[8:11]
  v_mfma_f32_16x16x32_bf16 v[24:27], a[152:155], v[44:47], v[24:27]
  v_mfma_f32_16x16x32_bf16 v[12:15], a[208:211], v[40:43], v[12:15]
  v_mfma_f32_16x16x32_bf16 v[28:31], a[208:211], v[44:47], v[28:31]
  ds_read_b128 v[40:43], v57 offset:13312
  ds_read_b128 v[44:47], v57 offset:27648
  s_waitcnt lgkmcnt(4)
  v_mfma_f32_16x16x32_bf16 v[0:3], a[44:47], v[48:51], v[0:3]
  v_mfma_f32_16x16x32_bf16 v[16:19], a[44:47], v[52:55], v[16:19]
  v_mfma_f32_16x16x32_bf16 v[4:7], a[100:103], v[48:51], v[4:7]
  v_mfma_f32_16x16x32_bf16 v[20:23], a[100:103], v[52:55], v[20:23]
  v_mfma_f32_16x16x32_bf16 v[8:11], a[156:159], v[48:51], v[8:11]
  v_mfma_f32_16x16x32_bf16 v[24:27], a[156:159], v[52:55], v[24:27]
  v_mfma_f32_16x16x32_bf16 v[12:15], a[212:215], v[48:51], v[12:15]
  v_mfma_f32_16x16x32_bf16 v[28:31], a[212:215], v[52:55], v[28:31]
  s_waitcnt lgkmcnt(2)
  v_mfma_f32_16x16x32_bf16 v[0:3], a[48:51], v[32:35], v[0:3]
  v_mfma_f32_16x16x32_bf16 v[16:19], a[48:51], v[36:39], v[16:19]
  v_mfma_f32_16x16x32_bf16 v[4:7], a[104:107], v[32:35], v[4:7]
  v_mfma_f32_16x16x32_bf16 v[20:23], a[104:107], v[36:39], v[20:23]
  v_mfma_f32_16x16x32_bf16 v[8:11], a[160:163], v[32:35], v[8:11]
  v_mfma_f32_16x16x32_bf16 v[24:27], a[160:163], v[36:39], v[24:27]
  v_mfma_f32_16x16x32_bf16 v[12:15], a[216:219], v[32:35], v[12:15]
  v_mfma_f32_16x16x32_bf16 v[28:31], a[216:219], v[36:39], v[28:31]
  s_waitcnt lgkmcnt(0)
  v_mfma_f32_16x16x32_bf16 v[0:3], a[52:55], v[40:43], v[0:3]
  v_mfma_f32_16x16x32_bf16 v[16:19], a[52:55], v[44:47], v[16:19]
  v_mfma_f32_16x16x32_bf16 v[4:7], a[108:111], v[40:43], v[4:7]
  v_mfma_f32_16x16x32_bf16 v[20:23], a[108:111], v[44:47], v[20:23]
  v_mfma_f32_16x16x32_bf16 v[8:11], a[164:167], v[40:43], v[8:11]
  v_mfma_f32_16x16x32_bf16 v[24:27], a[164:167], v[44:47], v[24:27]
  v_mfma_f32_16x16x32_bf16 v[12:15], a[220:223], v[40:43], v[12:15]
  v_mfma_f32_16x16x32_bf16 v[28:31], a[220:223], v[44:47], v[28:31]
  s_cmp_ge_u32 s19, 28672
  s_cselect_b32 s31, 28672, 0
  v_add_u32 v57, s31, v56
  s_add_u32 s30, s20, 57344
  v_cvt_pk_bf16_f32 v76, v0, v1
  v_cvt_pk_bf16_f32 v77, v8, v9
  v_lshlrev_b32 v0, 16, v76
  v_and_b32 v1, s24, v76
  v_lshlrev_b32 v8, 16, v77
  v_and_b32 v9, s24, v77
  v_cvt_pk_bf16_f32 v76, v2, v3
  v_cvt_pk_bf16_f32 v77, v10, v11
  v_lshlrev_b32 v2, 16, v76
  v_and_b32 v3, s24, v76
  v_lshlrev_b32 v10, 16, v77
  v_and_b32 v11, s24, v77
  v_cvt_pk_bf16_f32 v76, v4, v5
  v_cvt_pk_bf16_f32 v77, v12, v13
  v_lshlrev_b32 v4, 16, v76
  v_and_b32 v5, s24, v76
  v_lshlrev_b32 v12, 16, v77
  v_and_b32 v13, s24, v77
  v_cvt_pk_bf16_f32 v76, v6, v7
  v_cvt_pk_bf16_f32 v77, v14, v15
  v_lshlrev_b32 v6, 16, v76
  v_and_b32 v7, s24, v76
  v_lshlrev_b32 v14, 16, v77
  v_and_b32 v15, s24, v77
  v_mul_f32 v0, s23, v0
  v_mul_f32 v1, s23, v1
  v_mul_f32 v2, s23, v2
  v_mul_f32 v3, s23, v3
  v_mul_f32 v4, s23, v4
  v_mul_f32 v5, s23, v5
  v_mul_f32 v6, s23, v6
  v_mul_f32 v7, s23, v7
  v_exp_f32 v0, v0
  v_exp_f32 v1, v1
  v_exp_f32 v2, v2
  v_exp_f32 v3, v3
  v_exp_f32 v4, v4
  v_exp_f32 v5, v5
  v_exp_f32 v6, v6
  v_exp_f32 v7, v7
  v_add_f32 v0, 1.0, v0
  v_add_f32 v1, 1.0, v1
  v_add_f32 v2, 1.0, v2
  v_add_f32 v3, 1.0, v3
  v_add_f32 v4, 1.0, v4
  v_add_f32 v5, 1.0, v5
  v_add_f32 v6, 1.0, v6
  v_add_f32 v7, 1.0, v7
  v_rcp_f32 v0, v0
  v_rcp_f32 v1, v1
  v_rcp_f32 v2, v2
  v_rcp_f32 v3, v3
  v_rcp_f32 v4, v4
  v_rcp_f32 v5, v5
  v_rcp_f32 v6, v6
  v_rcp_f32 v7, v7
  v_cvt_pk_bf16_f32 v76, v0, v1
  v_cvt_pk_bf16_f32 v77, v2, v3
  v_cvt_pk_bf16_f32 v78, v4, v5
  v_cvt_pk_bf16_f32 v79, v6, v7
  v_lshlrev_b32 v0, 16, v76
  v_and_b32 v1, s24, v76
  v_lshlrev_b32 v2, 16, v77
  v_and_b32 v3, s24, v77
  v_lshlrev_b32 v4, 16, v78
  v_and_b32 v5, s24, v78
  v_lshlrev_b32 v6, 16, v79
  v_and_b32 v7, s24, v79
  v_mul_f32 v0, v0, v8
  v_mul_f32 v1, v1, v9
  v_mul_f32 v2, v2, v10
  v_mul_f32 v3, v3, v11
  v_mul_f32 v4, v4, v12
  v_mul_f32 v5, v5, v13
  v_mul_f32 v6, v6, v14
  v_mul_f32 v7, v7, v15
  v_cvt_pk_bf16_f32 v80, v0, v1
  v_cvt_pk_bf16_f32 v81, v2, v3
  v_cvt_pk_bf16_f32 v82, v4, v5
  v_cvt_pk_bf16_f32 v83, v6, v7
  buffer_store_dwordx4 v[80:83], v56, s[4:7], s20 offen sc1
  v_cvt_pk_bf16_f32 v76, v16, v17
  v_cvt_pk_bf16_f32 v77, v24, v25
  v_lshlrev_b32 v16, 16, v76
  v_and_b32 v17, s24, v76
  v_lshlrev_b32 v24, 16, v77
  v_and_b32 v25, s24, v77
  v_cvt_pk_bf16_f32 v76, v18, v19
  v_cvt_pk_bf16_f32 v77, v26, v27
  v_lshlrev_b32 v18, 16, v76
  v_and_b32 v19, s24, v76
  v_lshlrev_b32 v26, 16, v77
  v_and_b32 v27, s24, v77
  v_cvt_pk_bf16_f32 v76, v20, v21
  v_cvt_pk_bf16_f32 v77, v28, v29
  v_lshlrev_b32 v20, 16, v76
  v_and_b32 v21, s24, v76
  v_lshlrev_b32 v28, 16, v77
  v_and_b32 v29, s24, v77
  v_cvt_pk_bf16_f32 v76, v22, v23
  v_cvt_pk_bf16_f32 v77, v30, v31
  v_lshlrev_b32 v22, 16, v76
  v_and_b32 v23, s24, v76
  v_lshlrev_b32 v30, 16, v77
  v_and_b32 v31, s24, v77
  v_mul_f32 v16, s23, v16
  v_mul_f32 v17, s23, v17
  v_mul_f32 v18, s23, v18
  v_mul_f32 v19, s23, v19
  v_mul_f32 v20, s23, v20
  v_mul_f32 v21, s23, v21
  v_mul_f32 v22, s23, v22
  v_mul_f32 v23, s23, v23
  v_exp_f32 v16, v16
  v_exp_f32 v17, v17
  v_exp_f32 v18, v18
  v_exp_f32 v19, v19
  v_exp_f32 v20, v20
  v_exp_f32 v21, v21
  v_exp_f32 v22, v22
  v_exp_f32 v23, v23
  v_add_f32 v16, 1.0, v16
  v_add_f32 v17, 1.0, v17
  v_add_f32 v18, 1.0, v18
  v_add_f32 v19, 1.0, v19
  v_add_f32 v20, 1.0, v20
  v_add_f32 v21, 1.0, v21
  v_add_f32 v22, 1.0, v22
  v_add_f32 v23, 1.0, v23
  v_rcp_f32 v16, v16
  v_rcp_f32 v17, v17
  v_rcp_f32 v18, v18
  v_rcp_f32 v19, v19
  v_rcp_f32 v20, v20
  v_rcp_f32 v21, v21
  v_rcp_f32 v22, v22
  v_rcp_f32 v23, v23
  v_cvt_pk_bf16_f32 v76, v16, v17
  v_cvt_pk_bf16_f32 v77, v18, v19
  v_cvt_pk_bf16_f32 v78, v20, v21
  v_cvt_pk_bf16_f32 v79, v22, v23
  v_lshlrev_b32 v16, 16, v76
  v_and_b32 v17, s24, v76
  v_lshlrev_b32 v18, 16, v77
  v_and_b32 v19, s24, v77
  v_lshlrev_b32 v20, 16, v78
  v_and_b32 v21, s24, v78
  v_lshlrev_b32 v22, 16, v79
  v_and_b32 v23, s24, v79
  v_mul_f32 v16, v16, v24
  v_mul_f32 v17, v17, v25
  v_mul_f32 v18, v18, v26
  v_mul_f32 v19, v19, v27
  v_mul_f32 v20, v20, v28
  v_mul_f32 v21, v21, v29
  v_mul_f32 v22, v22, v30
  v_mul_f32 v23, v23, v31
  v_cvt_pk_bf16_f32 v84, v16, v17
  v_cvt_pk_bf16_f32 v85, v18, v19
  v_cvt_pk_bf16_f32 v86, v20, v21
  v_cvt_pk_bf16_f32 v87, v22, v23
  buffer_store_dwordx4 v[84:87], v56, s[4:7], s30 offen sc1
  s_mov_b32 s22, s21
  s_add_u32 s21, s21, 896
  s_add_u32 s20, s20, 229376
  s_add_u32 s17, s17, 2
  s_cmp_lt_u32 s17, 64
  s_cbranch_scc1 L_gu_58
  s_waitcnt vmcnt(0)
  buffer_store_dwordx2 v[60:61], v62, s[4:7], s22 offen sc1
  s_branch L_fin_20
L_TW_38:
  s_sub_u32 s9, s9, 60
  s_mul_i32 s16, s9, 21846
  s_lshr_b32 s16, s16, 16
  s_mul_i32 s30, s16, 3
  s_sub_u32 s17, s9, s30
  v_mbcnt_lo_u32_b32 v96, -1, 0
  v_mbcnt_hi_u32_b32 v96, -1, v96
  v_lshlrev_b32 v86, 4, v96
  v_lshlrev_b32 v87, 3, v96
  v_mov_b32 v98, s12
  v_mov_b32 v99, s13
  v_cmp_eq_u32 vcc, 0, v96
  v_mov_b32 v100, 0x80000000
  s_nop 0
  v_cndmask_b32 v100, v100, 0, vcc
  v_and_b32 v104, 15, v96
  v_lshrrev_b32 v105, 4, v96
  s_mul_i32 s30, s8, 7168
  s_add_u32 s23, s30, 57344
  v_add_u32 v95, s23, v86
  s_mul_i32 s31, s17, 28672
  s_add_u32 s30, s30, s31
  s_add_u32 s22, s30, 12845056
  v_and_b32 v106, 7, v104
  v_lshlrev_b32 v106, 4, v106
  s_mul_i32 s30, s8, 1792
  v_add_u32 v106, s30, v106
  v_lshl_add_u32 v88, v105, 7, v106
  v_lshrrev_b32 v107, 1, v105
  v_lshl_add_u32 v106, v107, 7, v106
  v_and_b32 v108, 1, v105
  v_lshl_add_u32 v106, v108, 3, v106
  v_add_u32 v89, 1536, v106
  s_mul_i32 s30, s8, 6144
  s_add_u32 s30, s30, 86016
  v_add_u32 v90, s30, v86
  s_and_b32 s31, s8, 1
  s_mul_i32 s30, s31, 3072
  s_add_u32 s30, s30, 86016
  v_lshl_add_u32 v106, v108, 4, v104
  v_lshlrev_b32 v106, 4, v106
  v_add_u32 v106, s30, v106
  v_lshl_add_u32 v91, v107, 10, v106
  v_lshl_add_u32 v92, v107, 3, v106
  v_add_u32 v92, 2048, v92
  v_lshl_add_u32 v106, v108, 4, v104
  v_lshlrev_b32 v106, 4, v106
  v_lshl_add_u32 v106, v107, 2, v106
  s_lshr_b32 s30, s16, 2
  s_lshl_b32 s30, s30, 11
  s_and_b32 s29, s16, 1
  s_lshl_b32 s29, s29, 9
  s_add_u32 s30, s30, s29
  s_lshr_b32 s29, s16, 1
  s_and_b32 s29, s29, 1
  s_lshl_b32 s29, s29, 3
  s_add_u32 s30, s30, s29
  s_add_u32 s30, s30, 32768
  s_lshl_b32 s29, s16, 11
  s_sub_u32 s30, s30, s29
  v_add_u32 v93, s30, v106
  s_mul_i32 s30, s17, 40960
  s_add_u32 s30, s30, s29
  s_lshl_b32 s29, s31, 10
  s_add_u32 s30, s30, s29
  s_add_u32 s20, s30, 62914560
  v_lshlrev_b32 v107, 4, v107
  v_lshl_add_u32 v107, v108, 2, v107
  v_lshrrev_b32 v106, 3, v104
  v_lshlrev_b32 v106, 4, v106
  v_bfe_u32 v108, v104, 1, 1
  v_lshl_add_u32 v106, v108, 3, v106
  v_bfe_u32 v108, v104, 2, 1
  v_lshl_add_u32 v106, v108, 2, v106
  v_and_b32 v108, 1, v104
  v_add_u32 v106, v106, v108
  s_lshl_b32 s30, s31, 1
  v_add_u32 v106, s30, v106
  v_sub_u32 v106, v106, v107
  v_cmp_le_i32 s[44:45], 0, v106
  v_cmp_le_i32 s[46:47], 1, v106
  v_cmp_le_i32 s[48:49], 2, v106
  v_cmp_le_i32 s[50:51], 3, v106
  v_cmp_le_i32 s[52:53], 8, v106
  v_cmp_le_i32 s[54:55], 9, v106
  v_cmp_le_i32 s[56:57], 10, v106
  v_cmp_le_i32 s[58:59], 11, v106
  s_mov_b32 s29, 68196352
  s_mov_b32 s28, 0
  s_branch L_wf0_60
L_wf_59:
  s_sleep 8
L_wf0_60:
  buffer_load_dwordx2 v[110:111], v87, s[4:7], s29 offen offset:0 sc1
  s_add_u32 s28, s28, 1
  s_cmp_gt_u32 s28, 2000000
  s_cbranch_scc1 L_fail
  s_waitcnt vmcnt(0)
  v_xor_b32 v110, s12, v110
  v_xor_b32 v111, s13, v111
  v_or_b32 v110, v110, v111
  v_cmp_ne_u32 vcc, 0, v110
  s_cbranch_vccnz L_wf_59
  s_cmp_lt_u32 s8, 2
  s_cselect_b32 s24, s20, 0xf0000000
  v_mov_b32 v0, -1
  v_mov_b32 v1, -1
  v_mov_b32 v2, -1
  v_mov_b32 v3, -1
  s_mov_b32 s30, s24
L_poi_61:
  buffer_store_dwordx4 v[0:3], v86, s[4:7], s30 offen offset:0 sc1
  buffer_store_dword v0, v93, s[4:7], s30 offen offset:0 sc1
  s_add_u32 s30, s30, 122880
  s_cmp_lt_u32 s30, 65536000
  s_cbranch_scc1 L_poi_61
  s_add_u32 s30, s9, 0
  s_lshl_b32 s30, s30, 2
  s_add_u32 s30, s30, s8
  s_lshl_b32 s30, s30, 3
  s_add_u32 s25, s30, 68222976
  s_mul_i32 s30, s17, 8192
  s_add_u32 s24, s30, 66584576
  s_mul_i32 s26, s16, 448
  s_add_u32 s26, s26, 68419584
  s_mov_b32 exec_lo, 0xffffffff
  s_mov_b32 exec_hi, 0xffffff
  s_mov_b32 s28, 0
  s_branch L_wf0_63
L_wf_62:
  s_sleep 2
L_wf0_63:
  buffer_load_dwordx2 v[110:111], v87, s[4:7], s26 offen offset:0 sc1
  s_add_u32 s28, s28, 1
  s_cmp_gt_u32 s28, 2000000
  s_cbranch_scc1 L_fail
  s_waitcnt vmcnt(0)
  v_xor_b32 v110, s12, v110
  v_xor_b32 v111, s13, v111
  v_or_b32 v110, v110, v111
  v_cmp_ne_u32 vcc, 0, v110
  s_cbranch_vccnz L_wf_62
  s_mov_b64 exec, -1
  s_mul_i32 s31, s16, 401408
  s_mul_i32 s30, s8, 100352
  s_add_u32 s31, s31, s30
  s_add_u32 s27, s31, 0
  s_add_u32 s26, s26, 14336
  s_add_u32 s30, s27, 0
  buffer_load_dwordx4 a[0:3], v86, s[4:7], s30 offen sc1
  s_add_u32 s30, s27, 14336
  buffer_load_dwordx4 a[56:59], v86, s[4:7], s30 offen sc1
  s_add_u32 s30, s27, 28672
  buffer_load_dwordx4 a[112:115], v86, s[4:7], s30 offen sc1
  s_add_u32 s30, s27, 43008
  buffer_load_dwordx4 a[168:171], v86, s[4:7], s30 offen sc1
  s_add_u32 s30, s27, 57344
  buffer_load_dwordx4 a[224:227], v86, s[4:7], s30 offen sc1
  s_add_u32 s30, s27, 71680
  buffer_load_dwordx4 v[144:147], v86, s[4:7], s30 offen sc1
  s_add_u32 s30, s27, 86016
  buffer_load_dwordx4 v[200:203], v86, s[4:7], s30 offen sc1
  s_add_u32 s30, s27, 1024
  buffer_load_dwordx4 a[4:7], v86, s[4:7], s30 offen sc1
  s_add_u32 s30, s27, 15360
  buffer_load_dwordx4 a[60:63], v86, s[4:7], s30 offen sc1
  s_add_u32 s30, s27, 29696
  buffer_load_dwordx4 a[116:119], v86, s[4:7], s30 offen sc1
  s_add_u32 s30, s27, 44032
  buffer_load_dwordx4 a[172:175], v86, s[4:7], s30 offen sc1
  s_add_u32 s30, s27, 58368
  buffer_load_dwordx4 a[228:231], v86, s[4:7], s30 offen sc1
  s_add_u32 s30, s27, 72704
  buffer_load_dwordx4 v[148:151], v86, s[4:7], s30 offen sc1
  s_add_u32 s30, s27, 87040
  buffer_load_dwordx4 v[204:207], v86, s[4:7], s30 offen sc1
  s_add_u32 s30, s27, 2048
  buffer_load_dwordx4 a[8:11], v86, s[4:7], s30 offen sc1
  s_add_u32 s30, s27, 16384
  buffer_load_dwordx4 a[64:67], v86, s[4:7], s30 offen sc1
  s_add_u32 s30, s27, 30720
  buffer_load_dwordx4 a[120:123], v86, s[4:7], s30 offen sc1
  s_add_u32 s30, s27, 45056
  buffer_load_dwordx4 a[176:179], v86, s[4:7], s30 offen sc1
  s_add_u32 s30, s27, 59392
  buffer_load_dwordx4 a[232:235], v86, s[4:7], s30 offen sc1
  s_add_u32 s30, s27, 73728
  buffer_load_dwordx4 v[152:155], v86, s[4:7], s30 offen sc1
  s_add_u32 s30, s27, 88064
  buffer_load_dwordx4 v[208:211], v86, s[4:7], s30 offen sc1
  s_add_u32 s30, s27, 3072
  buffer_load_dwordx4 a[12:15], v86, s[4:7], s30 offen sc1
  s_add_u32 s30, s27, 17408
  buffer_load_dwordx4 a[68:71], v86, s[4:7], s30 offen sc1
  s_add_u32 s30, s27, 31744
  buffer_load_dwordx4 a[124:127], v86, s[4:7], s30 offen sc1
  s_add_u32 s30, s27, 46080
  buffer_load_dwordx4 a[180:183], v86, s[4:7], s30 offen sc1
  s_add_u32 s30, s27, 60416
  buffer_load_dwordx4 a[236:239], v86, s[4:7], s30 offen sc1
  s_add_u32 s30, s27, 74752
  buffer_load_dwordx4 v[156:159], v86, s[4:7], s30 offen sc1
  s_add_u32 s30, s27, 89088
  buffer_load_dwordx4 v[212:215], v86, s[4:7], s30 offen sc1
  buffer_load_dwordx2 v[110:111], v87, s[4:7], s26 offen sc1
  s_add_u32 s30, s27, 7168
  buffer_load_dwordx4 a[28:31], v86, s[4:7], s30 offen sc1
  s_add_u32 s30, s27, 21504
  buffer_load_dwordx4 a[84:87], v86, s[4:7], s30 offen sc1
  s_add_u32 s30, s27, 35840
  buffer_load_dwordx4 a[140:143], v86, s[4:7], s30 offen sc1
  s_add_u32 s30, s27, 50176
  buffer_load_dwordx4 a[196:199], v86, s[4:7], s30 offen sc1
  s_add_u32 s30, s27, 64512
  buffer_load_dwordx4 a[252:255], v86, s[4:7], s30 offen sc1
  s_add_u32 s30, s27, 78848
  buffer_load_dwordx4 v[172:175], v86, s[4:7], s30 offen sc1
  s_add_u32 s30, s27, 93184
  buffer_load_dwordx4 v[228:231], v86, s[4:7], s30 offen sc1
  s_add_u32 s30, s27, 8192
  buffer_load_dwordx4 a[32:35], v86, s[4:7], s30 offen sc1
  s_add_u32 s30, s27, 22528
  buffer_load_dwordx4 a[88:91], v86, s[4:7], s30 offen sc1
  s_add_u32 s30, s27, 36864
  buffer_load_dwordx4 a[144:147], v86, s[4:7], s30 offen sc1
  s_add_u32 s30, s27, 51200
  buffer_load_dwordx4 a[200:203], v86, s[4:7], s30 offen sc1
  s_add_u32 s30, s27, 65536
  buffer_load_dwordx4 v[120:123], v86, s[4:7], s30 offen sc1
  s_add_u32 s30, s27, 79872
  buffer_load_dwordx4 v[176:179], v86, s[4:7], s30 offen sc1
  s_add_u32 s30, s27, 94208
  buffer_load_dwordx4 v[232:235], v86, s[4:7], s30 offen sc1
  s_add_u32 s30, s27, 9216
  buffer_load_dwordx4 a[36:39], v86, s[4:7], s30 offen sc1
  s_add_u32 s30, s27, 23552
  buffer_load_dwordx4 a[92:95], v86, s[4:7], s30 offen sc1
  s_add_u32 s30, s27, 37888
  buffer_load_dwordx4 a[148:151], v86, s[4:7], s30 offen sc1
  s_add_u32 s30, s27, 52224
  buffer_load_dwordx4 a[204:207], v86, s[4:7], s30 offen sc1
  s_add_u32 s30, s27, 66560
  buffer_load_dwordx4 v[124:127], v86, s[4:7], s30 offen sc1
  s_add_u32 s30, s27, 80896
  buffer_load_dwordx4 v[180:183], v86, s[4:7], s30 offen sc1
  s_add_u32 s30, s27, 95232
  buffer_load_dwordx4 v[236:239], v86, s[4:7], s30 offen sc1
  s_add_u32 s30, s27, 10240
  buffer_load_dwordx4 a[40:43], v86, s[4:7], s30 offen sc1
  s_add_u32 s30, s27, 24576
  buffer_load_dwordx4 a[96:99], v86, s[4:7], s30 offen sc1
  s_add_u32 s30, s27, 38912
  buffer_load_dwordx4 a[152:155], v86, s[4:7], s30 offen sc1
  s_add_u32 s30, s27, 53248
  buffer_load_dwordx4 a[208:211], v86, s[4:7], s30 offen sc1
  s_add_u32 s30, s27, 67584
  buffer_load_dwordx4 v[128:131], v86, s[4:7], s30 offen sc1
  s_add_u32 s30, s27, 81920
  buffer_load_dwordx4 v[184:187], v86, s[4:7], s30 offen sc1
  s_add_u32 s30, s27, 96256
  buffer_load_dwordx4 v[240:243], v86, s[4:7], s30 offen sc1
  s_waitcnt vmcnt(28)
  s_mov_b32 exec_lo, 0xffffffff
  s_mov_b32 exec_hi, 0xffffff
  v_xor_b32 v110, s12, v110
  v_xor_b32 v111, s13, v111
  v_or_b32 v110, v110, v111
  v_cmp_ne_u32 vcc, 0, v110
  s_mov_b64 exec, -1
  s_cbranch_vccz L_fok_64
  s_mov_b32 exec_lo, 0xffffffff
  s_mov_b32 exec_hi, 0xffffff
  s_mov_b32 s28, 0
  s_branch L_wf0_66
L_wf_65:
  s_sleep 1
L_wf0_66:
  buffer_load_dwordx2 v[110:111], v87, s[4:7], s26 offen offset:0 sc1
  s_add_u32 s28, s28, 1
  s_cmp_gt_u32 s28, 2000000
  s_cbranch_scc1 L_fail
  s_waitcnt vmcnt(0)
  v_xor_b32 v110, s12, v110
  v_xor_b32 v111, s13, v111
  v_or_b32 v110, v110, v111
  v_cmp_ne_u32 vcc, 0, v110
  s_cbranch_vccnz L_wf_65
  s_mov_b64 exec, -1
L_fok_64:
  s_add_u32 s30, s27, 4096
  buffer_load_dwordx4 a[16:19], v86, s[4:7], s30 offen sc1
  s_add_u32 s30, s27, 18432
  buffer_load_dwordx4 a[72:75], v86, s[4:7], s30 offen sc1
  s_add_u32 s30, s27, 32768
  buffer_load_dwordx4 a[128:131], v86, s[4:7], s30 offen sc1
  s_add_u32 s30, s27, 47104
  buffer_load_dwordx4 a[184:187], v86, s[4:7], s30 offen sc1
  s_add_u32 s30, s27, 61440
  buffer_load_dwordx4 a[240:243], v86, s[4:7], s30 offen sc1
  s_add_u32 s30, s27, 75776
  buffer_load_dwordx4 v[160:163], v86, s[4:7], s30 offen sc1
  s_add_u32 s30, s27, 90112
  buffer_load_dwordx4 v[216:219], v86, s[4:7], s30 offen sc1
  s_add_u32 s30, s27, 5120
  buffer_load_dwordx4 a[20:23], v86, s[4:7], s30 offen sc1
  s_add_u32 s30, s27, 19456
  buffer_load_dwordx4 a[76:79], v86, s[4:7], s30 offen sc1
  s_add_u32 s30, s27, 33792
  buffer_load_dwordx4 a[132:135], v86, s[4:7], s30 offen sc1
  s_add_u32 s30, s27, 48128
  buffer_load_dwordx4 a[188:191], v86, s[4:7], s30 offen sc1
  s_add_u32 s30, s27, 62464
  buffer_load_dwordx4 a[244:247], v86, s[4:7], s30 offen sc1
  s_add_u32 s30, s27, 76800
  buffer_load_dwordx4 v[164:167], v86, s[4:7], s30 offen sc1
  s_add_u32 s30, s27, 91136
  buffer_load_dwordx4 v[220:223], v86, s[4:7], s30 offen sc1
  s_add_u32 s30, s27, 6144
  buffer_load_dwordx4 a[24:27], v86, s[4:7], s30 offen sc1
  s_add_u32 s30, s27, 20480
  buffer_load_dwordx4 a[80:83], v86, s[4:7], s30 offen sc1
  s_add_u32 s30, s27, 34816
  buffer_load_dwordx4 a[136:139], v86, s[4:7], s30 offen sc1
  s_add_u32 s30, s27, 49152
  buffer_load_dwordx4 a[192:195], v86, s[4:7], s30 offen sc1
  s_add_u32 s30, s27, 63488
  buffer_load_dwordx4 a[248:251], v86, s[4:7], s30 offen sc1
  s_add_u32 s30, s27, 77824
  buffer_load_dwordx4 v[168:171], v86, s[4:7], s30 offen sc1
  s_add_u32 s30, s27, 92160
  buffer_load_dwordx4 v[224:227], v86, s[4:7], s30 offen sc1
  s_add_u32 s30, s27, 11264
  buffer_load_dwordx4 a[44:47], v86, s[4:7], s30 offen sc1
  s_add_u32 s30, s27, 25600
  buffer_load_dwordx4 a[100:103], v86, s[4:7], s30 offen sc1
  s_add_u32 s30, s27, 39936
  buffer_load_dwordx4 a[156:159], v86, s[4:7], s30 offen sc1
  s_add_u32 s30, s27, 54272
  buffer_load_dwordx4 a[212:215], v86, s[4:7], s30 offen sc1
  s_add_u32 s30, s27, 68608
  buffer_load_dwordx4 v[132:135], v86, s[4:7], s30 offen sc1
  s_add_u32 s30, s27, 82944
  buffer_load_dwordx4 v[188:191], v86, s[4:7], s30 offen sc1
  s_add_u32 s30, s27, 97280
  buffer_load_dwordx4 v[244:247], v86, s[4:7], s30 offen sc1
  s_add_u32 s30, s27, 12288
  buffer_load_dwordx4 a[48:51], v86, s[4:7], s30 offen sc1
  s_add_u32 s30, s27, 26624
  buffer_load_dwordx4 a[104:107], v86, s[4:7], s30 offen sc1
  s_add_u32 s30, s27, 40960
  buffer_load_dwordx4 a[160:163], v86, s[4:7], s30 offen sc1
  s_add_u32 s30, s27, 55296
  buffer_load_dwordx4 a[216:219], v86, s[4:7], s30 offen sc1
  s_add_u32 s30, s27, 69632
  buffer_load_dwordx4 v[136:139], v86, s[4:7], s30 offen sc1
  s_add_u32 s30, s27, 83968
  buffer_load_dwordx4 v[192:195], v86, s[4:7], s30 offen sc1
  s_add_u32 s30, s27, 98304
  buffer_load_dwordx4 v[248:251], v86, s[4:7], s30 offen sc1
  s_add_u32 s30, s27, 13312
  buffer_load_dwordx4 a[52:55], v86, s[4:7], s30 offen sc1
  s_add_u32 s30, s27, 27648
  buffer_load_dwordx4 a[108:111], v86, s[4:7], s30 offen sc1
  s_add_u32 s30, s27, 41984
  buffer_load_dwordx4 a[164:167], v86, s[4:7], s30 offen sc1
  s_add_u32 s30, s27, 56320
  buffer_load_dwordx4 a[220:223], v86, s[4:7], s30 offen sc1
  s_add_u32 s30, s27, 70656
  buffer_load_dwordx4 v[140:143], v86, s[4:7], s30 offen sc1
  s_add_u32 s30, s27, 84992
  buffer_load_dwordx4 v[196:199], v86, s[4:7], s30 offen sc1
  s_add_u32 s30, s27, 99328
  buffer_load_dwordx4 v[252:255], v86, s[4:7], s30 offen sc1
  s_mov_b32 s28, 0
  s_mov_b32 s29, 68173824
  s_branch L_wl0_68
L_wl_67:
  s_sleep 2
L_wl0_68:
  buffer_load_dwordx4 v[110:113], v86, s[4:7], s29 offen offset:0 sc1
  buffer_load_dwordx4 v[114:117], v86, s[4:7], s29 offen offset:1024 sc1
  s_add_u32 s28, s28, 1
  s_cmp_gt_u32 s28, 2000000
  s_cbranch_scc1 L_fail
  s_waitcnt vmcnt(0)
  v_xor_b32 v110, s12, v110
  v_xor_b32 v111, s13, v111
  v_xor_b32 v112, s12, v112
  v_xor_b32 v113, s13, v113
  v_xor_b32 v114, s12, v114
  v_xor_b32 v115, s13, v115
  v_xor_b32 v116, s12, v116
  v_xor_b32 v117, s13, v117
  v_or_b32 v110, v110, v111
  v_or3_b32 v110, v110, v112, v113
  v_or3_b32 v110, v110, v114, v115
  v_or3_b32 v110, v110, v116, v117
  v_cmp_ne_u32 vcc, 0, v110
  s_cbranch_vccnz L_wl_67
  v_mov_b32 v0, s12
  v_mov_b32 v1, s13
  v_mov_b32 v2, 0
  s_mov_b64 exec, 1
  buffer_store_dwordx2 v[0:1], v2, s[4:7], s25 offen offset:0 sc1
  s_mov_b64 exec, -1
  s_mov_b32 s28, 0
  s_mov_b32 s29, 68354048
  s_branch L_wl0_70
L_wl_69:
  s_sleep 2
L_wl0_70:
  buffer_load_dwordx4 v[110:113], v86, s[4:7], s29 offen offset:0 sc1
  s_add_u32 s28, s28, 1
  s_cmp_gt_u32 s28, 2000000
  s_cbranch_scc1 L_fail
  s_waitcnt vmcnt(0)
  v_xor_b32 v110, s12, v110
  v_xor_b32 v111, s13, v111
  v_xor_b32 v112, s12, v112
  v_xor_b32 v113, s13, v113
  v_or_b32 v110, v110, v111
  v_or3_b32 v110, v110, v112, v113
  v_cmp_ne_u32 vcc, 0, v110
  s_cbranch_vccnz L_wl_69
  s_mul_i32 s30, s17, 28672
  s_mul_i32 s19, s8, 7168
  s_add_u32 s30, s30, s19
  s_add_u32 s18, s30, 14680064
  v_mov_b32 v94, v86
  s_mov_b32 m0, s19
  s_nop 0
  buffer_load_dwordx4 v86, s[4:7], s18 offen offset:0 sc1 lds
  buffer_load_dwordx4 v86, s[4:7], s18 offen offset:1024 sc1 lds
  buffer_load_dwordx4 v86, s[4:7], s18 offen offset:2048 sc1 lds
  buffer_load_dwordx4 v86, s[4:7], s18 offen offset:3072 sc1 lds
  s_add_u32 m0, s19, 4096
  s_add_u32 s30, s18, 4096
  buffer_load_dwordx4 v86, s[4:7], s30 offen offset:0 sc1 lds
  buffer_load_dwordx4 v86, s[4:7], s30 offen offset:1024 sc1 lds
  buffer_load_dwordx4 v86, s[4:7], s30 offen offset:2048 sc1 lds
  s_waitcnt vmcnt(0)
L_tw_71:
  s_barrier
  s_add_u32 s30, s17, 3
  s_add_u32 s31, s18, 86016
  s_cmp_lt_u32 s30, 64
  s_cselect_b32 s18, s31, 0xf0000000
  s_add_u32 s31, s19, 28672
  s_sub_u32 s30, s19, 28672
  s_cmp_ge_u32 s19, 28672
  s_cselect_b32 s19, s30, s31
  ds_read_b128 v[56:59], v94 offset:0
  ds_read_b128 v[60:63], v94 offset:14336
  ds_read_b128 v[64:67], v94 offset:1024
  ds_read_b128 v[68:71], v94 offset:15360
  ds_read_b128 v[72:75], v94 offset:2048
  ds_read_b128 v[76:79], v94 offset:16384
  s_waitcnt lgkmcnt(4)
  v_mfma_f32_16x16x32_bf16 v[0:3], a[0:3], v[56:59], 0
  s_mov_b32 m0, s23
  s_nop 0
  buffer_load_dwordx4 v86, s[4:7], s22 offen offset:0 sc1 lds
  v_mfma_f32_16x16x32_bf16 v[28:31], a[0:3], v[60:63], 0
  v_mfma_f32_16x16x32_bf16 v[4:7], a[56:59], v[56:59], 0
  v_mfma_f32_16x16x32_bf16 v[32:35], a[56:59], v[60:63], 0
  v_mfma_f32_16x16x32_bf16 v[8:11], a[112:115], v[56:59], 0
  v_mfma_f32_16x16x32_bf16 v[36:39], a[112:115], v[60:63], 0
  v_mfma_f32_16x16x32_bf16 v[12:15], a[168:171], v[56:59], 0
  v_mfma_f32_16x16x32_bf16 v[40:43], a[168:171], v[60:63], 0
  v_mfma_f32_16x16x32_bf16 v[16:19], a[224:227], v[56:59], 0
  v_mfma_f32_16x16x32_bf16 v[44:47], a[224:227], v[60:63], 0
  v_mfma_f32_16x16x32_bf16 v[20:23], v[144:147], v[56:59], 0
  v_mfma_f32_16x16x32_bf16 v[48:51], v[144:147], v[60:63], 0
  v_mfma_f32_16x16x32_bf16 v[24:27], v[200:203], v[56:59], 0
  v_mfma_f32_16x16x32_bf16 v[52:55], v[200:203], v[60:63], 0
  ds_read_b128 v[56:59], v94 offset:3072
  ds_read_b128 v[60:63], v94 offset:17408
  s_waitcnt lgkmcnt(4)
  v_mfma_f32_16x16x32_bf16 v[0:3], a[4:7], v[64:67], v[0:3]
  buffer_load_dwordx4 v86, s[4:7], s22 offen offset:1024 sc1 lds
  v_mfma_f32_16x16x32_bf16 v[28:31], a[4:7], v[68:71], v[28:31]
  v_mfma_f32_16x16x32_bf16 v[4:7], a[60:63], v[64:67], v[4:7]
  v_mfma_f32_16x16x32_bf16 v[32:35], a[60:63], v[68:71], v[32:35]
  v_mfma_f32_16x16x32_bf16 v[8:11], a[116:119], v[64:67], v[8:11]
  v_mfma_f32_16x16x32_bf16 v[36:39], a[116:119], v[68:71], v[36:39]
  v_mfma_f32_16x16x32_bf16 v[12:15], a[172:175], v[64:67], v[12:15]
  v_mfma_f32_16x16x32_bf16 v[40:43], a[172:175], v[68:71], v[40:43]
  v_mfma_f32_16x16x32_bf16 v[16:19], a[228:231], v[64:67], v[16:19]
  v_mfma_f32_16x16x32_bf16 v[44:47], a[228:231], v[68:71], v[44:47]
  v_mfma_f32_16x16x32_bf16 v[20:23], v[148:151], v[64:67], v[20:23]
  v_mfma_f32_16x16x32_bf16 v[48:51], v[148:151], v[68:71], v[48:51]
  v_mfma_f32_16x16x32_bf16 v[24:27], v[204:207], v[64:67], v[24:27]
  v_mfma_f32_16x16x32_bf16 v[52:55], v[204:207], v[68:71], v[52:55]
  ds_read_b128 v[64:67], v94 offset:4096
  ds_read_b128 v[68:71], v94 offset:18432
  s_waitcnt lgkmcnt(4)
  v_mfma_f32_16x16x32_bf16 v[0:3], a[8:11], v[72:75], v[0:3]
  buffer_load_dwordx4 v86, s[4:7], s22 offen offset:2048 sc1 lds
  v_mfma_f32_16x16x32_bf16 v[28:31], a[8:11], v[76:79], v[28:31]
  v_mfma_f32_16x16x32_bf16 v[4:7], a[64:67], v[72:75], v[4:7]
  v_mfma_f32_16x16x32_bf16 v[32:35], a[64:67], v[76:79], v[32:35]
  v_mfma_f32_16x16x32_bf16 v[8:11], a[120:123], v[72:75], v[8:11]
  v_mfma_f32_16x16x32_bf16 v[36:39], a[120:123], v[76:79], v[36:39]
  v_mfma_f32_16x16x32_bf16 v[12:15], a[176:179], v[72:75], v[12:15]
  v_mfma_f32_16x16x32_bf16 v[40:43], a[176:179], v[76:79], v[40:43]
  v_mfma_f32_16x16x32_bf16 v[16:19], a[232:235], v[72:75], v[16:19]
  v_mfma_f32_16x16x32_bf16 v[44:47], a[232:235], v[76:79], v[44:47]
  v_mfma_f32_16x16x32_bf16 v[20:23], v[152:155], v[72:75], v[20:23]
  v_mfma_f32_16x16x32_bf16 v[48:51], v[152:155], v[76:79], v[48:51]
  v_mfma_f32_16x16x32_bf16 v[24:27], v[208:211], v[72:75], v[24:27]
  v_mfma_f32_16x16x32_bf16 v[52:55], v[208:211], v[76:79], v[52:55]
  ds_read_b128 v[72:75], v94 offset:5120
  ds_read_b128 v[76:79], v94 offset:19456
  s_waitcnt lgkmcnt(4)
  v_mfma_f32_16x16x32_bf16 v[0:3], a[12:15], v[56:59], v[0:3]
  buffer_load_dwordx4 v86, s[4:7], s22 offen offset:3072 sc1 lds
  v_mfma_f32_16x16x32_bf16 v[28:31], a[12:15], v[60:63], v[28:31]
  v_mfma_f32_16x16x32_bf16 v[4:7], a[68:71], v[56:59], v[4:7]
  v_mfma_f32_16x16x32_bf16 v[32:35], a[68:71], v[60:63], v[32:35]
  v_mfma_f32_16x16x32_bf16 v[8:11], a[124:127], v[56:59], v[8:11]
  v_mfma_f32_16x16x32_bf16 v[36:39], a[124:127], v[60:63], v[36:39]
  v_mfma_f32_16x16x32_bf16 v[12:15], a[180:183], v[56:59], v[12:15]
  v_mfma_f32_16x16x32_bf16 v[40:43], a[180:183], v[60:63], v[40:43]
  v_mfma_f32_16x16x32_bf16 v[16:19], a[236:239], v[56:59], v[16:19]
  v_mfma_f32_16x16x32_bf16 v[44:47], a[236:239], v[60:63], v[44:47]
  v_mfma_f32_16x16x32_bf16 v[20:23], v[156:159], v[56:59], v[20:23]
  v_mfma_f32_16x16x32_bf16 v[48:51], v[156:159], v[60:63], v[48:51]
  v_mfma_f32_16x16x32_bf16 v[24:27], v[212:215], v[56:59], v[24:27]
  v_mfma_f32_16x16x32_bf16 v[52:55], v[212:215], v[60:63], v[52:55]
  ds_read_b128 v[56:59], v94 offset:6144
  ds_read_b128 v[60:63], v94 offset:20480
  s_waitcnt lgkmcnt(4)
  v_mfma_f32_16x16x32_bf16 v[0:3], a[16:19], v[64:67], v[0:3]
  s_add_u32 m0, s23, 4096
  s_add_u32 s30, s22, 4096
  buffer_load_dwordx4 v86, s[4:7], s30 offen offset:0 sc1 lds
  v_mfma_f32_16x16x32_bf16 v[28:31], a[16:19], v[68:71], v[28:31]
  v_mfma_f32_16x16x32_bf16 v[4:7], a[72:75], v[64:67], v[4:7]
  v_mfma_f32_16x16x32_bf16 v[32:35], a[72:75], v[68:71], v[32:35]
  v_mfma_f32_16x16x32_bf16 v[8:11], a[128:131], v[64:67], v[8:11]
  v_mfma_f32_16x16x32_bf16 v[36:39], a[128:131], v[68:71], v[36:39]
  v_mfma_f32_16x16x32_bf16 v[12:15], a[184:187], v[64:67], v[12:15]
  v_mfma_f32_16x16x32_bf16 v[40:43], a[184:187], v[68:71], v[40:43]
  v_mfma_f32_16x16x32_bf16 v[16:19], a[240:243], v[64:67], v[16:19]
  v_mfma_f32_16x16x32_bf16 v[44:47], a[240:243], v[68:71], v[44:47]
  v_mfma_f32_16x16x32_bf16 v[20:23], v[160:163], v[64:67], v[20:23]
  v_mfma_f32_16x16x32_bf16 v[48:51], v[160:163], v[68:71], v[48:51]
  v_mfma_f32_16x16x32_bf16 v[24:27], v[216:219], v[64:67], v[24:27]
  v_mfma_f32_16x16x32_bf16 v[52:55], v[216:219], v[68:71], v[52:55]
  ds_read_b128 v[64:67], v94 offset:7168
  ds_read_b128 v[68:71], v94 offset:21504
  s_waitcnt lgkmcnt(4)
  v_mfma_f32_16x16x32_bf16 v[0:3], a[20:23], v[72:75], v[0:3]
  buffer_load_dwordx4 v86, s[4:7], s30 offen offset:1024 sc1 lds
  v_mfma_f32_16x16x32_bf16 v[28:31], a[20:23], v[76:79], v[28:31]
  v_mfma_f32_16x16x32_bf16 v[4:7], a[76:79], v[72:75], v[4:7]
  v_mfma_f32_16x16x32_bf16 v[32:35], a[76:79], v[76:79], v[32:35]
  v_mfma_f32_16x16x32_bf16 v[8:11], a[132:135], v[72:75], v[8:11]
  v_mfma_f32_16x16x32_bf16 v[36:39], a[132:135], v[76:79], v[36:39]
  v_mfma_f32_16x16x32_bf16 v[12:15], a[188:191], v[72:75], v[12:15]
  v_mfma_f32_16x16x32_bf16 v[40:43], a[188:191], v[76:79], v[40:43]
  v_mfma_f32_16x16x32_bf16 v[16:19], a[244:247], v[72:75], v[16:19]
  v_mfma_f32_16x16x32_bf16 v[44:47], a[244:247], v[76:79], v[44:47]
  v_mfma_f32_16x16x32_bf16 v[20:23], v[164:167], v[72:75], v[20:23]
  v_mfma_f32_16x16x32_bf16 v[48:51], v[164:167], v[76:79], v[48:51]
  v_mfma_f32_16x16x32_bf16 v[24:27], v[220:223], v[72:75], v[24:27]
  v_mfma_f32_16x16x32_bf16 v[52:55], v[220:223], v[76:79], v[52:55]
  ds_read_b128 v[72:75], v94 offset:8192
  ds_read_b128 v[76:79], v94 offset:22528
  s_waitcnt lgkmcnt(4)
  v_mfma_f32_16x16x32_bf16 v[0:3], a[24:27], v[56:59], v[0:3]
  buffer_load_dwordx4 v86, s[4:7], s30 offen offset:2048 sc1 lds
  v_mfma_f32_16x16x32_bf16 v[28:31], a[24:27], v[60:63], v[28:31]
  v_mfma_f32_16x16x32_bf16 v[4:7], a[80:83], v[56:59], v[4:7]
  v_mfma_f32_16x16x32_bf16 v[32:35], a[80:83], v[60:63], v[32:35]
  v_mfma_f32_16x16x32_bf16 v[8:11], a[136:139], v[56:59], v[8:11]
  v_mfma_f32_16x16x32_bf16 v[36:39], a[136:139], v[60:63], v[36:39]
  v_mfma_f32_16x16x32_bf16 v[12:15], a[192:195], v[56:59], v[12:15]
  v_mfma_f32_16x16x32_bf16 v[40:43], a[192:195], v[60:63], v[40:43]
  v_mfma_f32_16x16x32_bf16 v[16:19], a[248:251], v[56:59], v[16:19]
  v_mfma_f32_16x16x32_bf16 v[44:47], a[248:251], v[60:63], v[44:47]
  v_mfma_f32_16x16x32_bf16 v[20:23], v[168:171], v[56:59], v[20:23]
  v_mfma_f32_16x16x32_bf16 v[48:51], v[168:171], v[60:63], v[48:51]
  v_mfma_f32_16x16x32_bf16 v[24:27], v[224:227], v[56:59], v[24:27]
  v_mfma_f32_16x16x32_bf16 v[52:55], v[224:227], v[60:63], v[52:55]
  ds_read_b128 v[56:59], v94 offset:9216
  ds_read_b128 v[60:63], v94 offset:23552
  s_waitcnt lgkmcnt(4)
  v_mfma_f32_16x16x32_bf16 v[0:3], a[28:31], v[64:67], v[0:3]
  s_mov_b32 m0, s19
  s_nop 0
  buffer_load_dwordx4 v86, s[4:7], s18 offen offset:0 sc1 lds
  v_mfma_f32_16x16x32_bf16 v[28:31], a[28:31], v[68:71], v[28:31]
  v_mfma_f32_16x16x32_bf16 v[4:7], a[84:87], v[64:67], v[4:7]
  v_mfma_f32_16x16x32_bf16 v[32:35], a[84:87], v[68:71], v[32:35]
  v_mfma_f32_16x16x32_bf16 v[8:11], a[140:143], v[64:67], v[8:11]
  v_mfma_f32_16x16x32_bf16 v[36:39], a[140:143], v[68:71], v[36:39]
  v_mfma_f32_16x16x32_bf16 v[12:15], a[196:199], v[64:67], v[12:15]
  v_mfma_f32_16x16x32_bf16 v[40:43], a[196:199], v[68:71], v[40:43]
  v_mfma_f32_16x16x32_bf16 v[16:19], a[252:255], v[64:67], v[16:19]
  v_mfma_f32_16x16x32_bf16 v[44:47], a[252:255], v[68:71], v[44:47]
  v_mfma_f32_16x16x32_bf16 v[20:23], v[172:175], v[64:67], v[20:23]
  v_mfma_f32_16x16x32_bf16 v[48:51], v[172:175], v[68:71], v[48:51]
  v_mfma_f32_16x16x32_bf16 v[24:27], v[228:231], v[64:67], v[24:27]
  v_mfma_f32_16x16x32_bf16 v[52:55], v[228:231], v[68:71], v[52:55]
  ds_read_b128 v[64:67], v94 offset:10240
  ds_read_b128 v[68:71], v94 offset:24576
  s_waitcnt lgkmcnt(4)
  v_mfma_f32_16x16x32_bf16 v[0:3], a[32:35], v[72:75], v[0:3]
  buffer_load_dwordx4 v86, s[4:7], s18 offen offset:1024 sc1 lds
  v_mfma_f32_16x16x32_bf16 v[28:31], a[32:35], v[76:79], v[28:31]
  v_mfma_f32_16x16x32_bf16 v[4:7], a[88:91], v[72:75], v[4:7]
  v_mfma_f32_16x16x32_bf16 v[32:35], a[88:91], v[76:79], v[32:35]
  v_mfma_f32_16x16x32_bf16 v[8:11], a[144:147], v[72:75], v[8:11]
  v_mfma_f32_16x16x32_bf16 v[36:39], a[144:147], v[76:79], v[36:39]
  v_mfma_f32_16x16x32_bf16 v[12:15], a[200:203], v[72:75], v[12:15]
  v_mfma_f32_16x16x32_bf16 v[40:43], a[200:203], v[76:79], v[40:43]
  v_mfma_f32_16x16x32_bf16 v[16:19], v[120:123], v[72:75], v[16:19]
  v_mfma_f32_16x16x32_bf16 v[44:47], v[120:123], v[76:79], v[44:47]
  v_mfma_f32_16x16x32_bf16 v[20:23], v[176:179], v[72:75], v[20:23]
  v_mfma_f32_16x16x32_bf16 v[48:51], v[176:179], v[76:79], v[48:51]
  v_mfma_f32_16x16x32_bf16 v[24:27], v[232:235], v[72:75], v[24:27]
  v_mfma_f32_16x16x32_bf16 v[52:55], v[232:235], v[76:79], v[52:55]
  ds_read_b128 v[72:75], v94 offset:11264
  ds_read_b128 v[76:79], v94 offset:25600
  s_waitcnt lgkmcnt(4)
  v_mfma_f32_16x16x32_bf16 v[0:3], a[36:39], v[56:59], v[0:3]
  buffer_load_dwordx4 v86, s[4:7], s18 offen offset:2048 sc1 lds
  v_mfma_f32_16x16x32_bf16 v[28:31], a[36:39], v[60:63], v[28:31]
  v_mfma_f32_16x16x32_bf16 v[4:7], a[92:95], v[56:59], v[4:7]
  v_mfma_f32_16x16x32_bf16 v[32:35], a[92:95], v[60:63], v[32:35]
  v_mfma_f32_16x16x32_bf16 v[8:11], a[148:151], v[56:59], v[8:11]
  v_mfma_f32_16x16x32_bf16 v[36:39], a[148:151], v[60:63], v[36:39]
  v_mfma_f32_16x16x32_bf16 v[12:15], a[204:207], v[56:59], v[12:15]
  v_mfma_f32_16x16x32_bf16 v[40:43], a[204:207], v[60:63], v[40:43]
  v_mfma_f32_16x16x32_bf16 v[16:19], v[124:127], v[56:59], v[16:19]
  v_mfma_f32_16x16x32_bf16 v[44:47], v[124:127], v[60:63], v[44:47]
  v_mfma_f32_16x16x32_bf16 v[20:23], v[180:183], v[56:59], v[20:23]
  v_mfma_f32_16x16x32_bf16 v[48:51], v[180:183], v[60:63], v[48:51]
  v_mfma_f32_16x16x32_bf16 v[24:27], v[236:239], v[56:59], v[24:27]
  v_mfma_f32_16x16x32_bf16 v[52:55], v[236:239], v[60:63], v[52:55]
  ds_read_b128 v[56:59], v94 offset:12288
  ds_read_b128 v[60:63], v94 offset:26624
  s_waitcnt lgkmcnt(4)
  v_mfma_f32_16x16x32_bf16 v[0:3], a[40:43], v[64:67], v[0:3]
  buffer_load_dwordx4 v86, s[4:7], s18 offen offset:3072 sc1 lds
  v_mfma_f32_16x16x32_bf16 v[28:31], a[40:43], v[68:71], v[28:31]
  v_mfma_f32_16x16x32_bf16 v[4:7], a[96:99], v[64:67], v[4:7]
  v_mfma_f32_16x16x32_bf16 v[32:35], a[96:99], v[68:71], v[32:35]
  v_mfma_f32_16x16x32_bf16 v[8:11], a[152:155], v[64:67], v[8:11]
  v_mfma_f32_16x16x32_bf16 v[36:39], a[152:155], v[68:71], v[36:39]
  v_mfma_f32_16x16x32_bf16 v[12:15], a[208:211], v[64:67], v[12:15]
  v_mfma_f32_16x16x32_bf16 v[40:43], a[208:211], v[68:71], v[40:43]
  v_mfma_f32_16x16x32_bf16 v[16:19], v[128:131], v[64:67], v[16:19]
  v_mfma_f32_16x16x32_bf16 v[44:47], v[128:131], v[68:71], v[44:47]
  v_mfma_f32_16x16x32_bf16 v[20:23], v[184:187], v[64:67], v[20:23]
  v_mfma_f32_16x16x32_bf16 v[48:51], v[184:187], v[68:71], v[48:51]
  v_mfma_f32_16x16x32_bf16 v[24:27], v[240:243], v[64:67], v[24:27]
  v_mfma_f32_16x16x32_bf16 v[52:55], v[240:243], v[68:71], v[52:55]
  ds_read_b128 v[64:67], v94 offset:13312
  ds_read_b128 v[68:71], v94 offset:27648
  s_waitcnt lgkmcnt(4)
  v_mfma_f32_16x16x32_bf16 v[0:3], a[44:47], v[72:75], v[0:3]
  s_add_u32 m0, s19, 4096
  s_add_u32 s30, s18, 4096
  buffer_load_dwordx4 v86, s[4:7], s30 offen offset:0 sc1 lds
  v_mfma_f32_16x16x32_bf16 v[28:31], a[44:47], v[76:79], v[28:31]
  v_mfma_f32_16x16x32_bf16 v[4:7], a[100:103], v[72:75], v[4:7]
  v_mfma_f32_16x16x32_bf16 v[32:35], a[100:103], v[76:79], v[32:35]
  v_mfma_f32_16x16x32_bf16 v[8:11], a[156:159], v[72:75], v[8:11]
  v_mfma_f32_16x16x32_bf16 v[36:39], a[156:159], v[76:79], v[36:39]
  v_mfma_f32_16x16x32_bf16 v[12:15], a[212:215], v[72:75], v[12:15]
  v_mfma_f32_16x16x32_bf16 v[40:43], a[212:215], v[76:79], v[40:43]
  v_mfma_f32_16x16x32_bf16 v[16:19], v[132:135], v[72:75], v[16:19]
  v_mfma_f32_16x16x32_bf16 v[44:47], v[132:135], v[76:79], v[44:47]
  v_mfma_f32_16x16x32_bf16 v[20:23], v[188:191], v[72:75], v[20:23]
  v_mfma_f32_16x16x32_bf16 v[48:51], v[188:191], v[76:79], v[48:51]
  v_mfma_f32_16x16x32_bf16 v[24:27], v[244:247], v[72:75], v[24:27]
  v_mfma_f32_16x16x32_bf16 v[52:55], v[244:247], v[76:79], v[52:55]
  s_waitcnt lgkmcnt(2)
  v_mfma_f32_16x16x32_bf16 v[0:3], a[48:51], v[56:59], v[0:3]
  buffer_load_dwordx4 v86, s[4:7], s30 offen offset:1024 sc1 lds
  v_mfma_f32_16x16x32_bf16 v[28:31], a[48:51], v[60:63], v[28:31]
  v_mfma_f32_16x16x32_bf16 v[4:7], a[104:107], v[56:59], v[4:7]
  v_mfma_f32_16x16x32_bf16 v[32:35], a[104:107], v[60:63], v[32:35]
  v_mfma_f32_16x16x32_bf16 v[8:11], a[160:163], v[56:59], v[8:11]
  v_mfma_f32_16x16x32_bf16 v[36:39], a[160:163], v[60:63], v[36:39]
  v_mfma_f32_16x16x32_bf16 v[12:15], a[216:219], v[56:59], v[12:15]
  v_mfma_f32_16x16x32_bf16 v[40:43], a[216:219], v[60:63], v[40:43]
  v_mfma_f32_16x16x32_bf16 v[16:19], v[136:139], v[56:59], v[16:19]
  v_mfma_f32_16x16x32_bf16 v[44:47], v[136:139], v[60:63], v[44:47]
  v_mfma_f32_16x16x32_bf16 v[20:23], v[192:195], v[56:59], v[20:23]
  v_mfma_f32_16x16x32_bf16 v[48:51], v[192:195], v[60:63], v[48:51]
  v_mfma_f32_16x16x32_bf16 v[24:27], v[248:251], v[56:59], v[24:27]
  v_mfma_f32_16x16x32_bf16 v[52:55], v[248:251], v[60:63], v[52:55]
  s_waitcnt lgkmcnt(0)
  v_mfma_f32_16x16x32_bf16 v[0:3], a[52:55], v[64:67], v[0:3]
  buffer_load_dwordx4 v86, s[4:7], s30 offen offset:2048 sc1 lds
  v_mfma_f32_16x16x32_bf16 v[28:31], a[52:55], v[68:71], v[28:31]
  v_mfma_f32_16x16x32_bf16 v[4:7], a[108:111], v[64:67], v[4:7]
  v_mfma_f32_16x16x32_bf16 v[32:35], a[108:111], v[68:71], v[32:35]
  v_mfma_f32_16x16x32_bf16 v[8:11], a[164:167], v[64:67], v[8:11]
  v_mfma_f32_16x16x32_bf16 v[36:39], a[164:167], v[68:71], v[36:39]
  v_mfma_f32_16x16x32_bf16 v[12:15], a[220:223], v[64:67], v[12:15]
  v_mfma_f32_16x16x32_bf16 v[40:43], a[220:223], v[68:71], v[40:43]
  v_mfma_f32_16x16x32_bf16 v[16:19], v[140:143], v[64:67], v[16:19]
  v_mfma_f32_16x16x32_bf16 v[44:47], v[140:143], v[68:71], v[44:47]
  v_mfma_f32_16x16x32_bf16 v[20:23], v[196:199], v[64:67], v[20:23]
  v_mfma_f32_16x16x32_bf16 v[48:51], v[196:199], v[68:71], v[48:51]
  v_mfma_f32_16x16x32_bf16 v[24:27], v[252:255], v[64:67], v[24:27]
  v_mfma_f32_16x16x32_bf16 v[52:55], v[252:255], v[68:71], v[52:55]
  s_cmp_ge_u32 s19, 28672
  s_cselect_b32 s31, 28672, 0
  v_add_u32 v94, s31, v86
  s_waitcnt vmcnt(7)
  ds_read_b128 v[56:59], v95 offset:0
  ds_read_b128 v[60:63], v95 offset:3072
  ds_read_b128 v[64:67], v95 offset:1024
  ds_read_b128 v[68:71], v95 offset:4096
  v_cvt_pk_bf16_f32 v0, v0, v1
  v_cvt_pk_bf16_f32 v1, v2, v3
  v_cvt_pk_bf16_f32 v2, v4, v5
  v_cvt_pk_bf16_f32 v3, v6, v7
  v_cvt_pk_bf16_f32 v28, v28, v29
  v_cvt_pk_bf16_f32 v29, v30, v31
  v_cvt_pk_bf16_f32 v30, v32, v33
  v_cvt_pk_bf16_f32 v31, v34, v35
  v_cvt_pk_bf16_f32 v8, v8, v9
  v_cvt_pk_bf16_f32 v9, v10, v11
  v_cvt_pk_bf16_f32 v10, v12, v13
  v_cvt_pk_bf16_f32 v11, v14, v15
  v_cvt_pk_bf16_f32 v36, v36, v37
  v_cvt_pk_bf16_f32 v37, v38, v39
  v_cvt_pk_bf16_f32 v38, v40, v41
  v_cvt_pk_bf16_f32 v39, v42, v43
  v_cvt_pk_bf16_f32 v16, v16, v17
  v_cvt_pk_bf16_f32 v17, v18, v19
  v_cvt_pk_bf16_f32 v18, v20, v21
  v_cvt_pk_bf16_f32 v19, v22, v23
  v_cvt_pk_bf16_f32 v44, v44, v45
  v_cvt_pk_bf16_f32 v45, v46, v47
  v_cvt_pk_bf16_f32 v46, v48, v49
  v_cvt_pk_bf16_f32 v47, v50, v51
  v_cvt_pk_bf16_f32 v24, v24, v25
  v_cvt_pk_bf16_f32 v25, v26, v27
  v_cvt_pk_bf16_f32 v52, v52, v53
  v_cvt_pk_bf16_f32 v53, v54, v55
  v_mov_b32 v26, 0
  v_mov_b32 v27, 0
  v_mov_b32 v54, 0
  v_mov_b32 v55, 0
  s_waitcnt lgkmcnt(2)
  v_mfma_f32_16x16x32_bf16 v[4:7], v[56:59], v[0:3], 0
  v_mfma_f32_16x16x32_bf16 v[32:35], v[56:59], v[28:31], 0
  v_mfma_f32_16x16x32_bf16 v[12:15], v[60:63], v[0:3], 0
  v_mfma_f32_16x16x32_bf16 v[40:43], v[60:63], v[28:31], 0
  ds_read_b128 v[56:59], v95 offset:2048
  ds_read_b128 v[60:63], v95 offset:5120
  s_waitcnt lgkmcnt(2)
  v_mfma_f32_16x16x32_bf16 v[4:7], v[64:67], v[8:11], v[4:7]
  v_mfma_f32_16x16x32_bf16 v[32:35], v[64:67], v[36:39], v[32:35]
  v_mfma_f32_16x16x32_bf16 v[12:15], v[68:71], v[8:11], v[12:15]
  v_mfma_f32_16x16x32_bf16 v[40:43], v[68:71], v[36:39], v[40:43]
  ds_read_b128 v[64:67], v95 offset:6144
  s_waitcnt lgkmcnt(1)
  v_mfma_f32_16x16x32_bf16 v[4:7], v[56:59], v[16:19], v[4:7]
  v_mfma_f32_16x16x32_bf16 v[32:35], v[56:59], v[44:47], v[32:35]
  v_mfma_f32_16x16x32_bf16 v[12:15], v[60:63], v[16:19], v[12:15]
  v_mfma_f32_16x16x32_bf16 v[40:43], v[60:63], v[44:47], v[40:43]
  s_waitcnt lgkmcnt(0)
  v_mfma_f32_16x16x32_bf16 v[4:7], v[64:67], v[24:27], v[4:7]
  v_mfma_f32_16x16x32_bf16 v[32:35], v[64:67], v[52:55], v[32:35]
  v_mfma_f32_16x16x32_bf16 v[12:15], v[66:69], v[24:27], v[12:15]
  v_mfma_f32_16x16x32_bf16 v[40:43], v[66:69], v[52:55], v[40:43]
  s_nop 4
  ds_write_b128 v90, v[4:7] offset:0
  s_nop 0
  ds_write_b128 v90, v[12:15] offset:1024
  ds_write_b128 v90, v[32:35] offset:3072
  ds_write_b128 v90, v[40:43] offset:4096
  s_mov_b32 s28, 0
L_poll_72:
  buffer_load_dwordx4 v[72:75], v88, s[4:7], s24 offen offset:0 sc1
  buffer_load_dwordx4 v[76:79], v88, s[4:7], s24 offen offset:512 sc1
  buffer_load_dwordx4 v[80:83], v88, s[4:7], s24 offen offset:1024 sc1
  buffer_load_dwordx2 v[84:85], v89, s[4:7], s24 offen offset:0 sc1
  s_add_u32 s28, s28, 1
  s_cmp_gt_u32 s28, 400000
  s_cbranch_scc1 L_fail
  s_waitcnt vmcnt(0)
  v_max3_u32 v110, v72, v73, v74
  v_max3_u32 v110, v110, v75, v76
  v_max3_u32 v110, v110, v77, v78
  v_max3_u32 v110, v110, v79, v80
  v_max3_u32 v110, v110, v81, v82
  v_max3_u32 v110, v110, v83, v84
  v_max_u32 v110, v110, v85
  v_cmp_eq_u32 vcc, -1, v110
  s_cbranch_vccnz L_poll_72
  v_mfma_f32_16x16x32_bf16 v[20:23], v[72:75], v[0:3], 0
  v_mfma_f32_16x16x32_bf16 v[48:51], v[72:75], v[28:31], 0
  v_mfma_f32_16x16x32_bf16 v[20:23], v[76:79], v[8:11], v[20:23]
  v_mfma_f32_16x16x32_bf16 v[48:51], v[76:79], v[36:39], v[48:51]
  v_mfma_f32_16x16x32_bf16 v[20:23], v[80:83], v[16:19], v[20:23]
  v_mfma_f32_16x16x32_bf16 v[48:51], v[80:83], v[44:47], v[48:51]
  v_mfma_f32_16x16x32_bf16 v[20:23], v[84:87], v[24:27], v[20:23]
  v_mfma_f32_16x16x32_bf16 v[48:51], v[84:87], v[52:55], v[48:51]
  s_nop 6
  ds_write_b128 v90, v[20:23] offset:2048
  ds_write_b128 v90, v[48:51] offset:5120
  s_waitcnt lgkmcnt(0)
  s_barrier
  s_cmp_lt_u32 s8, 2
  s_cbranch_scc0 L_twskip_73
  ds_read_b128 v[0:3], v91 offset:0
  ds_read_b128 v[4:7], v91 offset:512
  ds_read_b64 v[8:9], v92 offset:0
  ds_read_b128 v[12:15], v91 offset:6144
  ds_read_b128 v[16:19], v91 offset:6656
  ds_read_b64 v[20:21], v92 offset:6144
  ds_read_b128 v[24:27], v91 offset:12288
  ds_read_b128 v[28:31], v91 offset:12800
  ds_read_b64 v[32:33], v92 offset:12288
  ds_read_b128 v[36:39], v91 offset:18432
  ds_read_b128 v[40:43], v91 offset:18944
  ds_read_b64 v[44:45], v92 offset:18432
  s_waitcnt lgkmcnt(0)
  v_pk_add_f32 v[0:1], v[0:1], v[12:13]
  v_pk_add_f32 v[2:3], v[2:3], v[14:15]
  v_pk_add_f32 v[4:5], v[4:5], v[16:17]
  v_pk_add_f32 v[6:7], v[6:7], v[18:19]
  v_pk_add_f32 v[8:9], v[8:9], v[20:21]
  v_pk_add_f32 v[24:25], v[24:25], v[36:37]
  v_pk_add_f32 v[26:27], v[26:27], v[38:39]
  v_pk_add_f32 v[28:29], v[28:29], v[40:41]
  v_pk_add_f32 v[30:31], v[30:31], v[42:43]
  v_pk_add_f32 v[32:33], v[32:33], v[44:45]
  v_pk_add_f32 v[0:1], v[0:1], v[24:25]
  v_pk_add_f32 v[2:3], v[2:3], v[26:27]
  v_pk_add_f32 v[4:5], v[4:5], v[28:29]
  v_pk_add_f32 v[6:7], v[6:7], v[30:31]
  v_pk_add_f32 v[8:9], v[8:9], v[32:33]
  v_mov_b32 v13, 0xff800000
  v_cndmask_b32 v0, v13, v0, s[44:45]
  v_cndmask_b32 v1, v13, v1, s[46:47]
  v_cndmask_b32 v2, v13, v2, s[48:49]
  v_cndmask_b32 v3, v13, v3, s[50:51]
  v_cndmask_b32 v4, v13, v4, s[52:53]
  v_cndmask_b32 v5, v13, v5, s[54:55]
  v_cndmask_b32 v6, v13, v6, s[56:57]
  v_cndmask_b32 v7, v13, v7, s[58:59]
  v_max3_f32 v12, v0, v1, v2
  v_max3_f32 v12, v12, v3, v4
  v_max3_f32 v12, v12, v5, v6
  v_max3_f32 v12, v12, v7, v8
  v_max_f32 v12, v12, v9
  v_mov_b32 v13, v12
  s_nop 1
  v_permlane16_swap_b32 v12, v13
  v_max_f32 v12, v12, v13
  v_mov_b32 v13, v12
  s_nop 1
  v_permlane32_swap_b32 v12, v13
  v_max_f32 v12, v12, v13
  v_sub_f32 v0, v0, v12
  v_sub_f32 v1, v1, v12
  v_sub_f32 v2, v2, v12
  v_sub_f32 v3, v3, v12
  v_sub_f32 v4, v4, v12
  v_sub_f32 v5, v5, v12
  v_sub_f32 v6, v6, v12
  v_sub_f32 v7, v7, v12
  v_sub_f32 v8, v8, v12
  v_sub_f32 v9, v9, v12
  v_exp_f32 v0, v0
  v_exp_f32 v1, v1
  v_exp_f32 v2, v2
  v_exp_f32 v3, v3
  v_exp_f32 v4, v4
  v_exp_f32 v5, v5
  v_exp_f32 v6, v6
  v_exp_f32 v7, v7
  v_exp_f32 v8, v8
  v_exp_f32 v9, v9
  v_add_f32 v12, v0, v1
  v_add_f32 v12, v12, v2
  v_add_f32 v12, v12, v3
  v_add_f32 v12, v12, v4
  v_add_f32 v12, v12, v5
  v_add_f32 v12, v12, v6
  v_add_f32 v12, v12, v7
  v_add_f32 v12, v12, v8
  v_add_f32 v12, v12, v9
  v_mov_b32 v13, v12
  s_nop 1
  v_permlane16_swap_b32 v12, v13
  v_add_f32 v12, v12, v13
  v_mov_b32 v13, v12
  s_nop 1
  v_permlane32_swap_b32 v12, v13
  v_add_f32 v12, v12, v13
  v_rcp_f32 v12, v12
  s_nop 0
  v_mul_f32 v0, v0, v12
  v_mul_f32 v1, v1, v12
  v_mul_f32 v2, v2, v12
  v_mul_f32 v3, v3, v12
  v_mul_f32 v4, v4, v12
  v_mul_f32 v5, v5, v12
  v_mul_f32 v6, v6, v12
  v_mul_f32 v7, v7, v12
  v_mul_f32 v8, v8, v12
  v_mul_f32 v9, v9, v12
  v_cvt_pk_bf16_f32 v16, v0, v1
  v_cvt_pk_bf16_f32 v17, v4, v5
  v_cvt_pk_bf16_f32 v18, v2, v3
  v_cvt_pk_bf16_f32 v19, v6, v7
  v_cvt_pk_bf16_f32 v20, v8, v9
  v_min_u32 v16, -2, v16
  v_min_u32 v17, -2, v17
  v_min_u32 v18, -2, v18
  v_min_u32 v19, -2, v19
  v_min_u32 v20, -2, v20
  buffer_store_dwordx4 v[16:19], v86, s[4:7], s20 offen sc1
  buffer_store_dword v20, v93, s[4:7], s20 offen sc1
L_twskip_73:
  s_add_u32 s22, s22, 86016
  s_add_u32 s20, s20, 122880
  s_add_u32 s24, s24, 24576
  s_add_u32 s17, s17, 3
  s_cmp_lt_u32 s17, 64
  s_cbranch_scc1 L_tw_71
  s_branch L_fin_20
L_UW_39:
  s_sub_u32 s9, s9, 108
  s_lshr_b32 s16, s9, 1
  s_and_b32 s17, s9, 1
  v_mbcnt_lo_u32_b32 v67, -1, 0
  v_mbcnt_hi_u32_b32 v67, -1, v67
  v_lshlrev_b32 v65, 4, v67
  v_lshlrev_b32 v66, 3, v67
  v_mov_b32 v72, s12
  v_mov_b32 v73, s13
  v_cmp_eq_u32 vcc, 0, v67
  v_mov_b32 v74, 0x80000000
  s_nop 0
  v_cndmask_b32 v74, v74, 0, vcc
  v_and_b32 v76, 8, v67
  v_mov_b32 v64, 0x44444444
  v_mov_b32 v77, 0xeeeeeeee
  v_cmp_ne_u32 vcc, 0, v76
  s_nop 1
  v_cndmask_b32 v64, v64, v77, vcc
  s_lshl_b32 s30, s8, 10
  v_add_u32 v68, s30, v65
  s_add_u32 s30, s8, 4
  s_min_u32 s30, s30, 6
  s_lshl_b32 s30, s30, 10
  v_add_u32 v69, s30, v65
  v_and_b32 v76, 15, v67
  v_lshlrev_b32 v70, 3, v76
  v_bfe_u32 v76, v67, 4, 1
  v_lshl_add_u32 v70, v76, 7, v70
  v_lshrrev_b32 v76, 5, v67
  v_lshl_add_u32 v70, v76, 2, v70
  s_lshl_b32 s30, s17, 4
  s_add_u32 s30, s30, s16
  s_lshl_b32 s31, s30, 2
  s_add_u32 s31, s31, s8
  s_mul_i32 s30, s31, 1792
  s_add_u32 s19, s30, 46137344
  s_mul_i32 s30, s17, 8192
  s_add_u32 s18, s30, 66584576
  s_add_u32 s23, s16, 16
  s_mov_b32 s29, 68200448
  s_mov_b32 s28, 0
  s_branch L_wf0_75
L_wf_74:
  s_sleep 8
L_wf0_75:
  buffer_load_dwordx2 v[76:77], v66, s[4:7], s29 offen offset:0 sc1
  s_add_u32 s28, s28, 1
  s_cmp_gt_u32 s28, 2000000
  s_cbranch_scc1 L_fail
  s_waitcnt vmcnt(0)
  v_xor_b32 v76, s12, v76
  v_xor_b32 v77, s13, v77
  v_or_b32 v76, v76, v77
  v_cmp_ne_u32 vcc, 0, v76
  s_cbranch_vccnz L_wf_74
  v_mov_b32 v76, 0x80000000
  v_cmp_gt_u32 vcc, 48, v67
  s_nop 1
  v_cndmask_b32 v78, v76, v65, vcc
  v_mov_b32 v0, -1
  v_mov_b32 v1, -1
  v_mov_b32 v2, -1
  v_mov_b32 v3, -1
  s_mov_b32 s30, s19
L_poi_76:
  buffer_store_dwordx4 v[0:3], v65, s[4:7], s30 offen offset:0 sc1
  buffer_store_dwordx4 v[0:3], v78, s[4:7], s30 offen offset:1024 sc1
  s_add_u32 s30, s30, 229376
  s_cmp_lt_u32 s30, 53477376
  s_cbranch_scc1 L_poi_76
  s_add_u32 s30, s9, 48
  s_lshl_b32 s30, s30, 2
  s_add_u32 s30, s30, s8
  s_lshl_b32 s30, s30, 3
  s_add_u32 s25, s30, 68222976
  s_mul_i32 s26, s23, 448
  s_add_u32 s26, s26, 68419584
  s_mov_b32 exec_lo, 0xffffffff
  s_mov_b32 exec_hi, 0xffffff
  s_mov_b32 s28, 0
  s_branch L_wf0_78
L_wf_77:
  s_sleep 2
L_wf0_78:
  buffer_load_dwordx2 v[76:77], v66, s[4:7], s26 offen offset:0 sc1
  s_add_u32 s28, s28, 1
  s_cmp_gt_u32 s28, 2000000
  s_cbranch_scc1 L_fail
  s_waitcnt vmcnt(0)
  v_xor_b32 v76, s12, v76
  v_xor_b32 v77, s13, v77
  v_or_b32 v76, v76, v77
  v_cmp_ne_u32 vcc, 0, v76
  s_cbranch_vccnz L_wf_77
  s_mov_b64 exec, -1
  s_mul_i32 s31, s23, 401408
  s_mul_i32 s30, s8, 100352
  s_add_u32 s31, s31, s30
  s_add_u32 s27, s31, 0
  s_add_u32 s26, s26, 14336
  s_add_u32 s30, s27, 0
  buffer_load_dwordx4 a[0:3], v65, s[4:7], s30 offen sc1
  s_add_u32 s30, s27, 14336
  buffer_load_dwordx4 a[56:59], v65, s[4:7], s30 offen sc1
  s_add_u32 s30, s27, 28672
  buffer_load_dwordx4 a[112:115], v65, s[4:7], s30 offen sc1
  s_add_u32 s30, s27, 43008
  buffer_load_dwordx4 a[168:171], v65, s[4:7], s30 offen sc1
  s_add_u32 s30, s27, 57344
  buffer_load_dwordx4 a[224:227], v65, s[4:7], s30 offen sc1
  s_add_u32 s30, s27, 71680
  buffer_load_dwordx4 v[144:147], v65, s[4:7], s30 offen sc1
  s_add_u32 s30, s27, 86016
  buffer_load_dwordx4 v[200:203], v65, s[4:7], s30 offen sc1
  s_add_u32 s30, s27, 1024
  buffer_load_dwordx4 a[4:7], v65, s[4:7], s30 offen sc1
  s_add_u32 s30, s27, 15360
  buffer_load_dwordx4 a[60:63], v65, s[4:7], s30 offen sc1
  s_add_u32 s30, s27, 29696
  buffer_load_dwordx4 a[116:119], v65, s[4:7], s30 offen sc1
  s_add_u32 s30, s27, 44032
  buffer_load_dwordx4 a[172:175], v65, s[4:7], s30 offen sc1
  s_add_u32 s30, s27, 58368
  buffer_load_dwordx4 a[228:231], v65, s[4:7], s30 offen sc1
  s_add_u32 s30, s27, 72704
  buffer_load_dwordx4 v[148:151], v65, s[4:7], s30 offen sc1
  s_add_u32 s30, s27, 87040
  buffer_load_dwordx4 v[204:207], v65, s[4:7], s30 offen sc1
  s_add_u32 s30, s27, 2048
  buffer_load_dwordx4 a[8:11], v65, s[4:7], s30 offen sc1
  s_add_u32 s30, s27, 16384
  buffer_load_dwordx4 a[64:67], v65, s[4:7], s30 offen sc1
  s_add_u32 s30, s27, 30720
  buffer_load_dwordx4 a[120:123], v65, s[4:7], s30 offen sc1
  s_add_u32 s30, s27, 45056
  buffer_load_dwordx4 a[176:179], v65, s[4:7], s30 offen sc1
  s_add_u32 s30, s27, 59392
  buffer_load_dwordx4 a[232:235], v65, s[4:7], s30 offen sc1
  s_add_u32 s30, s27, 73728
  buffer_load_dwordx4 v[152:155], v65, s[4:7], s30 offen sc1
  s_add_u32 s30, s27, 88064
  buffer_load_dwordx4 v[208:211], v65, s[4:7], s30 offen sc1
  s_add_u32 s30, s27, 3072
  buffer_load_dwordx4 a[12:15], v65, s[4:7], s30 offen sc1
  s_add_u32 s30, s27, 17408
  buffer_load_dwordx4 a[68:71], v65, s[4:7], s30 offen sc1
  s_add_u32 s30, s27, 31744
  buffer_load_dwordx4 a[124:127], v65, s[4:7], s30 offen sc1
  s_add_u32 s30, s27, 46080
  buffer_load_dwordx4 a[180:183], v65, s[4:7], s30 offen sc1
  s_add_u32 s30, s27, 60416
  buffer_load_dwordx4 a[236:239], v65, s[4:7], s30 offen sc1
  s_add_u32 s30, s27, 74752
  buffer_load_dwordx4 v[156:159], v65, s[4:7], s30 offen sc1
  s_add_u32 s30, s27, 89088
  buffer_load_dwordx4 v[212:215], v65, s[4:7], s30 offen sc1
  buffer_load_dwordx2 v[76:77], v66, s[4:7], s26 offen sc1
  s_add_u32 s30, s27, 7168
  buffer_load_dwordx4 a[28:31], v65, s[4:7], s30 offen sc1
  s_add_u32 s30, s27, 21504
  buffer_load_dwordx4 a[84:87], v65, s[4:7], s30 offen sc1
  s_add_u32 s30, s27, 35840
  buffer_load_dwordx4 a[140:143], v65, s[4:7], s30 offen sc1
  s_add_u32 s30, s27, 50176
  buffer_load_dwordx4 a[196:199], v65, s[4:7], s30 offen sc1
  s_add_u32 s30, s27, 64512
  buffer_load_dwordx4 a[252:255], v65, s[4:7], s30 offen sc1
  s_add_u32 s30, s27, 78848
  buffer_load_dwordx4 v[172:175], v65, s[4:7], s30 offen sc1
  s_add_u32 s30, s27, 93184
  buffer_load_dwordx4 v[228:231], v65, s[4:7], s30 offen sc1
  s_add_u32 s30, s27, 8192
  buffer_load_dwordx4 a[32:35], v65, s[4:7], s30 offen sc1
  s_add_u32 s30, s27, 22528
  buffer_load_dwordx4 a[88:91], v65, s[4:7], s30 offen sc1
  s_add_u32 s30, s27, 36864
  buffer_load_dwordx4 a[144:147], v65, s[4:7], s30 offen sc1
  s_add_u32 s30, s27, 51200
  buffer_load_dwordx4 a[200:203], v65, s[4:7], s30 offen sc1
  s_add_u32 s30, s27, 65536
  buffer_load_dwordx4 v[120:123], v65, s[4:7], s30 offen sc1
  s_add_u32 s30, s27, 79872
  buffer_load_dwordx4 v[176:179], v65, s[4:7], s30 offen sc1
  s_add_u32 s30, s27, 94208
  buffer_load_dwordx4 v[232:235], v65, s[4:7], s30 offen sc1
  s_add_u32 s30, s27, 9216
  buffer_load_dwordx4 a[36:39], v65, s[4:7], s30 offen sc1
  s_add_u32 s30, s27, 23552
  buffer_load_dwordx4 a[92:95], v65, s[4:7], s30 offen sc1
  s_add_u32 s30, s27, 37888
  buffer_load_dwordx4 a[148:151], v65, s[4:7], s30 offen sc1
  s_add_u32 s30, s27, 52224
  buffer_load_dwordx4 a[204:207], v65, s[4:7], s30 offen sc1
  s_add_u32 s30, s27, 66560
  buffer_load_dwordx4 v[124:127], v65, s[4:7], s30 offen sc1
  s_add_u32 s30, s27, 80896
  buffer_load_dwordx4 v[180:183], v65, s[4:7], s30 offen sc1
  s_add_u32 s30, s27, 95232
  buffer_load_dwordx4 v[236:239], v65, s[4:7], s30 offen sc1
  s_add_u32 s30, s27, 10240
  buffer_load_dwordx4 a[40:43], v65, s[4:7], s30 offen sc1
  s_add_u32 s30, s27, 24576
  buffer_load_dwordx4 a[96:99], v65, s[4:7], s30 offen sc1
  s_add_u32 s30, s27, 38912
  buffer_load_dwordx4 a[152:155], v65, s[4:7], s30 offen sc1
  s_add_u32 s30, s27, 53248
  buffer_load_dwordx4 a[208:211], v65, s[4:7], s30 offen sc1
  s_add_u32 s30, s27, 67584
  buffer_load_dwordx4 v[128:131], v65, s[4:7], s30 offen sc1
  s_add_u32 s30, s27, 81920
  buffer_load_dwordx4 v[184:187], v65, s[4:7], s30 offen sc1
  s_add_u32 s30, s27, 96256
  buffer_load_dwordx4 v[240:243], v65, s[4:7], s30 offen sc1
  s_waitcnt vmcnt(28)
  s_mov_b32 exec_lo, 0xffffffff
  s_mov_b32 exec_hi, 0xffffff
  v_xor_b32 v76, s12, v76
  v_xor_b32 v77, s13, v77
  v_or_b32 v76, v76, v77
  v_cmp_ne_u32 vcc, 0, v76
  s_mov_b64 exec, -1
  s_cbranch_vccz L_fok_79
  s_mov_b32 exec_lo, 0xffffffff
  s_mov_b32 exec_hi, 0xffffff
  s_mov_b32 s28, 0
  s_branch L_wf0_81
L_wf_80:
  s_sleep 1
L_wf0_81:
  buffer_load_dwordx2 v[76:77], v66, s[4:7], s26 offen offset:0 sc1
  s_add_u32 s28, s28, 1
  s_cmp_gt_u32 s28, 2000000
  s_cbranch_scc1 L_fail
  s_waitcnt vmcnt(0)
  v_xor_b32 v76, s12, v76
  v_xor_b32 v77, s13, v77
  v_or_b32 v76, v76, v77
  v_cmp_ne_u32 vcc, 0, v76
  s_cbranch_vccnz L_wf_80
  s_mov_b64 exec, -1
L_fok_79:
  s_add_u32 s30, s27, 4096
  buffer_load_dwordx4 a[16:19], v65, s[4:7], s30 offen sc1
  s_add_u32 s30, s27, 18432
  buffer_load_dwordx4 a[72:75], v65, s[4:7], s30 offen sc1
  s_add_u32 s30, s27, 32768
  buffer_load_dwordx4 a[128:131], v65, s[4:7], s30 offen sc1
  s_add_u32 s30, s27, 47104
  buffer_load_dwordx4 a[184:187], v65, s[4:7], s30 offen sc1
  s_add_u32 s30, s27, 61440
  buffer_load_dwordx4 a[240:243], v65, s[4:7], s30 offen sc1
  s_add_u32 s30, s27, 75776
  buffer_load_dwordx4 v[160:163], v65, s[4:7], s30 offen sc1
  s_add_u32 s30, s27, 90112
  buffer_load_dwordx4 v[216:219], v65, s[4:7], s30 offen sc1
  s_add_u32 s30, s27, 5120
  buffer_load_dwordx4 a[20:23], v65, s[4:7], s30 offen sc1
  s_add_u32 s30, s27, 19456
  buffer_load_dwordx4 a[76:79], v65, s[4:7], s30 offen sc1
  s_add_u32 s30, s27, 33792
  buffer_load_dwordx4 a[132:135], v65, s[4:7], s30 offen sc1
  s_add_u32 s30, s27, 48128
  buffer_load_dwordx4 a[188:191], v65, s[4:7], s30 offen sc1
  s_add_u32 s30, s27, 62464
  buffer_load_dwordx4 a[244:247], v65, s[4:7], s30 offen sc1
  s_add_u32 s30, s27, 76800
  buffer_load_dwordx4 v[164:167], v65, s[4:7], s30 offen sc1
  s_add_u32 s30, s27, 91136
  buffer_load_dwordx4 v[220:223], v65, s[4:7], s30 offen sc1
  s_add_u32 s30, s27, 6144
  buffer_load_dwordx4 a[24:27], v65, s[4:7], s30 offen sc1
  s_add_u32 s30, s27, 20480
  buffer_load_dwordx4 a[80:83], v65, s[4:7], s30 offen sc1
  s_add_u32 s30, s27, 34816
  buffer_load_dwordx4 a[136:139], v65, s[4:7], s30 offen sc1
  s_add_u32 s30, s27, 49152
  buffer_load_dwordx4 a[192:195], v65, s[4:7], s30 offen sc1
  s_add_u32 s30, s27, 63488
  buffer_load_dwordx4 a[248:251], v65, s[4:7], s30 offen sc1
  s_add_u32 s30, s27, 77824
  buffer_load_dwordx4 v[168:171], v65, s[4:7], s30 offen sc1
  s_add_u32 s30, s27, 92160
  buffer_load_dwordx4 v[224:227], v65, s[4:7], s30 offen sc1
  s_add_u32 s30, s27, 11264
  buffer_load_dwordx4 a[44:47], v65, s[4:7], s30 offen sc1
  s_add_u32 s30, s27, 25600
  buffer_load_dwordx4 a[100:103], v65, s[4:7], s30 offen sc1
  s_add_u32 s30, s27, 39936
  buffer_load_dwordx4 a[156:159], v65, s[4:7], s30 offen sc1
  s_add_u32 s30, s27, 54272
  buffer_load_dwordx4 a[212:215], v65, s[4:7], s30 offen sc1
  s_add_u32 s30, s27, 68608
  buffer_load_dwordx4 v[132:135], v65, s[4:7], s30 offen sc1
  s_add_u32 s30, s27, 82944
  buffer_load_dwordx4 v[188:191], v65, s[4:7], s30 offen sc1
  s_add_u32 s30, s27, 97280
  buffer_load_dwordx4 v[244:247], v65, s[4:7], s30 offen sc1
  s_add_u32 s30, s27, 12288
  buffer_load_dwordx4 a[48:51], v65, s[4:7], s30 offen sc1
  s_add_u32 s30, s27, 26624
  buffer_load_dwordx4 a[104:107], v65, s[4:7], s30 offen sc1
  s_add_u32 s30, s27, 40960
  buffer_load_dwordx4 a[160:163], v65, s[4:7], s30 offen sc1
  s_add_u32 s30, s27, 55296
  buffer_load_dwordx4 a[216:219], v65, s[4:7], s30 offen sc1
  s_add_u32 s30, s27, 69632
  buffer_load_dwordx4 v[136:139], v65, s[4:7], s30 offen sc1
  s_add_u32 s30, s27, 83968
  buffer_load_dwordx4 v[192:195], v65, s[4:7], s30 offen sc1
  s_add_u32 s30, s27, 98304
  buffer_load_dwordx4 v[248:251], v65, s[4:7], s30 offen sc1
  s_add_u32 s30, s27, 13312
  buffer_load_dwordx4 a[52:55], v65, s[4:7], s30 offen sc1
  s_add_u32 s30, s27, 27648
  buffer_load_dwordx4 a[108:111], v65, s[4:7], s30 offen sc1
  s_add_u32 s30, s27, 41984
  buffer_load_dwordx4 a[164:167], v65, s[4:7], s30 offen sc1
  s_add_u32 s30, s27, 56320
  buffer_load_dwordx4 a[220:223], v65, s[4:7], s30 offen sc1
  s_add_u32 s30, s27, 70656
  buffer_load_dwordx4 v[140:143], v65, s[4:7], s30 offen sc1
  s_add_u32 s30, s27, 84992
  buffer_load_dwordx4 v[196:199], v65, s[4:7], s30 offen sc1
  s_add_u32 s30, s27, 99328
  buffer_load_dwordx4 v[252:255], v65, s[4:7], s30 offen sc1
  s_mov_b32 s28, 0
  s_mov_b32 s29, 68354048
  s_branch L_wl0_83
L_wl_82:
  s_sleep 2
L_wl0_83:
  buffer_load_dwordx4 v[76:79], v65, s[4:7], s29 offen offset:0 sc1
  s_add_u32 s28, s28, 1
  s_cmp_gt_u32 s28, 2000000
  s_cbranch_scc1 L_fail
  s_waitcnt vmcnt(0)
  v_xor_b32 v76, s12, v76
  v_xor_b32 v77, s13, v77
  v_xor_b32 v78, s12, v78
  v_xor_b32 v79, s13, v79
  v_or_b32 v76, v76, v77
  v_or3_b32 v76, v76, v78, v79
  v_cmp_ne_u32 vcc, 0, v76
  s_cbranch_vccnz L_wl_82
  v_mov_b32 v0, s12
  v_mov_b32 v1, s13
  v_mov_b32 v2, 0
  s_mov_b64 exec, 1
  buffer_store_dwordx2 v[0:1], v2, s[4:7], s25 offen offset:0 sc1
  s_mov_b64 exec, -1
L_uw_84:
  v_mov_b32 v28, 0
  v_mov_b32 v29, 0
  v_mov_b32 v30, 0
  v_mov_b32 v31, 0
  v_mov_b32 v32, 0
  v_mov_b32 v33, 0
  v_mov_b32 v34, 0
  v_mov_b32 v35, 0
  v_mov_b32 v36, 0
  v_mov_b32 v37, 0
  v_mov_b32 v38, 0
  v_mov_b32 v39, 0
  v_mov_b32 v40, 0
  v_mov_b32 v41, 0
  v_mov_b32 v42, 0
  v_mov_b32 v43, 0
  v_mov_b32 v44, 0
  v_mov_b32 v45, 0
  v_mov_b32 v46, 0
  v_mov_b32 v47, 0
  v_mov_b32 v48, 0
  v_mov_b32 v49, 0
  v_mov_b32 v50, 0
  v_mov_b32 v51, 0
  v_mov_b32 v52, 0
  v_mov_b32 v53, 0
  v_mov_b32 v54, 0
  v_mov_b32 v55, 0
  s_mov_b32 s28, 0
L_poll_85:
  buffer_load_dwordx4 v[56:59], v68, s[4:7], s18 offen offset:0 sc1
  buffer_load_dwordx4 v[60:63], v69, s[4:7], s18 offen offset:0 sc1
  s_add_u32 s28, s28, 1
  s_cmp_gt_u32 s28, 400000
  s_cbranch_scc1 L_fail
  s_waitcnt vmcnt(0)
  v_max3_u32 v76, v56, v57, v58
  v_max3_u32 v76, v76, v59, v60
  v_max3_u32 v76, v76, v61, v62
  v_max_u32 v76, v76, v63
  v_cmp_eq_u32 vcc, -1, v76
  s_cbranch_vccnz L_poll_85
  s_barrier
  ds_write_b128 v68, v[56:59]
  ds_write_b128 v69, v[60:63]
  s_waitcnt lgkmcnt(0)
  s_barrier
  ds_read_b128 v[0:3], v65 offset:0
  ds_read_b128 v[4:7], v65 offset:1024
  ds_read_b128 v[8:11], v65 offset:2048
  ds_read_b128 v[12:15], v65 offset:3072
  ds_read_b128 v[16:19], v65 offset:4096
  ds_read_b128 v[20:23], v65 offset:5120
  ds_read_b128 v[24:27], v65 offset:6144
  s_waitcnt lgkmcnt(6)
  v_smfmac_f32_16x16x64_bf16 v[28:31], v[0:3], a[0:7], v64
  s_waitcnt lgkmcnt(5)
  v_smfmac_f32_16x16x64_bf16 v[28:31], v[4:7], a[8:15], v64
  s_waitcnt lgkmcnt(4)
  v_smfmac_f32_16x16x64_bf16 v[28:31], v[8:11], a[16:23], v64
  s_waitcnt lgkmcnt(3)
  v_smfmac_f32_16x16x64_bf16 v[28:31], v[12:15], a[24:31], v64
  s_waitcnt lgkmcnt(2)
  v_smfmac_f32_16x16x64_bf16 v[28:31], v[16:19], a[32:39], v64
  s_waitcnt lgkmcnt(1)
  v_smfmac_f32_16x16x64_bf16 v[28:31], v[20:23], a[40:47], v64
  s_waitcnt lgkmcnt(0)
  v_smfmac_f32_16x16x64_bf16 v[28:31], v[24:27], a[48:55], v64
  v_smfmac_f32_16x16x64_bf16 v[32:35], v[0:3], a[56:63], v64
  v_smfmac_f32_16x16x64_bf16 v[32:35], v[4:7], a[64:71], v64
  v_smfmac_f32_16x16x64_bf16 v[32:35], v[8:11], a[72:79], v64
  v_smfmac_f32_16x16x64_bf16 v[32:35], v[12:15], a[80:87], v64
  v_smfmac_f32_16x16x64_bf16 v[32:35], v[16:19], a[88:95], v64
  v_smfmac_f32_16x16x64_bf16 v[32:35], v[20:23], a[96:103], v64
  v_smfmac_f32_16x16x64_bf16 v[32:35], v[24:27], a[104:111], v64
  v_smfmac_f32_16x16x64_bf16 v[36:39], v[0:3], a[112:119], v64
  v_smfmac_f32_16x16x64_bf16 v[36:39], v[4:7], a[120:127], v64
  v_smfmac_f32_16x16x64_bf16 v[36:39], v[8:11], a[128:135], v64
  v_smfmac_f32_16x16x64_bf16 v[36:39], v[12:15], a[136:143], v64
  v_smfmac_f32_16x16x64_bf16 v[36:39], v[16:19], a[144:151], v64
  v_smfmac_f32_16x16x64_bf16 v[36:39], v[20:23], a[152:159], v64
  v_smfmac_f32_16x16x64_bf16 v[36:39], v[24:27], a[160:167], v64
  v_smfmac_f32_16x16x64_bf16 v[40:43], v[0:3], a[168:175], v64
  v_smfmac_f32_16x16x64_bf16 v[40:43], v[4:7], a[176:183], v64
  v_smfmac_f32_16x16x64_bf16 v[40:43], v[8:11], a[184:191], v64
  v_smfmac_f32_16x16x64_bf16 v[40:43], v[12:15], a[192:199], v64
  v_smfmac_f32_16x16x64_bf16 v[40:43], v[16:19], a[200:207], v64
  v_smfmac_f32_16x16x64_bf16 v[40:43], v[20:23], a[208:215], v64
  v_smfmac_f32_16x16x64_bf16 v[40:43], v[24:27], a[216:223], v64
  v_smfmac_f32_16x16x64_bf16 v[44:47], v[0:3], a[224:231], v64
  v_smfmac_f32_16x16x64_bf16 v[44:47], v[4:7], a[232:239], v64
  v_smfmac_f32_16x16x64_bf16 v[44:47], v[8:11], a[240:247], v64
  v_smfmac_f32_16x16x64_bf16 v[44:47], v[12:15], a[248:255], v64
  v_smfmac_f32_16x16x64_bf16 v[44:47], v[16:19], v[120:127], v64
  v_smfmac_f32_16x16x64_bf16 v[44:47], v[20:23], v[128:135], v64
  v_smfmac_f32_16x16x64_bf16 v[44:47], v[24:27], v[136:143], v64
  v_smfmac_f32_16x16x64_bf16 v[48:51], v[0:3], v[144:151], v64
  v_smfmac_f32_16x16x64_bf16 v[48:51], v[4:7], v[152:159], v64
  v_smfmac_f32_16x16x64_bf16 v[48:51], v[8:11], v[160:167], v64
  v_smfmac_f32_16x16x64_bf16 v[48:51], v[12:15], v[168:175], v64
  v_smfmac_f32_16x16x64_bf16 v[48:51], v[16:19], v[176:183], v64
  v_smfmac_f32_16x16x64_bf16 v[48:51], v[20:23], v[184:191], v64
  v_smfmac_f32_16x16x64_bf16 v[48:51], v[24:27], v[192:199], v64
  v_smfmac_f32_16x16x64_bf16 v[52:55], v[0:3], v[200:207], v64
  v_smfmac_f32_16x16x64_bf16 v[52:55], v[4:7], v[208:215], v64
  v_smfmac_f32_16x16x64_bf16 v[52:55], v[8:11], v[216:223], v64
  v_smfmac_f32_16x16x64_bf16 v[52:55], v[12:15], v[224:231], v64
  v_smfmac_f32_16x16x64_bf16 v[52:55], v[16:19], v[232:239], v64
  v_smfmac_f32_16x16x64_bf16 v[52:55], v[20:23], v[240:247], v64
  v_smfmac_f32_16x16x64_bf16 v[52:55], v[24:27], v[248:255], v64
  v_permlane32_swap_b32 v28, v30
  v_permlane32_swap_b32 v29, v31
  v_pk_add_f32 v[28:29], v[28:29], v[30:31]
  v_cvt_pk_bf16_f32 v28, v28, v29
  v_min_u32 v28, -2, v28
  buffer_store_dword v28, v70, s[4:7], s19 offen offset:0 sc1
  v_permlane32_swap_b32 v32, v34
  v_permlane32_swap_b32 v33, v35
  v_pk_add_f32 v[32:33], v[32:33], v[34:35]
  v_cvt_pk_bf16_f32 v32, v32, v33
  v_min_u32 v32, -2, v32
  buffer_store_dword v32, v70, s[4:7], s19 offen offset:256 sc1
  v_permlane32_swap_b32 v36, v38
  v_permlane32_swap_b32 v37, v39
  v_pk_add_f32 v[36:37], v[36:37], v[38:39]
  v_cvt_pk_bf16_f32 v36, v36, v37
  v_min_u32 v36, -2, v36
  buffer_store_dword v36, v70, s[4:7], s19 offen offset:512 sc1
  v_permlane32_swap_b32 v40, v42
  v_permlane32_swap_b32 v41, v43
  v_pk_add_f32 v[40:41], v[40:41], v[42:43]
  v_cvt_pk_bf16_f32 v40, v40, v41
  v_min_u32 v40, -2, v40
  buffer_store_dword v40, v70, s[4:7], s19 offen offset:768 sc1
  v_permlane32_swap_b32 v44, v46
  v_permlane32_swap_b32 v45, v47
  v_pk_add_f32 v[44:45], v[44:45], v[46:47]
  v_cvt_pk_bf16_f32 v44, v44, v45
  v_min_u32 v44, -2, v44
  buffer_store_dword v44, v70, s[4:7], s19 offen offset:1024 sc1
  v_permlane32_swap_b32 v48, v50
  v_permlane32_swap_b32 v49, v51
  v_pk_add_f32 v[48:49], v[48:49], v[50:51]
  v_cvt_pk_bf16_f32 v48, v48, v49
  v_min_u32 v48, -2, v48
  buffer_store_dword v48, v70, s[4:7], s19 offen offset:1280 sc1
  v_permlane32_swap_b32 v52, v54
  v_permlane32_swap_b32 v53, v55
  v_pk_add_f32 v[52:53], v[52:53], v[54:55]
  v_cvt_pk_bf16_f32 v52, v52, v53
  v_min_u32 v52, -2, v52
  buffer_store_dword v52, v70, s[4:7], s19 offen offset:1536 sc1
  s_add_u32 s18, s18, 16384
  s_add_u32 s19, s19, 229376
  s_add_u32 s17, s17, 2
  s_cmp_lt_u32 s17, 64
  s_cbranch_scc1 L_uw_84
  s_branch L_fin_20
L_GD_40:
  s_sub_u32 s9, s9, 140
  s_and_b32 s16, s9, 3
  s_lshr_b32 s17, s9, 2
  s_load_dwordx2 s[32:33], s[0:1], 80
  s_waitcnt lgkmcnt(0)
  s_and_b32 s33, s33, 0xffff
  s_mov_b32 s34, 1605632
  s_mov_b32 s35, 0x20000
  v_mbcnt_lo_u32_b32 v82, -1, 0
  v_mbcnt_hi_u32_b32 v82, -1, v82
  v_lshlrev_b32 v80, 4, v82
  v_lshlrev_b32 v81, 3, v82
  v_mov_b32 v84, s12
  v_mov_b32 v85, s13
  v_cmp_eq_u32 vcc, 0, v82
  v_mov_b32 v86, 0x80000000
  s_nop 0
  v_cndmask_b32 v86, v86, 0, vcc
  v_lshrrev_b32 v104, 4, v82
  v_mul_u32_u24 v105, 896, v104
  v_lshlrev_b32 v104, 1, v104
  v_and_b32 v106, 15, v82
  v_xor_b32 v104, v104, v106
  v_mov_b32 v108, 0x80000000
  v_xor_b32 v106, 0, v104
  v_cmp_gt_u32 vcc, 14, v106
  v_lshl_add_u32 v106, v106, 4, v105
  s_nop 0
  v_cndmask_b32 v90, v108, v106, vcc
  v_xor_b32 v106, 8, v104
  v_cmp_gt_u32 vcc, 14, v106
  v_lshl_add_u32 v106, v106, 4, v105
  s_nop 0
  v_cndmask_b32 v91, v108, v106, vcc
  v_and_b32 v107, 15, v82
  v_lshrrev_b32 v108, 4, v82
  v_lshrrev_b32 v106, 2, v107
  v_lshl_add_u32 v104, v108, 2, v106
  v_and_b32 v108, 7, v104
  v_lshlrev_b32 v108, 1, v108
  v_lshlrev_b32 v104, 8, v104
  v_and_b32 v105, 1, v107
  v_lshl_add_u32 v104, v105, 3, v104
  s_lshl_b32 s21, s8, 14
  v_add_u32 v104, s21, v104
  v_bfe_u32 v105, v107, 1, 1
  v_xor_b32 v105, v105, v108
  v_xor_b32 v106, 0, v105
  v_lshl_add_u32 v92, v106, 4, v104
  v_xor_b32 v106, 2, v105
  v_lshl_add_u32 v93, v106, 4, v104
  v_xor_b32 v106, 4, v105
  v_lshl_add_u32 v94, v106, 4, v104
  v_xor_b32 v106, 6, v105
  v_lshl_add_u32 v95, v106, 4, v104
  v_xor_b32 v106, 8, v105
  v_lshl_add_u32 v96, v106, 4, v104
  v_xor_b32 v106, 10, v105
  v_lshl_add_u32 v97, v106, 4, v104
  v_xor_b32 v106, 12, v105
  v_lshl_add_u32 v98, v106, 4, v104
  s_mul_i32 s20, s8, 401408
  s_mul_i32 s31, s16, 224
  s_add_u32 s20, s20, s31
  s_mov_b32 s29, 68194304
  s_mov_b32 s28, 0
  s_branch L_wf0_87
L_wf_86:
  s_sleep 8
L_wf0_87:
  buffer_load_dwordx2 v[88:89], v81, s[4:7], s29 offen offset:0 sc1
  s_add_u32 s28, s28, 1
  s_cmp_gt_u32 s28, 2000000
  s_cbranch_scc1 L_fail
  s_waitcnt vmcnt(0)
  v_xor_b32 v88, s12, v88
  v_xor_b32 v89, s13, v89
  v_or_b32 v88, v88, v89
  v_cmp_ne_u32 vcc, 0, v88
  s_cbranch_vccnz L_wf_86
  s_add_u32 m0, s21, 0
  s_add_u32 s30, s20, 0
  buffer_load_dwordx4 v90, s[32:35], s30 offen nt lds
  s_add_u32 m0, s21, 1024
  s_add_u32 s30, s20, 3584
  buffer_load_dwordx4 v91, s[32:35], s30 offen nt lds
  s_add_u32 m0, s21, 2048
  s_add_u32 s30, s20, 7168
  buffer_load_dwordx4 v90, s[32:35], s30 offen nt lds
  s_add_u32 m0, s21, 3072
  s_add_u32 s30, s20, 10752
  buffer_load_dwordx4 v91, s[32:35], s30 offen nt lds
  s_add_u32 m0, s21, 4096
  s_add_u32 s30, s20, 14336
  buffer_load_dwordx4 v90, s[32:35], s30 offen nt lds
  s_add_u32 m0, s21, 5120
  s_add_u32 s30, s20, 17920
  buffer_load_dwordx4 v91, s[32:35], s30 offen nt lds
  s_add_u32 m0, s21, 6144
  s_add_u32 s30, s20, 21504
  buffer_load_dwordx4 v90, s[32:35], s30 offen nt lds
  s_add_u32 m0, s21, 7168
  s_add_u32 s30, s20, 25088
  buffer_load_dwordx4 v91, s[32:35], s30 offen nt lds
  s_waitcnt lgkmcnt(0)
  s_add_u32 m0, s21, 8192
  s_add_u32 s30, s20, 28672
  buffer_load_dwordx4 v90, s[32:35], s30 offen nt lds
  s_add_u32 m0, s21, 9216
  s_add_u32 s30, s20, 32256
  buffer_load_dwordx4 v91, s[32:35], s30 offen nt lds
  s_add_u32 m0, s21, 10240
  s_add_u32 s30, s20, 35840
  buffer_load_dwordx4 v90, s[32:35], s30 offen nt lds
  s_add_u32 m0, s21, 11264
  s_add_u32 s30, s20, 39424
  buffer_load_dwordx4 v91, s[32:35], s30 offen nt lds
  s_add_u32 m0, s21, 12288
  s_add_u32 s30, s20, 43008
  buffer_load_dwordx4 v90, s[32:35], s30 offen nt lds
  s_add_u32 m0, s21, 13312
  s_add_u32 s30, s20, 46592
  buffer_load_dwordx4 v91, s[32:35], s30 offen nt lds
  s_add_u32 m0, s21, 14336
  s_add_u32 s30, s20, 50176
  buffer_load_dwordx4 v90, s[32:35], s30 offen nt lds
  s_add_u32 m0, s21, 15360
  s_add_u32 s30, s20, 53760
  buffer_load_dwordx4 v91, s[32:35], s30 offen nt lds
  s_waitcnt vmcnt(8)
  ds_read_b64_tr_b16 a[0:1], v92 offset:0
  ds_read_b64_tr_b16 a[2:3], v92 offset:4096
  ds_read_b64_tr_b16 a[56:57], v93 offset:0
  ds_read_b64_tr_b16 a[58:59], v93 offset:4096
  ds_read_b64_tr_b16 a[112:113], v94 offset:0
  ds_read_b64_tr_b16 a[114:115], v94 offset:4096
  ds_read_b64_tr_b16 a[168:169], v95 offset:0
  ds_read_b64_tr_b16 a[170:171], v95 offset:4096
  ds_read_b64_tr_b16 a[224:225], v96 offset:0
  ds_read_b64_tr_b16 a[226:227], v96 offset:4096
  ds_read_b64_tr_b16 v[144:145], v97 offset:0
  ds_read_b64_tr_b16 v[146:147], v97 offset:4096
  ds_read_b64_tr_b16 v[200:201], v98 offset:0
  ds_read_b64_tr_b16 v[202:203], v98 offset:4096
  s_waitcnt lgkmcnt(0)
  s_add_u32 m0, s21, 0
  s_add_u32 s30, s20, 57344
  buffer_load_dwordx4 v90, s[32:35], s30 offen nt lds
  s_add_u32 m0, s21, 1024
  s_add_u32 s30, s20, 60928
  buffer_load_dwordx4 v91, s[32:35], s30 offen nt lds
  s_add_u32 m0, s21, 2048
  s_add_u32 s30, s20, 64512
  buffer_load_dwordx4 v90, s[32:35], s30 offen nt lds
  s_add_u32 m0, s21, 3072
  s_add_u32 s30, s20, 68096
  buffer_load_dwordx4 v91, s[32:35], s30 offen nt lds
  s_add_u32 m0, s21, 4096
  s_add_u32 s30, s20, 71680
  buffer_load_dwordx4 v90, s[32:35], s30 offen nt lds
  s_add_u32 m0, s21, 5120
  s_add_u32 s30, s20, 75264
  buffer_load_dwordx4 v91, s[32:35], s30 offen nt lds
  s_add_u32 m0, s21, 6144
  s_add_u32 s30, s20, 78848
  buffer_load_dwordx4 v90, s[32:35], s30 offen nt lds
  s_add_u32 m0, s21, 7168
  s_add_u32 s30, s20, 82432
  buffer_load_dwordx4 v91, s[32:35], s30 offen nt lds
  s_waitcnt vmcnt(8)
  ds_read_b64_tr_b16 a[4:5], v92 offset:8192
  ds_read_b64_tr_b16 a[6:7], v92 offset:12288
  ds_read_b64_tr_b16 a[60:61], v93 offset:8192
  ds_read_b64_tr_b16 a[62:63], v93 offset:12288
  ds_read_b64_tr_b16 a[116:117], v94 offset:8192
  ds_read_b64_tr_b16 a[118:119], v94 offset:12288
  ds_read_b64_tr_b16 a[172:173], v95 offset:8192
  ds_read_b64_tr_b16 a[174:175], v95 offset:12288
  ds_read_b64_tr_b16 a[228:229], v96 offset:8192
  ds_read_b64_tr_b16 a[230:231], v96 offset:12288
  ds_read_b64_tr_b16 v[148:149], v97 offset:8192
  ds_read_b64_tr_b16 v[150:151], v97 offset:12288
  ds_read_b64_tr_b16 v[204:205], v98 offset:8192
  ds_read_b64_tr_b16 v[206:207], v98 offset:12288
  s_waitcnt lgkmcnt(0)
  s_add_u32 m0, s21, 8192
  s_add_u32 s30, s20, 86016
  buffer_load_dwordx4 v90, s[32:35], s30 offen nt lds
  s_add_u32 m0, s21, 9216
  s_add_u32 s30, s20, 89600
  buffer_load_dwordx4 v91, s[32:35], s30 offen nt lds
  s_add_u32 m0, s21, 10240
  s_add_u32 s30, s20, 93184
  buffer_load_dwordx4 v90, s[32:35], s30 offen nt lds
  s_add_u32 m0, s21, 11264
  s_add_u32 s30, s20, 96768
  buffer_load_dwordx4 v91, s[32:35], s30 offen nt lds
  s_add_u32 m0, s21, 12288
  s_add_u32 s30, s20, 100352
  buffer_load_dwordx4 v90, s[32:35], s30 offen nt lds
  s_add_u32 m0, s21, 13312
  s_add_u32 s30, s20, 103936
  buffer_load_dwordx4 v91, s[32:35], s30 offen nt lds
  s_add_u32 m0, s21, 14336
  s_add_u32 s30, s20, 107520
  buffer_load_dwordx4 v90, s[32:35], s30 offen nt lds
  s_add_u32 m0, s21, 15360
  s_add_u32 s30, s20, 111104
  buffer_load_dwordx4 v91, s[32:35], s30 offen nt lds
  s_waitcnt vmcnt(8)
  ds_read_b64_tr_b16 a[8:9], v92 offset:0
  ds_read_b64_tr_b16 a[10:11], v92 offset:4096
  ds_read_b64_tr_b16 a[64:65], v93 offset:0
  ds_read_b64_tr_b16 a[66:67], v93 offset:4096
  ds_read_b64_tr_b16 a[120:121], v94 offset:0
  ds_read_b64_tr_b16 a[122:123], v94 offset:4096
  ds_read_b64_tr_b16 a[176:177], v95 offset:0
  ds_read_b64_tr_b16 a[178:179], v95 offset:4096
  ds_read_b64_tr_b16 a[232:233], v96 offset:0
  ds_read_b64_tr_b16 a[234:235], v96 offset:4096
  ds_read_b64_tr_b16 v[152:153], v97 offset:0
  ds_read_b64_tr_b16 v[154:155], v97 offset:4096
  ds_read_b64_tr_b16 v[208:209], v98 offset:0
  ds_read_b64_tr_b16 v[210:211], v98 offset:4096
  s_waitcnt lgkmcnt(0)
  s_add_u32 m0, s21, 0
  s_add_u32 s30, s20, 114688
  buffer_load_dwordx4 v90, s[32:35], s30 offen nt lds
  s_add_u32 m0, s21, 1024
  s_add_u32 s30, s20, 118272
  buffer_load_dwordx4 v91, s[32:35], s30 offen nt lds
  s_add_u32 m0, s21, 2048
  s_add_u32 s30, s20, 121856
  buffer_load_dwordx4 v90, s[32:35], s30 offen nt lds
  s_add_u32 m0, s21, 3072
  s_add_u32 s30, s20, 125440
  buffer_load_dwordx4 v91, s[32:35], s30 offen nt lds
  s_add_u32 m0, s21, 4096
  s_add_u32 s30, s20, 129024
  buffer_load_dwordx4 v90, s[32:35], s30 offen nt lds
  s_add_u32 m0, s21, 5120
  s_add_u32 s30, s20, 132608
  buffer_load_dwordx4 v91, s[32:35], s30 offen nt lds
  s_add_u32 m0, s21, 6144
  s_add_u32 s30, s20, 136192
  buffer_load_dwordx4 v90, s[32:35], s30 offen nt lds
  s_add_u32 m0, s21, 7168
  s_add_u32 s30, s20, 139776
  buffer_load_dwordx4 v91, s[32:35], s30 offen nt lds
  s_waitcnt vmcnt(8)
  ds_read_b64_tr_b16 a[12:13], v92 offset:8192
  ds_read_b64_tr_b16 a[14:15], v92 offset:12288
  ds_read_b64_tr_b16 a[68:69], v93 offset:8192
  ds_read_b64_tr_b16 a[70:71], v93 offset:12288
  ds_read_b64_tr_b16 a[124:125], v94 offset:8192
  ds_read_b64_tr_b16 a[126:127], v94 offset:12288
  ds_read_b64_tr_b16 a[180:181], v95 offset:8192
  ds_read_b64_tr_b16 a[182:183], v95 offset:12288
  ds_read_b64_tr_b16 a[236:237], v96 offset:8192
  ds_read_b64_tr_b16 a[238:239], v96 offset:12288
  ds_read_b64_tr_b16 v[156:157], v97 offset:8192
  ds_read_b64_tr_b16 v[158:159], v97 offset:12288
  ds_read_b64_tr_b16 v[212:213], v98 offset:8192
  ds_read_b64_tr_b16 v[214:215], v98 offset:12288
  s_waitcnt lgkmcnt(0)
  s_add_u32 m0, s21, 8192
  s_add_u32 s30, s20, 143360
  buffer_load_dwordx4 v90, s[32:35], s30 offen nt lds
  s_add_u32 m0, s21, 9216
  s_add_u32 s30, s20, 146944
  buffer_load_dwordx4 v91, s[32:35], s30 offen nt lds
  s_add_u32 m0, s21, 10240
  s_add_u32 s30, s20, 150528
  buffer_load_dwordx4 v90, s[32:35], s30 offen nt lds
  s_add_u32 m0, s21, 11264
  s_add_u32 s30, s20, 154112
  buffer_load_dwordx4 v91, s[32:35], s30 offen nt lds
  s_add_u32 m0, s21, 12288
  s_add_u32 s30, s20, 157696
  buffer_load_dwordx4 v90, s[32:35], s30 offen nt lds
  s_add_u32 m0, s21, 13312
  s_add_u32 s30, s20, 161280
  buffer_load_dwordx4 v91, s[32:35], s30 offen nt lds
  s_add_u32 m0, s21, 14336
  s_add_u32 s30, s20, 164864
  buffer_load_dwordx4 v90, s[32:35], s30 offen nt lds
  s_add_u32 m0, s21, 15360
  s_add_u32 s30, s20, 168448
  buffer_load_dwordx4 v91, s[32:35], s30 offen nt lds
  s_waitcnt vmcnt(8)
  ds_read_b64_tr_b16 a[16:17], v92 offset:0
  ds_read_b64_tr_b16 a[18:19], v92 offset:4096
  ds_read_b64_tr_b16 a[72:73], v93 offset:0
  ds_read_b64_tr_b16 a[74:75], v93 offset:4096
  ds_read_b64_tr_b16 a[128:129], v94 offset:0
  ds_read_b64_tr_b16 a[130:131], v94 offset:4096
  ds_read_b64_tr_b16 a[184:185], v95 offset:0
  ds_read_b64_tr_b16 a[186:187], v95 offset:4096
  ds_read_b64_tr_b16 a[240:241], v96 offset:0
  ds_read_b64_tr_b16 a[242:243], v96 offset:4096
  ds_read_b64_tr_b16 v[160:161], v97 offset:0
  ds_read_b64_tr_b16 v[162:163], v97 offset:4096
  ds_read_b64_tr_b16 v[216:217], v98 offset:0
  ds_read_b64_tr_b16 v[218:219], v98 offset:4096
  s_waitcnt lgkmcnt(0)
  s_add_u32 m0, s21, 0
  s_add_u32 s30, s20, 172032
  buffer_load_dwordx4 v90, s[32:35], s30 offen nt lds
  s_add_u32 m0, s21, 1024
  s_add_u32 s30, s20, 175616
  buffer_load_dwordx4 v91, s[32:35], s30 offen nt lds
  s_add_u32 m0, s21, 2048
  s_add_u32 s30, s20, 179200
  buffer_load_dwordx4 v90, s[32:35], s30 offen nt lds
  s_add_u32 m0, s21, 3072
  s_add_u32 s30, s20, 182784
  buffer_load_dwordx4 v91, s[32:35], s30 offen nt lds
  s_add_u32 m0, s21, 4096
  s_add_u32 s30, s20, 186368
  buffer_load_dwordx4 v90, s[32:35], s30 offen nt lds
  s_add_u32 m0, s21, 5120
  s_add_u32 s30, s20, 189952
  buffer_load_dwordx4 v91, s[32:35], s30 offen nt lds
  s_add_u32 m0, s21, 6144
  s_add_u32 s30, s20, 193536
  buffer_load_dwordx4 v90, s[32:35], s30 offen nt lds
  s_add_u32 m0, s21, 7168
  s_add_u32 s30, s20, 197120
  buffer_load_dwordx4 v91, s[32:35], s30 offen nt lds
  s_waitcnt vmcnt(8)
  ds_read_b64_tr_b16 a[20:21], v92 offset:8192
  ds_read_b64_tr_b16 a[22:23], v92 offset:12288
  ds_read_b64_tr_b16 a[76:77], v93 offset:8192
  ds_read_b64_tr_b16 a[78:79], v93 offset:12288
  ds_read_b64_tr_b16 a[132:133], v94 offset:8192
  ds_read_b64_tr_b16 a[134:135], v94 offset:12288
  ds_read_b64_tr_b16 a[188:189], v95 offset:8192
  ds_read_b64_tr_b16 a[190:191], v95 offset:12288
  ds_read_b64_tr_b16 a[244:245], v96 offset:8192
  ds_read_b64_tr_b16 a[246:247], v96 offset:12288
  ds_read_b64_tr_b16 v[164:165], v97 offset:8192
  ds_read_b64_tr_b16 v[166:167], v97 offset:12288
  ds_read_b64_tr_b16 v[220:221], v98 offset:8192
  ds_read_b64_tr_b16 v[222:223], v98 offset:12288
  s_waitcnt lgkmcnt(0)
  s_add_u32 m0, s21, 8192
  s_add_u32 s30, s20, 200704
  buffer_load_dwordx4 v90, s[32:35], s30 offen nt lds
  s_add_u32 m0, s21, 9216
  s_add_u32 s30, s20, 204288
  buffer_load_dwordx4 v91, s[32:35], s30 offen nt lds
  s_add_u32 m0, s21, 10240
  s_add_u32 s30, s20, 207872
  buffer_load_dwordx4 v90, s[32:35], s30 offen nt lds
  s_add_u32 m0, s21, 11264
  s_add_u32 s30, s20, 211456
  buffer_load_dwordx4 v91, s[32:35], s30 offen nt lds
  s_add_u32 m0, s21, 12288
  s_add_u32 s30, s20, 215040
  buffer_load_dwordx4 v90, s[32:35], s30 offen nt lds
  s_add_u32 m0, s21, 13312
  s_add_u32 s30, s20, 218624
  buffer_load_dwordx4 v91, s[32:35], s30 offen nt lds
  s_add_u32 m0, s21, 14336
  s_add_u32 s30, s20, 222208
  buffer_load_dwordx4 v90, s[32:35], s30 offen nt lds
  s_add_u32 m0, s21, 15360
  s_add_u32 s30, s20, 225792
  buffer_load_dwordx4 v91, s[32:35], s30 offen nt lds
  s_waitcnt vmcnt(8)
  ds_read_b64_tr_b16 a[24:25], v92 offset:0
  ds_read_b64_tr_b16 a[26:27], v92 offset:4096
  ds_read_b64_tr_b16 a[80:81], v93 offset:0
  ds_read_b64_tr_b16 a[82:83], v93 offset:4096
  ds_read_b64_tr_b16 a[136:137], v94 offset:0
  ds_read_b64_tr_b16 a[138:139], v94 offset:4096
  ds_read_b64_tr_b16 a[192:193], v95 offset:0
  ds_read_b64_tr_b16 a[194:195], v95 offset:4096
  ds_read_b64_tr_b16 a[248:249], v96 offset:0
  ds_read_b64_tr_b16 a[250:251], v96 offset:4096
  ds_read_b64_tr_b16 v[168:169], v97 offset:0
  ds_read_b64_tr_b16 v[170:171], v97 offset:4096
  ds_read_b64_tr_b16 v[224:225], v98 offset:0
  ds_read_b64_tr_b16 v[226:227], v98 offset:4096
  s_waitcnt lgkmcnt(0)
  s_add_u32 m0, s21, 0
  s_add_u32 s30, s20, 229376
  buffer_load_dwordx4 v90, s[32:35], s30 offen nt lds
  s_add_u32 m0, s21, 1024
  s_add_u32 s30, s20, 232960
  buffer_load_dwordx4 v91, s[32:35], s30 offen nt lds
  s_add_u32 m0, s21, 2048
  s_add_u32 s30, s20, 236544
  buffer_load_dwordx4 v90, s[32:35], s30 offen nt lds
  s_add_u32 m0, s21, 3072
  s_add_u32 s30, s20, 240128
  buffer_load_dwordx4 v91, s[32:35], s30 offen nt lds
  s_add_u32 m0, s21, 4096
  s_add_u32 s30, s20, 243712
  buffer_load_dwordx4 v90, s[32:35], s30 offen nt lds
  s_add_u32 m0, s21, 5120
  s_add_u32 s30, s20, 247296
  buffer_load_dwordx4 v91, s[32:35], s30 offen nt lds
  s_add_u32 m0, s21, 6144
  s_add_u32 s30, s20, 250880
  buffer_load_dwordx4 v90, s[32:35], s30 offen nt lds
  s_add_u32 m0, s21, 7168
  s_add_u32 s30, s20, 254464
  buffer_load_dwordx4 v91, s[32:35], s30 offen nt lds
  s_waitcnt vmcnt(8)
  ds_read_b64_tr_b16 a[28:29], v92 offset:8192
  ds_read_b64_tr_b16 a[30:31], v92 offset:12288
  ds_read_b64_tr_b16 a[84:85], v93 offset:8192
  ds_read_b64_tr_b16 a[86:87], v93 offset:12288
  ds_read_b64_tr_b16 a[140:141], v94 offset:8192
  ds_read_b64_tr_b16 a[142:143], v94 offset:12288
  ds_read_b64_tr_b16 a[196:197], v95 offset:8192
  ds_read_b64_tr_b16 a[198:199], v95 offset:12288
  ds_read_b64_tr_b16 a[252:253], v96 offset:8192
  ds_read_b64_tr_b16 a[254:255], v96 offset:12288
  ds_read_b64_tr_b16 v[172:173], v97 offset:8192
  ds_read_b64_tr_b16 v[174:175], v97 offset:12288
  ds_read_b64_tr_b16 v[228:229], v98 offset:8192
  ds_read_b64_tr_b16 v[230:231], v98 offset:12288
  s_waitcnt lgkmcnt(0)
  s_add_u32 m0, s21, 8192
  s_add_u32 s30, s20, 258048
  buffer_load_dwordx4 v90, s[32:35], s30 offen nt lds
  s_add_u32 m0, s21, 9216
  s_add_u32 s30, s20, 261632
  buffer_load_dwordx4 v91, s[32:35], s30 offen nt lds
  s_add_u32 m0, s21, 10240
  s_add_u32 s30, s20, 265216
  buffer_load_dwordx4 v90, s[32:35], s30 offen nt lds
  s_add_u32 m0, s21, 11264
  s_add_u32 s30, s20, 268800
  buffer_load_dwordx4 v91, s[32:35], s30 offen nt lds
  s_add_u32 m0, s21, 12288
  s_add_u32 s30, s20, 272384
  buffer_load_dwordx4 v90, s[32:35], s30 offen nt lds
  s_add_u32 m0, s21, 13312
  s_add_u32 s30, s20, 275968
  buffer_load_dwordx4 v91, s[32:35], s30 offen nt lds
  s_add_u32 m0, s21, 14336
  s_add_u32 s30, s20, 279552
  buffer_load_dwordx4 v90, s[32:35], s30 offen nt lds
  s_add_u32 m0, s21, 15360
  s_add_u32 s30, s20, 283136
  buffer_load_dwordx4 v91, s[32:35], s30 offen nt lds
  s_waitcnt vmcnt(8)
  ds_read_b64_tr_b16 a[32:33], v92 offset:0
  ds_read_b64_tr_b16 a[34:35], v92 offset:4096
  ds_read_b64_tr_b16 a[88:89], v93 offset:0
  ds_read_b64_tr_b16 a[90:91], v93 offset:4096
  ds_read_b64_tr_b16 a[144:145], v94 offset:0
  ds_read_b64_tr_b16 a[146:147], v94 offset:4096
  ds_read_b64_tr_b16 a[200:201], v95 offset:0
  ds_read_b64_tr_b16 a[202:203], v95 offset:4096
  ds_read_b64_tr_b16 v[120:121], v96 offset:0
  ds_read_b64_tr_b16 v[122:123], v96 offset:4096
  ds_read_b64_tr_b16 v[176:177], v97 offset:0
  ds_read_b64_tr_b16 v[178:179], v97 offset:4096
  ds_read_b64_tr_b16 v[232:233], v98 offset:0
  ds_read_b64_tr_b16 v[234:235], v98 offset:4096
  s_waitcnt lgkmcnt(0)
  s_add_u32 m0, s21, 0
  s_add_u32 s30, s20, 286720
  buffer_load_dwordx4 v90, s[32:35], s30 offen nt lds
  s_add_u32 m0, s21, 1024
  s_add_u32 s30, s20, 290304
  buffer_load_dwordx4 v91, s[32:35], s30 offen nt lds
  s_add_u32 m0, s21, 2048
  s_add_u32 s30, s20, 293888
  buffer_load_dwordx4 v90, s[32:35], s30 offen nt lds
  s_add_u32 m0, s21, 3072
  s_add_u32 s30, s20, 297472
  buffer_load_dwordx4 v91, s[32:35], s30 offen nt lds
  s_add_u32 m0, s21, 4096
  s_add_u32 s30, s20, 301056
  buffer_load_dwordx4 v90, s[32:35], s30 offen nt lds
  s_add_u32 m0, s21, 5120
  s_add_u32 s30, s20, 304640
  buffer_load_dwordx4 v91, s[32:35], s30 offen nt lds
  s_add_u32 m0, s21, 6144
  s_add_u32 s30, s20, 308224
  buffer_load_dwordx4 v90, s[32:35], s30 offen nt lds
  s_add_u32 m0, s21, 7168
  s_add_u32 s30, s20, 311808
  buffer_load_dwordx4 v91, s[32:35], s30 offen nt lds
  s_waitcnt vmcnt(8)
  ds_read_b64_tr_b16 a[36:37], v92 offset:8192
  ds_read_b64_tr_b16 a[38:39], v92 offset:12288
  ds_read_b64_tr_b16 a[92:93], v93 offset:8192
  ds_read_b64_tr_b16 a[94:95], v93 offset:12288
  ds_read_b64_tr_b16 a[148:149], v94 offset:8192
  ds_read_b64_tr_b16 a[150:151], v94 offset:12288
  ds_read_b64_tr_b16 a[204:205], v95 offset:8192
  ds_read_b64_tr_b16 a[206:207], v95 offset:12288
  ds_read_b64_tr_b16 v[124:125], v96 offset:8192
  ds_read_b64_tr_b16 v[126:127], v96 offset:12288
  ds_read_b64_tr_b16 v[180:181], v97 offset:8192
  ds_read_b64_tr_b16 v[182:183], v97 offset:12288
  ds_read_b64_tr_b16 v[236:237], v98 offset:8192
  ds_read_b64_tr_b16 v[238:239], v98 offset:12288
  s_waitcnt lgkmcnt(0)
  s_add_u32 m0, s21, 8192
  s_add_u32 s30, s20, 315392
  buffer_load_dwordx4 v90, s[32:35], s30 offen nt lds
  s_add_u32 m0, s21, 9216
  s_add_u32 s30, s20, 318976
  buffer_load_dwordx4 v91, s[32:35], s30 offen nt lds
  s_add_u32 m0, s21, 10240
  s_add_u32 s30, s20, 322560
  buffer_load_dwordx4 v90, s[32:35], s30 offen nt lds
  s_add_u32 m0, s21, 11264
  s_add_u32 s30, s20, 326144
  buffer_load_dwordx4 v91, s[32:35], s30 offen nt lds
  s_add_u32 m0, s21, 12288
  s_add_u32 s30, s20, 329728
  buffer_load_dwordx4 v90, s[32:35], s30 offen nt lds
  s_add_u32 m0, s21, 13312
  s_add_u32 s30, s20, 333312
  buffer_load_dwordx4 v91, s[32:35], s30 offen nt lds
  s_add_u32 m0, s21, 14336
  s_add_u32 s30, s20, 336896
  buffer_load_dwordx4 v90, s[32:35], s30 offen nt lds
  s_add_u32 m0, s21, 15360
  s_add_u32 s30, s20, 340480
  buffer_load_dwordx4 v91, s[32:35], s30 offen nt lds
  s_waitcnt vmcnt(8)
  ds_read_b64_tr_b16 a[40:41], v92 offset:0
  ds_read_b64_tr_b16 a[42:43], v92 offset:4096
  ds_read_b64_tr_b16 a[96:97], v93 offset:0
  ds_read_b64_tr_b16 a[98:99], v93 offset:4096
  ds_read_b64_tr_b16 a[152:153], v94 offset:0
  ds_read_b64_tr_b16 a[154:155], v94 offset:4096
  ds_read_b64_tr_b16 a[208:209], v95 offset:0
  ds_read_b64_tr_b16 a[210:211], v95 offset:4096
  ds_read_b64_tr_b16 v[128:129], v96 offset:0
  ds_read_b64_tr_b16 v[130:131], v96 offset:4096
  ds_read_b64_tr_b16 v[184:185], v97 offset:0
  ds_read_b64_tr_b16 v[186:187], v97 offset:4096
  ds_read_b64_tr_b16 v[240:241], v98 offset:0
  ds_read_b64_tr_b16 v[242:243], v98 offset:4096
  s_waitcnt lgkmcnt(0)
  s_add_u32 m0, s21, 0
  s_add_u32 s30, s20, 344064
  buffer_load_dwordx4 v90, s[32:35], s30 offen nt lds
  s_add_u32 m0, s21, 1024
  s_add_u32 s30, s20, 347648
  buffer_load_dwordx4 v91, s[32:35], s30 offen nt lds
  s_add_u32 m0, s21, 2048
  s_add_u32 s30, s20, 351232
  buffer_load_dwordx4 v90, s[32:35], s30 offen nt lds
  s_add_u32 m0, s21, 3072
  s_add_u32 s30, s20, 354816
  buffer_load_dwordx4 v91, s[32:35], s30 offen nt lds
  s_add_u32 m0, s21, 4096
  s_add_u32 s30, s20, 358400
  buffer_load_dwordx4 v90, s[32:35], s30 offen nt lds
  s_add_u32 m0, s21, 5120
  s_add_u32 s30, s20, 361984
  buffer_load_dwordx4 v91, s[32:35], s30 offen nt lds
  s_add_u32 m0, s21, 6144
  s_add_u32 s30, s20, 365568
  buffer_load_dwordx4 v90, s[32:35], s30 offen nt lds
  s_add_u32 m0, s21, 7168
  s_add_u32 s30, s20, 369152
  buffer_load_dwordx4 v91, s[32:35], s30 offen nt lds
  s_waitcnt vmcnt(8)
  ds_read_b64_tr_b16 a[44:45], v92 offset:8192
  ds_read_b64_tr_b16 a[46:47], v92 offset:12288
  ds_read_b64_tr_b16 a[100:101], v93 offset:8192
  ds_read_b64_tr_b16 a[102:103], v93 offset:12288
  ds_read_b64_tr_b16 a[156:157], v94 offset:8192
  ds_read_b64_tr_b16 a[158:159], v94 offset:12288
  ds_read_b64_tr_b16 a[212:213], v95 offset:8192
  ds_read_b64_tr_b16 a[214:215], v95 offset:12288
  ds_read_b64_tr_b16 v[132:133], v96 offset:8192
  ds_read_b64_tr_b16 v[134:135], v96 offset:12288
  ds_read_b64_tr_b16 v[188:189], v97 offset:8192
  ds_read_b64_tr_b16 v[190:191], v97 offset:12288
  ds_read_b64_tr_b16 v[244:245], v98 offset:8192
  ds_read_b64_tr_b16 v[246:247], v98 offset:12288
  s_waitcnt lgkmcnt(0)
  s_add_u32 m0, s21, 8192
  s_add_u32 s30, s20, 372736
  buffer_load_dwordx4 v90, s[32:35], s30 offen nt lds
  s_add_u32 m0, s21, 9216
  s_add_u32 s30, s20, 376320
  buffer_load_dwordx4 v91, s[32:35], s30 offen nt lds
  s_add_u32 m0, s21, 10240
  s_add_u32 s30, s20, 379904
  buffer_load_dwordx4 v90, s[32:35], s30 offen nt lds
  s_add_u32 m0, s21, 11264
  s_add_u32 s30, s20, 383488
  buffer_load_dwordx4 v91, s[32:35], s30 offen nt lds
  s_add_u32 m0, s21, 12288
  s_add_u32 s30, s20, 387072
  buffer_load_dwordx4 v90, s[32:35], s30 offen nt lds
  s_add_u32 m0, s21, 13312
  s_add_u32 s30, s20, 390656
  buffer_load_dwordx4 v91, s[32:35], s30 offen nt lds
  s_add_u32 m0, s21, 14336
  s_add_u32 s30, s20, 394240
  buffer_load_dwordx4 v90, s[32:35], s30 offen nt lds
  s_add_u32 m0, s21, 15360
  s_add_u32 s30, s20, 397824
  buffer_load_dwordx4 v91, s[32:35], s30 offen nt lds
  s_waitcnt vmcnt(8)
  ds_read_b64_tr_b16 a[48:49], v92 offset:0
  ds_read_b64_tr_b16 a[50:51], v92 offset:4096
  ds_read_b64_tr_b16 a[104:105], v93 offset:0
  ds_read_b64_tr_b16 a[106:107], v93 offset:4096
  ds_read_b64_tr_b16 a[160:161], v94 offset:0
  ds_read_b64_tr_b16 a[162:163], v94 offset:4096
  ds_read_b64_tr_b16 a[216:217], v95 offset:0
  ds_read_b64_tr_b16 a[218:219], v95 offset:4096
  ds_read_b64_tr_b16 v[136:137], v96 offset:0
  ds_read_b64_tr_b16 v[138:139], v96 offset:4096
  ds_read_b64_tr_b16 v[192:193], v97 offset:0
  ds_read_b64_tr_b16 v[194:195], v97 offset:4096
  ds_read_b64_tr_b16 v[248:249], v98 offset:0
  ds_read_b64_tr_b16 v[250:251], v98 offset:4096
  s_waitcnt vmcnt(0)
  ds_read_b64_tr_b16 a[52:53], v92 offset:8192
  ds_read_b64_tr_b16 a[54:55], v92 offset:12288
  ds_read_b64_tr_b16 a[108:109], v93 offset:8192
  ds_read_b64_tr_b16 a[110:111], v93 offset:12288
  ds_read_b64_tr_b16 a[164:165], v94 offset:8192
  ds_read_b64_tr_b16 a[166:167], v94 offset:12288
  ds_read_b64_tr_b16 a[220:221], v95 offset:8192
  ds_read_b64_tr_b16 a[222:223], v95 offset:12288
  ds_read_b64_tr_b16 v[140:141], v96 offset:8192
  ds_read_b64_tr_b16 v[142:143], v96 offset:12288
  ds_read_b64_tr_b16 v[196:197], v97 offset:8192
  ds_read_b64_tr_b16 v[198:199], v97 offset:12288
  ds_read_b64_tr_b16 v[252:253], v98 offset:8192
  ds_read_b64_tr_b16 v[254:255], v98 offset:12288
  s_mul_i32 s30, s8, 14336
  v_add_u32 v100, s30, v80
  s_lshl_b32 s30, s8, 10
  v_add_u32 v101, s30, v80
  s_mul_i32 s30, s17, 56
  s_mul_i32 s31, s8, 14
  s_add_u32 s29, s30, s31
  s_lshl_b32 s29, s29, 3
  s_add_u32 s21, s29, 68288512
  s_lshl_b32 s30, s30, 1
  s_add_u32 s30, s30, s31
  s_lshl_b32 s30, s30, 10
  s_add_u32 s18, s30, 53477376
  s_mul_i32 s30, s17, 28
  s_mul_i32 s31, s16, 7
  s_add_u32 s30, s30, s31
  s_lshl_b32 s30, s30, 1
  s_add_u32 s30, s30, s8
  s_lshl_b32 s30, s30, 9
  s_add_u32 s19, s30, 60817408
  s_lshl_b32 s30, s17, 2
  s_add_u32 s30, s30, s16
  s_lshl_b32 s30, s30, 2
  s_add_u32 s30, s30, s8
  s_lshl_b32 s30, s30, 3
  s_add_u32 s20, s30, 68321280
  s_mov_b32 s22, 3216550459
  s_mov_b32 s23, 0xffff0000
  s_waitcnt lgkmcnt(0)
  s_barrier
L_gd_88:
  s_mov_b32 exec_lo, 0x3fff
  s_mov_b32 exec_hi, 0x0
  s_mov_b32 s28, 0
  s_branch L_wf0_90
L_wf_89:
  s_sleep 4
L_wf0_90:
  buffer_load_dwordx2 v[88:89], v81, s[4:7], s21 offen offset:0 sc1
  s_add_u32 s28, s28, 1
  s_cmp_gt_u32 s28, 2000000
  s_cbranch_scc1 L_fail
  s_waitcnt vmcnt(0)
  v_xor_b32 v88, s12, v88
  v_xor_b32 v89, s13, v89
  v_or_b32 v88, v88, v89
  v_cmp_ne_u32 vcc, 0, v88
  s_cbranch_vccnz L_wf_89
  s_mov_b64 exec, -1
  s_add_u32 s30, s18, 0
  buffer_load_dwordx4 v[56:59], v80, s[4:7], s30 offen offset:0 sc1
  s_add_u32 s30, s18, 57344
  buffer_load_dwordx4 v[60:63], v80, s[4:7], s30 offen offset:0 sc1
  s_add_u32 s30, s18, 0
  buffer_load_dwordx4 v[64:67], v80, s[4:7], s30 offen offset:1024 sc1
  s_add_u32 s30, s18, 57344
  buffer_load_dwordx4 v[68:71], v80, s[4:7], s30 offen offset:1024 sc1
  s_add_u32 s30, s18, 0
  buffer_load_dwordx4 v[72:75], v80, s[4:7], s30 offen offset:2048 sc1
  s_add_u32 s30, s18, 57344
  buffer_load_dwordx4 v[76:79], v80, s[4:7], s30 offen offset:2048 sc1
  s_waitcnt vmcnt(5)
  v_mfma_f32_16x16x32_bf16 v[0:3], a[0:3], v[56:59], 0
  v_mfma_f32_16x16x32_bf16 v[8:11], a[56:59], v[56:59], 0
  v_mfma_f32_16x16x32_bf16 v[16:19], a[112:115], v[56:59], 0
  v_mfma_f32_16x16x32_bf16 v[24:27], a[168:171], v[56:59], 0
  v_mfma_f32_16x16x32_bf16 v[32:35], a[224:227], v[56:59], 0
  v_mfma_f32_16x16x32_bf16 v[40:43], v[144:147], v[56:59], 0
  v_mfma_f32_16x16x32_bf16 v[48:51], v[200:203], v[56:59], 0
  s_add_u32 s30, s18, 0
  buffer_load_dwordx4 v[56:59], v80, s[4:7], s30 offen offset:3072 sc1
  s_waitcnt vmcnt(5)
  v_mfma_f32_16x16x32_bf16 v[4:7], a[0:3], v[60:63], 0
  v_mfma_f32_16x16x32_bf16 v[12:15], a[56:59], v[60:63], 0
  v_mfma_f32_16x16x32_bf16 v[20:23], a[112:115], v[60:63], 0
  v_mfma_f32_16x16x32_bf16 v[28:31], a[168:171], v[60:63], 0
  v_mfma_f32_16x16x32_bf16 v[36:39], a[224:227], v[60:63], 0
  v_mfma_f32_16x16x32_bf16 v[44:47], v[144:147], v[60:63], 0
  v_mfma_f32_16x16x32_bf16 v[52:55], v[200:203], v[60:63], 0
  s_add_u32 s30, s18, 57344
  buffer_load_dwordx4 v[60:63], v80, s[4:7], s30 offen offset:3072 sc1
  s_waitcnt vmcnt(5)
  v_mfma_f32_16x16x32_bf16 v[0:3], a[4:7], v[64:67], v[0:3]
  v_mfma_f32_16x16x32_bf16 v[8:11], a[60:63], v[64:67], v[8:11]
  v_mfma_f32_16x16x32_bf16 v[16:19], a[116:119], v[64:67], v[16:19]
  v_mfma_f32_16x16x32_bf16 v[24:27], a[172:175], v[64:67], v[24:27]
  v_mfma_f32_16x16x32_bf16 v[32:35], a[228:231], v[64:67], v[32:35]
  v_mfma_f32_16x16x32_bf16 v[40:43], v[148:151], v[64:67], v[40:43]
  v_mfma_f32_16x16x32_bf16 v[48:51], v[204:207], v[64:67], v[48:51]
  s_add_u32 s30, s18, 4096
  buffer_load_dwordx4 v[64:67], v80, s[4:7], s30 offen offset:0 sc1
  s_waitcnt vmcnt(5)
  v_mfma_f32_16x16x32_bf16 v[4:7], a[4:7], v[68:71], v[4:7]
  v_mfma_f32_16x16x32_bf16 v[12:15], a[60:63], v[68:71], v[12:15]
  v_mfma_f32_16x16x32_bf16 v[20:23], a[116:119], v[68:71], v[20:23]
  v_mfma_f32_16x16x32_bf16 v[28:31], a[172:175], v[68:71], v[28:31]
  v_mfma_f32_16x16x32_bf16 v[36:39], a[228:231], v[68:71], v[36:39]
  v_mfma_f32_16x16x32_bf16 v[44:47], v[148:151], v[68:71], v[44:47]
  v_mfma_f32_16x16x32_bf16 v[52:55], v[204:207], v[68:71], v[52:55]
  s_add_u32 s30, s18, 61440
  buffer_load_dwordx4 v[68:71], v80, s[4:7], s30 offen offset:0 sc1
  s_waitcnt vmcnt(5)
  v_mfma_f32_16x16x32_bf16 v[0:3], a[8:11], v[72:75], v[0:3]
  v_mfma_f32_16x16x32_bf16 v[8:11], a[64:67], v[72:75], v[8:11]
  v_mfma_f32_16x16x32_bf16 v[16:19], a[120:123], v[72:75], v[16:19]
  v_mfma_f32_16x16x32_bf16 v[24:27], a[176:179], v[72:75], v[24:27]
  v_mfma_f32_16x16x32_bf16 v[32:35], a[232:235], v[72:75], v[32:35]
  v_mfma_f32_16x16x32_bf16 v[40:43], v[152:155], v[72:75], v[40:43]
  v_mfma_f32_16x16x32_bf16 v[48:51], v[208:211], v[72:75], v[48:51]
  s_add_u32 s30, s18, 4096
  buffer_load_dwordx4 v[72:75], v80, s[4:7], s30 offen offset:1024 sc1
  s_waitcnt vmcnt(5)
  v_mfma_f32_16x16x32_bf16 v[4:7], a[8:11], v[76:79], v[4:7]
  v_mfma_f32_16x16x32_bf16 v[12:15], a[64:67], v[76:79], v[12:15]
  v_mfma_f32_16x16x32_bf16 v[20:23], a[120:123], v[76:79], v[20:23]
  v_mfma_f32_16x16x32_bf16 v[28:31], a[176:179], v[76:79], v[28:31]
  v_mfma_f32_16x16x32_bf16 v[36:39], a[232:235], v[76:79], v[36:39]
  v_mfma_f32_16x16x32_bf16 v[44:47], v[152:155], v[76:79], v[44:47]
  v_mfma_f32_16x16x32_bf16 v[52:55], v[208:211], v[76:79], v[52:55]
  s_add_u32 s30, s18, 61440
  buffer_load_dwordx4 v[76:79], v80, s[4:7], s30 offen offset:1024 sc1
  s_waitcnt vmcnt(5)
  v_mfma_f32_16x16x32_bf16 v[0:3], a[12:15], v[56:59], v[0:3]
  v_mfma_f32_16x16x32_bf16 v[8:11], a[68:71], v[56:59], v[8:11]
  v_mfma_f32_16x16x32_bf16 v[16:19], a[124:127], v[56:59], v[16:19]
  v_mfma_f32_16x16x32_bf16 v[24:27], a[180:183], v[56:59], v[24:27]
  v_mfma_f32_16x16x32_bf16 v[32:35], a[236:239], v[56:59], v[32:35]
  v_mfma_f32_16x16x32_bf16 v[40:43], v[156:159], v[56:59], v[40:43]
  v_mfma_f32_16x16x32_bf16 v[48:51], v[212:215], v[56:59], v[48:51]
  s_add_u32 s30, s18, 4096
  buffer_load_dwordx4 v[56:59], v80, s[4:7], s30 offen offset:2048 sc1
  s_waitcnt vmcnt(5)
  v_mfma_f32_16x16x32_bf16 v[4:7], a[12:15], v[60:63], v[4:7]
  v_mfma_f32_16x16x32_bf16 v[12:15], a[68:71], v[60:63], v[12:15]
  v_mfma_f32_16x16x32_bf16 v[20:23], a[124:127], v[60:63], v[20:23]
  v_mfma_f32_16x16x32_bf16 v[28:31], a[180:183], v[60:63], v[28:31]
  v_mfma_f32_16x16x32_bf16 v[36:39], a[236:239], v[60:63], v[36:39]
  v_mfma_f32_16x16x32_bf16 v[44:47], v[156:159], v[60:63], v[44:47]
  v_mfma_f32_16x16x32_bf16 v[52:55], v[212:215], v[60:63], v[52:55]
  s_add_u32 s30, s18, 61440
  buffer_load_dwordx4 v[60:63], v80, s[4:7], s30 offen offset:2048 sc1
  s_waitcnt vmcnt(5)
  v_mfma_f32_16x16x32_bf16 v[0:3], a[16:19], v[64:67], v[0:3]
  v_mfma_f32_16x16x32_bf16 v[8:11], a[72:75], v[64:67], v[8:11]
  v_mfma_f32_16x16x32_bf16 v[16:19], a[128:131], v[64:67], v[16:19]
  v_mfma_f32_16x16x32_bf16 v[24:27], a[184:187], v[64:67], v[24:27]
  v_mfma_f32_16x16x32_bf16 v[32:35], a[240:243], v[64:67], v[32:35]
  v_mfma_f32_16x16x32_bf16 v[40:43], v[160:163], v[64:67], v[40:43]
  v_mfma_f32_16x16x32_bf16 v[48:51], v[216:219], v[64:67], v[48:51]
  s_add_u32 s30, s18, 4096
  buffer_load_dwordx4 v[64:67], v80, s[4:7], s30 offen offset:3072 sc1
  s_waitcnt vmcnt(5)
  v_mfma_f32_16x16x32_bf16 v[4:7], a[16:19], v[68:71], v[4:7]
  v_mfma_f32_16x16x32_bf16 v[12:15], a[72:75], v[68:71], v[12:15]
  v_mfma_f32_16x16x32_bf16 v[20:23], a[128:131], v[68:71], v[20:23]
  v_mfma_f32_16x16x32_bf16 v[28:31], a[184:187], v[68:71], v[28:31]
  v_mfma_f32_16x16x32_bf16 v[36:39], a[240:243], v[68:71], v[36:39]
  v_mfma_f32_16x16x32_bf16 v[44:47], v[160:163], v[68:71], v[44:47]
  v_mfma_f32_16x16x32_bf16 v[52:55], v[216:219], v[68:71], v[52:55]
  s_add_u32 s30, s18, 61440
  buffer_load_dwordx4 v[68:71], v80, s[4:7], s30 offen offset:3072 sc1
  s_waitcnt vmcnt(5)
  v_mfma_f32_16x16x32_bf16 v[0:3], a[20:23], v[72:75], v[0:3]
  v_mfma_f32_16x16x32_bf16 v[8:11], a[76:79], v[72:75], v[8:11]
  v_mfma_f32_16x16x32_bf16 v[16:19], a[132:135], v[72:75], v[16:19]
  v_mfma_f32_16x16x32_bf16 v[24:27], a[188:191], v[72:75], v[24:27]
  v_mfma_f32_16x16x32_bf16 v[32:35], a[244:247], v[72:75], v[32:35]
  v_mfma_f32_16x16x32_bf16 v[40:43], v[164:167], v[72:75], v[40:43]
  v_mfma_f32_16x16x32_bf16 v[48:51], v[220:223], v[72:75], v[48:51]
  s_add_u32 s30, s18, 8192
  buffer_load_dwordx4 v[72:75], v80, s[4:7], s30 offen offset:0 sc1
  s_waitcnt vmcnt(5)
  v_mfma_f32_16x16x32_bf16 v[4:7], a[20:23], v[76:79], v[4:7]
  v_mfma_f32_16x16x32_bf16 v[12:15], a[76:79], v[76:79], v[12:15]
  v_mfma_f32_16x16x32_bf16 v[20:23], a[132:135], v[76:79], v[20:23]
  v_mfma_f32_16x16x32_bf16 v[28:31], a[188:191], v[76:79], v[28:31]
  v_mfma_f32_16x16x32_bf16 v[36:39], a[244:247], v[76:79], v[36:39]
  v_mfma_f32_16x16x32_bf16 v[44:47], v[164:167], v[76:79], v[44:47]
  v_mfma_f32_16x16x32_bf16 v[52:55], v[220:223], v[76:79], v[52:55]
  s_add_u32 s30, s18, 65536
  buffer_load_dwordx4 v[76:79], v80, s[4:7], s30 offen offset:0 sc1
  s_waitcnt vmcnt(5)
  v_mfma_f32_16x16x32_bf16 v[0:3], a[24:27], v[56:59], v[0:3]
  v_mfma_f32_16x16x32_bf16 v[8:11], a[80:83], v[56:59], v[8:11]
  v_mfma_f32_16x16x32_bf16 v[16:19], a[136:139], v[56:59], v[16:19]
  v_mfma_f32_16x16x32_bf16 v[24:27], a[192:195], v[56:59], v[24:27]
  v_mfma_f32_16x16x32_bf16 v[32:35], a[248:251], v[56:59], v[32:35]
  v_mfma_f32_16x16x32_bf16 v[40:43], v[168:171], v[56:59], v[40:43]
  v_mfma_f32_16x16x32_bf16 v[48:51], v[224:227], v[56:59], v[48:51]
  s_add_u32 s30, s18, 8192
  buffer_load_dwordx4 v[56:59], v80, s[4:7], s30 offen offset:1024 sc1
  s_waitcnt vmcnt(5)
  v_mfma_f32_16x16x32_bf16 v[4:7], a[24:27], v[60:63], v[4:7]
  v_mfma_f32_16x16x32_bf16 v[12:15], a[80:83], v[60:63], v[12:15]
  v_mfma_f32_16x16x32_bf16 v[20:23], a[136:139], v[60:63], v[20:23]
  v_mfma_f32_16x16x32_bf16 v[28:31], a[192:195], v[60:63], v[28:31]
  v_mfma_f32_16x16x32_bf16 v[36:39], a[248:251], v[60:63], v[36:39]
  v_mfma_f32_16x16x32_bf16 v[44:47], v[168:171], v[60:63], v[44:47]
  v_mfma_f32_16x16x32_bf16 v[52:55], v[224:227], v[60:63], v[52:55]
  s_add_u32 s30, s18, 65536
  buffer_load_dwordx4 v[60:63], v80, s[4:7], s30 offen offset:1024 sc1
  s_waitcnt vmcnt(5)
  v_mfma_f32_16x16x32_bf16 v[0:3], a[28:31], v[64:67], v[0:3]
  v_mfma_f32_16x16x32_bf16 v[8:11], a[84:87], v[64:67], v[8:11]
  v_mfma_f32_16x16x32_bf16 v[16:19], a[140:143], v[64:67], v[16:19]
  v_mfma_f32_16x16x32_bf16 v[24:27], a[196:199], v[64:67], v[24:27]
  v_mfma_f32_16x16x32_bf16 v[32:35], a[252:255], v[64:67], v[32:35]
  v_mfma_f32_16x16x32_bf16 v[40:43], v[172:175], v[64:67], v[40:43]
  v_mfma_f32_16x16x32_bf16 v[48:51], v[228:231], v[64:67], v[48:51]
  s_add_u32 s30, s18, 8192
  buffer_load_dwordx4 v[64:67], v80, s[4:7], s30 offen offset:2048 sc1
  s_waitcnt vmcnt(5)
  v_mfma_f32_16x16x32_bf16 v[4:7], a[28:31], v[68:71], v[4:7]
  v_mfma_f32_16x16x32_bf16 v[12:15], a[84:87], v[68:71], v[12:15]
  v_mfma_f32_16x16x32_bf16 v[20:23], a[140:143], v[68:71], v[20:23]
  v_mfma_f32_16x16x32_bf16 v[28:31], a[196:199], v[68:71], v[28:31]
  v_mfma_f32_16x16x32_bf16 v[36:39], a[252:255], v[68:71], v[36:39]
  v_mfma_f32_16x16x32_bf16 v[44:47], v[172:175], v[68:71], v[44:47]
  v_mfma_f32_16x16x32_bf16 v[52:55], v[228:231], v[68:71], v[52:55]
  s_add_u32 s30, s18, 65536
  buffer_load_dwordx4 v[68:71], v80, s[4:7], s30 offen offset:2048 sc1
  s_waitcnt vmcnt(5)
  v_mfma_f32_16x16x32_bf16 v[0:3], a[32:35], v[72:75], v[0:3]
  v_mfma_f32_16x16x32_bf16 v[8:11], a[88:91], v[72:75], v[8:11]
  v_mfma_f32_16x16x32_bf16 v[16:19], a[144:147], v[72:75], v[16:19]
  v_mfma_f32_16x16x32_bf16 v[24:27], a[200:203], v[72:75], v[24:27]
  v_mfma_f32_16x16x32_bf16 v[32:35], v[120:123], v[72:75], v[32:35]
  v_mfma_f32_16x16x32_bf16 v[40:43], v[176:179], v[72:75], v[40:43]
  v_mfma_f32_16x16x32_bf16 v[48:51], v[232:235], v[72:75], v[48:51]
  s_add_u32 s30, s18, 8192
  buffer_load_dwordx4 v[72:75], v80, s[4:7], s30 offen offset:3072 sc1
  s_waitcnt vmcnt(5)
  v_mfma_f32_16x16x32_bf16 v[4:7], a[32:35], v[76:79], v[4:7]
  v_mfma_f32_16x16x32_bf16 v[12:15], a[88:91], v[76:79], v[12:15]
  v_mfma_f32_16x16x32_bf16 v[20:23], a[144:147], v[76:79], v[20:23]
  v_mfma_f32_16x16x32_bf16 v[28:31], a[200:203], v[76:79], v[28:31]
  v_mfma_f32_16x16x32_bf16 v[36:39], v[120:123], v[76:79], v[36:39]
  v_mfma_f32_16x16x32_bf16 v[44:47], v[176:179], v[76:79], v[44:47]
  v_mfma_f32_16x16x32_bf16 v[52:55], v[232:235], v[76:79], v[52:55]
  s_add_u32 s30, s18, 65536
  buffer_load_dwordx4 v[76:79], v80, s[4:7], s30 offen offset:3072 sc1
  s_waitcnt vmcnt(5)
  v_mfma_f32_16x16x32_bf16 v[0:3], a[36:39], v[56:59], v[0:3]
  v_mfma_f32_16x16x32_bf16 v[8:11], a[92:95], v[56:59], v[8:11]
  v_mfma_f32_16x16x32_bf16 v[16:19], a[148:151], v[56:59], v[16:19]
  v_mfma_f32_16x16x32_bf16 v[24:27], a[204:207], v[56:59], v[24:27]
  v_mfma_f32_16x16x32_bf16 v[32:35], v[124:127], v[56:59], v[32:35]
  v_mfma_f32_16x16x32_bf16 v[40:43], v[180:183], v[56:59], v[40:43]
  v_mfma_f32_16x16x32_bf16 v[48:51], v[236:239], v[56:59], v[48:51]
  s_add_u32 s30, s18, 12288
  buffer_load_dwordx4 v[56:59], v80, s[4:7], s30 offen offset:0 sc1
  s_waitcnt vmcnt(5)
  v_mfma_f32_16x16x32_bf16 v[4:7], a[36:39], v[60:63], v[4:7]
  v_mfma_f32_16x16x32_bf16 v[12:15], a[92:95], v[60:63], v[12:15]
  v_mfma_f32_16x16x32_bf16 v[20:23], a[148:151], v[60:63], v[20:23]
  v_mfma_f32_16x16x32_bf16 v[28:31], a[204:207], v[60:63], v[28:31]
  v_mfma_f32_16x16x32_bf16 v[36:39], v[124:127], v[60:63], v[36:39]
  v_mfma_f32_16x16x32_bf16 v[44:47], v[180:183], v[60:63], v[44:47]
  v_mfma_f32_16x16x32_bf16 v[52:55], v[236:239], v[60:63], v[52:55]
  s_add_u32 s30, s18, 69632
  buffer_load_dwordx4 v[60:63], v80, s[4:7], s30 offen offset:0 sc1
  s_waitcnt vmcnt(5)
  v_mfma_f32_16x16x32_bf16 v[0:3], a[40:43], v[64:67], v[0:3]
  v_mfma_f32_16x16x32_bf16 v[8:11], a[96:99], v[64:67], v[8:11]
  v_mfma_f32_16x16x32_bf16 v[16:19], a[152:155], v[64:67], v[16:19]
  v_mfma_f32_16x16x32_bf16 v[24:27], a[208:211], v[64:67], v[24:27]
  v_mfma_f32_16x16x32_bf16 v[32:35], v[128:131], v[64:67], v[32:35]
  v_mfma_f32_16x16x32_bf16 v[40:43], v[184:187], v[64:67], v[40:43]
  v_mfma_f32_16x16x32_bf16 v[48:51], v[240:243], v[64:67], v[48:51]
  s_add_u32 s30, s18, 12288
  buffer_load_dwordx4 v[64:67], v80, s[4:7], s30 offen offset:1024 sc1
  s_waitcnt vmcnt(5)
  v_mfma_f32_16x16x32_bf16 v[4:7], a[40:43], v[68:71], v[4:7]
  v_mfma_f32_16x16x32_bf16 v[12:15], a[96:99], v[68:71], v[12:15]
  v_mfma_f32_16x16x32_bf16 v[20:23], a[152:155], v[68:71], v[20:23]
  v_mfma_f32_16x16x32_bf16 v[28:31], a[208:211], v[68:71], v[28:31]
  v_mfma_f32_16x16x32_bf16 v[36:39], v[128:131], v[68:71], v[36:39]
  v_mfma_f32_16x16x32_bf16 v[44:47], v[184:187], v[68:71], v[44:47]
  v_mfma_f32_16x16x32_bf16 v[52:55], v[240:243], v[68:71], v[52:55]
  s_add_u32 s30, s18, 69632
  buffer_load_dwordx4 v[68:71], v80, s[4:7], s30 offen offset:1024 sc1
  s_waitcnt vmcnt(5)
  v_mfma_f32_16x16x32_bf16 v[0:3], a[44:47], v[72:75], v[0:3]
  v_mfma_f32_16x16x32_bf16 v[8:11], a[100:103], v[72:75], v[8:11]
  v_mfma_f32_16x16x32_bf16 v[16:19], a[156:159], v[72:75], v[16:19]
  v_mfma_f32_16x16x32_bf16 v[24:27], a[212:215], v[72:75], v[24:27]
  v_mfma_f32_16x16x32_bf16 v[32:35], v[132:135], v[72:75], v[32:35]
  v_mfma_f32_16x16x32_bf16 v[40:43], v[188:191], v[72:75], v[40:43]
  v_mfma_f32_16x16x32_bf16 v[48:51], v[244:247], v[72:75], v[48:51]
  s_waitcnt vmcnt(4)
  v_mfma_f32_16x16x32_bf16 v[4:7], a[44:47], v[76:79], v[4:7]
  v_mfma_f32_16x16x32_bf16 v[12:15], a[100:103], v[76:79], v[12:15]
  v_mfma_f32_16x16x32_bf16 v[20:23], a[156:159], v[76:79], v[20:23]
  v_mfma_f32_16x16x32_bf16 v[28:31], a[212:215], v[76:79], v[28:31]
  v_mfma_f32_16x16x32_bf16 v[36:39], v[132:135], v[76:79], v[36:39]
  v_mfma_f32_16x16x32_bf16 v[44:47], v[188:191], v[76:79], v[44:47]
  v_mfma_f32_16x16x32_bf16 v[52:55], v[244:247], v[76:79], v[52:55]
  s_waitcnt vmcnt(3)
  v_mfma_f32_16x16x32_bf16 v[0:3], a[48:51], v[56:59], v[0:3]
  v_mfma_f32_16x16x32_bf16 v[8:11], a[104:107], v[56:59], v[8:11]
  v_mfma_f32_16x16x32_bf16 v[16:19], a[160:163], v[56:59], v[16:19]
  v_mfma_f32_16x16x32_bf16 v[24:27], a[216:219], v[56:59], v[24:27]
  v_mfma_f32_16x16x32_bf16 v[32:35], v[136:139], v[56:59], v[32:35]
  v_mfma_f32_16x16x32_bf16 v[40:43], v[192:195], v[56:59], v[40:43]
  v_mfma_f32_16x16x32_bf16 v[48:51], v[248:251], v[56:59], v[48:51]
  s_waitcnt vmcnt(2)
  v_mfma_f32_16x16x32_bf16 v[4:7], a[48:51], v[60:63], v[4:7]
  v_mfma_f32_16x16x32_bf16 v[12:15], a[104:107], v[60:63], v[12:15]
  v_mfma_f32_16x16x32_bf16 v[20:23], a[160:163], v[60:63], v[20:23]
  v_mfma_f32_16x16x32_bf16 v[28:31], a[216:219], v[60:63], v[28:31]
  v_mfma_f32_16x16x32_bf16 v[36:39], v[136:139], v[60:63], v[36:39]
  v_mfma_f32_16x16x32_bf16 v[44:47], v[192:195], v[60:63], v[44:47]
  v_mfma_f32_16x16x32_bf16 v[52:55], v[248:251], v[60:63], v[52:55]
  s_waitcnt vmcnt(1)
  v_mfma_f32_16x16x32_bf16 v[0:3], a[52:55], v[64:67], v[0:3]
  v_mfma_f32_16x16x32_bf16 v[8:11], a[108:111], v[64:67], v[8:11]
  v_mfma_f32_16x16x32_bf16 v[16:19], a[164:167], v[64:67], v[16:19]
  v_mfma_f32_16x16x32_bf16 v[24:27], a[220:223], v[64:67], v[24:27]
  v_mfma_f32_16x16x32_bf16 v[32:35], v[140:143], v[64:67], v[32:35]
  v_mfma_f32_16x16x32_bf16 v[40:43], v[196:199], v[64:67], v[40:43]
  v_mfma_f32_16x16x32_bf16 v[48:51], v[252:255], v[64:67], v[48:51]
  s_waitcnt vmcnt(0)
  v_mfma_f32_16x16x32_bf16 v[4:7], a[52:55], v[68:71], v[4:7]
  v_mfma_f32_16x16x32_bf16 v[12:15], a[108:111], v[68:71], v[12:15]
  v_mfma_f32_16x16x32_bf16 v[20:23], a[164:167], v[68:71], v[20:23]
  v_mfma_f32_16x16x32_bf16 v[28:31], a[220:223], v[68:71], v[28:31]
  v_mfma_f32_16x16x32_bf16 v[36:39], v[140:143], v[68:71], v[36:39]
  v_mfma_f32_16x16x32_bf16 v[44:47], v[196:199], v[68:71], v[44:47]
  v_mfma_f32_16x16x32_bf16 v[52:55], v[252:255], v[68:71], v[52:55]
  s_barrier
  ds_write_b128 v100, v[0:3] offset:0
  ds_write_b128 v100, v[4:7] offset:1024
  ds_write_b128 v100, v[8:11] offset:2048
  ds_write_b128 v100, v[12:15] offset:3072
  ds_write_b128 v100, v[16:19] offset:4096
  ds_write_b128 v100, v[20:23] offset:5120
  ds_write_b128 v100, v[24:27] offset:6144
  ds_write_b128 v100, v[28:31] offset:7168
  ds_write_b128 v100, v[32:35] offset:8192
  ds_write_b128 v100, v[36:39] offset:9216
  ds_write_b128 v100, v[40:43] offset:10240
  ds_write_b128 v100, v[44:47] offset:11264
  ds_write_b128 v100, v[48:51] offset:12288
  ds_write_b128 v100, v[52:55] offset:13312
  s_waitcnt lgkmcnt(0)
  s_barrier
  ds_read_b128 v[0:3], v101 offset:0
  ds_read_b128 v[4:7], v101 offset:14336
  ds_read_b128 v[8:11], v101 offset:28672
  ds_read_b128 v[12:15], v101 offset:43008
  ds_read_b128 v[16:19], v101 offset:4096
  ds_read_b128 v[20:23], v101 offset:18432
  ds_read_b128 v[24:27], v101 offset:32768
  ds_read_b128 v[28:31], v101 offset:47104
  ds_read_b128 v[32:35], v101 offset:8192
  ds_read_b128 v[36:39], v101 offset:22528
  ds_read_b128 v[40:43], v101 offset:36864
  ds_read_b128 v[44:47], v101 offset:51200
  ds_read_b128 v[48:51], v101 offset:12288
  ds_read_b128 v[52:55], v101 offset:26624
  ds_read_b128 v[56:59], v101 offset:40960
  ds_read_b128 v[60:63], v101 offset:55296
  s_waitcnt lgkmcnt(12)
  v_pk_add_f32 v[0:1], v[0:1], v[4:5]
  v_pk_add_f32 v[2:3], v[2:3], v[6:7]
  v_pk_add_f32 v[8:9], v[8:9], v[12:13]
  v_pk_add_f32 v[10:11], v[10:11], v[14:15]
  v_pk_add_f32 v[0:1], v[0:1], v[8:9]
  v_pk_add_f32 v[2:3], v[2:3], v[10:11]
  v_cvt_pk_bf16_f32 v4, v0, v1
  v_lshlrev_b32 v0, 16, v4
  v_and_b32 v1, s23, v4
  v_cvt_pk_bf16_f32 v4, v2, v3
  v_lshlrev_b32 v2, 16, v4
  v_and_b32 v3, s23, v4
  v_mul_f32 v4, s22, v0
  v_mul_f32 v5, s22, v1
  v_mul_f32 v6, s22, v2
  v_mul_f32 v7, s22, v3
  v_exp_f32 v4, v4
  v_exp_f32 v5, v5
  v_exp_f32 v6, v6
  v_exp_f32 v7, v7
  v_add_f32 v4, 1.0, v4
  v_add_f32 v5, 1.0, v5
  v_add_f32 v6, 1.0, v6
  v_add_f32 v7, 1.0, v7
  v_rcp_f32 v4, v4
  v_rcp_f32 v5, v5
  v_rcp_f32 v6, v6
  v_rcp_f32 v7, v7
  v_mul_f32 v0, v0, v4
  v_mul_f32 v1, v1, v5
  v_mul_f32 v2, v2, v6
  v_mul_f32 v3, v3, v7
  v_cvt_pk_bf16_f32 v8, v0, v1
  v_cvt_pk_bf16_f32 v9, v2, v3
  s_add_u32 s30, s19, 0
  buffer_store_dwordx2 v[8:9], v81, s[4:7], s30 offen sc1
  s_waitcnt lgkmcnt(8)
  v_pk_add_f32 v[16:17], v[16:17], v[20:21]
  v_pk_add_f32 v[18:19], v[18:19], v[22:23]
  v_pk_add_f32 v[24:25], v[24:25], v[28:29]
  v_pk_add_f32 v[26:27], v[26:27], v[30:31]
  v_pk_add_f32 v[16:17], v[16:17], v[24:25]
  v_pk_add_f32 v[18:19], v[18:19], v[26:27]
  v_cvt_pk_bf16_f32 v20, v16, v17
  v_lshlrev_b32 v16, 16, v20
  v_and_b32 v17, s23, v20
  v_cvt_pk_bf16_f32 v20, v18, v19
  v_lshlrev_b32 v18, 16, v20
  v_and_b32 v19, s23, v20
  v_mul_f32 v20, s22, v16
  v_mul_f32 v21, s22, v17
  v_mul_f32 v22, s22, v18
  v_mul_f32 v23, s22, v19
  v_exp_f32 v20, v20
  v_exp_f32 v21, v21
  v_exp_f32 v22, v22
  v_exp_f32 v23, v23
  v_add_f32 v20, 1.0, v20
  v_add_f32 v21, 1.0, v21
  v_add_f32 v22, 1.0, v22
  v_add_f32 v23, 1.0, v23
  v_rcp_f32 v20, v20
  v_rcp_f32 v21, v21
  v_rcp_f32 v22, v22
  v_rcp_f32 v23, v23
  v_mul_f32 v16, v16, v20
  v_mul_f32 v17, v17, v21
  v_mul_f32 v18, v18, v22
  v_mul_f32 v19, v19, v23
  v_cvt_pk_bf16_f32 v24, v16, v17
  v_cvt_pk_bf16_f32 v25, v18, v19
  s_add_u32 s30, s19, 2048
  buffer_store_dwordx2 v[24:25], v81, s[4:7], s30 offen sc1
  s_waitcnt lgkmcnt(4)
  v_pk_add_f32 v[32:33], v[32:33], v[36:37]
  v_pk_add_f32 v[34:35], v[34:35], v[38:39]
  v_pk_add_f32 v[40:41], v[40:41], v[44:45]
  v_pk_add_f32 v[42:43], v[42:43], v[46:47]
  v_pk_add_f32 v[32:33], v[32:33], v[40:41]
  v_pk_add_f32 v[34:35], v[34:35], v[42:43]
  v_cvt_pk_bf16_f32 v36, v32, v33
  v_lshlrev_b32 v32, 16, v36
  v_and_b32 v33, s23, v36
  v_cvt_pk_bf16_f32 v36, v34, v35
  v_lshlrev_b32 v34, 16, v36
  v_and_b32 v35, s23, v36
  v_mul_f32 v36, s22, v32
  v_mul_f32 v37, s22, v33
  v_mul_f32 v38, s22, v34
  v_mul_f32 v39, s22, v35
  v_exp_f32 v36, v36
  v_exp_f32 v37, v37
  v_exp_f32 v38, v38
  v_exp_f32 v39, v39
  v_add_f32 v36, 1.0, v36
  v_add_f32 v37, 1.0, v37
  v_add_f32 v38, 1.0, v38
  v_add_f32 v39, 1.0, v39
  v_rcp_f32 v36, v36
  v_rcp_f32 v37, v37
  v_rcp_f32 v38, v38
  v_rcp_f32 v39, v39
  v_mul_f32 v32, v32, v36
  v_mul_f32 v33, v33, v37
  v_mul_f32 v34, v34, v38
  v_mul_f32 v35, v35, v39
  v_cvt_pk_bf16_f32 v40, v32, v33
  v_cvt_pk_bf16_f32 v41, v34, v35
  s_add_u32 s30, s19, 4096
  buffer_store_dwordx2 v[40:41], v81, s[4:7], s30 offen sc1
  s_waitcnt lgkmcnt(0)
  v_pk_add_f32 v[48:49], v[48:49], v[52:53]
  v_pk_add_f32 v[50:51], v[50:51], v[54:55]
  v_pk_add_f32 v[56:57], v[56:57], v[60:61]
  v_pk_add_f32 v[58:59], v[58:59], v[62:63]
  v_pk_add_f32 v[48:49], v[48:49], v[56:57]
  v_pk_add_f32 v[50:51], v[50:51], v[58:59]
  v_cvt_pk_bf16_f32 v52, v48, v49
  v_lshlrev_b32 v48, 16, v52
  v_and_b32 v49, s23, v52
  v_cvt_pk_bf16_f32 v52, v50, v51
  v_lshlrev_b32 v50, 16, v52
  v_and_b32 v51, s23, v52
  v_mul_f32 v52, s22, v48
  v_mul_f32 v53, s22, v49
  v_mul_f32 v54, s22, v50
  v_mul_f32 v55, s22, v51
  v_exp_f32 v52, v52
  v_exp_f32 v53, v53
  v_exp_f32 v54, v54
  v_exp_f32 v55, v55
  v_add_f32 v52, 1.0, v52
  v_add_f32 v53, 1.0, v53
  v_add_f32 v54, 1.0, v54
  v_add_f32 v55, 1.0, v55
  v_rcp_f32 v52, v52
  v_rcp_f32 v53, v53
  v_rcp_f32 v54, v54
  v_rcp_f32 v55, v55
  v_mul_f32 v48, v48, v52
  v_mul_f32 v49, v49, v53
  v_mul_f32 v50, v50, v54
  v_mul_f32 v51, v51, v55
  v_cvt_pk_bf16_f32 v56, v48, v49
  v_cvt_pk_bf16_f32 v57, v50, v51
  s_add_u32 s31, s19, 6144
  s_cmp_lt_u32 s8, 2
  s_cselect_b32 s30, s31, 0xf0000000
  buffer_store_dwordx2 v[56:57], v81, s[4:7], s30 offen sc1
  s_waitcnt vmcnt(0)
  buffer_store_dwordx2 v[84:85], v86, s[4:7], s20 offen sc1
  s_add_u32 s21, s21, 3136
  s_add_u32 s18, s18, 802816
  s_add_u32 s19, s19, 200704
  s_add_u32 s20, s20, 896
  s_add_u32 s17, s17, 7
  s_cmp_lt_u32 s17, 64
  s_cbranch_scc1 L_gd_88
  s_branch L_fin_20
L_F_41:
  s_sub_u32 s9, s9, 168
  s_mul_i32 s17, s9, 4682
  s_lshr_b32 s17, s17, 16
  s_mul_i32 s30, s17, 14
  s_sub_u32 s16, s9, s30
  s_load_dwordx2 s[32:33], s[0:1], 0
  s_waitcnt lgkmcnt(0)
  s_and_b32 s33, s33, 0xffff
  s_mov_b32 s34, 1835008
  s_mov_b32 s35, 0x20000
  s_load_dwordx2 s[36:37], s[0:1], 88
  s_waitcnt lgkmcnt(0)
  s_and_b32 s37, s37, 0xffff
  s_mov_b32 s38, 1835008
  s_mov_b32 s39, 0x20000
  v_mbcnt_lo_u32_b32 v102, -1, 0
  v_mbcnt_hi_u32_b32 v102, -1, v102
  v_lshlrev_b32 v100, 4, v102
  v_lshlrev_b32 v101, 3, v102
  v_and_b32 v112, 15, v102
  v_lshrrev_b32 v113, 4, v102
  v_lshrrev_b32 v110, 3, v112
  v_lshlrev_b32 v110, 4, v110
  v_bfe_u32 v111, v112, 1, 1
  v_lshl_add_u32 v110, v111, 3, v110
  v_bfe_u32 v111, v112, 2, 1
  v_lshl_add_u32 v110, v111, 2, v110
  v_and_b32 v111, 1, v112
  v_add_u32 v110, v110, v111
  s_and_b32 s31, s8, 1
  s_lshl_b32 s30, s31, 1
  v_add_u32 v110, s30, v110
  v_mul_u32_u24 v110, 896, v110
  v_lshl_add_u32 v108, v113, 3, v110
  v_lshrrev_b32 v110, 1, v113
  v_mul_u32_u24 v110, 7168, v110
  v_and_b32 v111, 1, v113
  v_lshl_add_u32 v110, v111, 7, v110
  v_lshl_add_u32 v109, v112, 3, v110
  s_lshr_b32 s29, s8, 1
  s_lshl_b32 s30, s16, 1
  s_add_u32 s29, s29, s30
  s_mul_i32 s30, s17, 28672
  s_lshl_b32 s28, s29, 5
  s_add_u32 s22, s30, s28
  s_mul_i32 s30, s17, 28
  s_add_u32 s30, s30, s29
  s_lshl_b32 s30, s30, 1
  s_add_u32 s30, s30, s31
  s_lshl_b32 s30, s30, 9
  s_add_u32 s21, s30, 60817408
  s_lshl_b32 s30, s17, 4
  s_lshl_b32 s31, s8, 2
  s_add_u32 s30, s30, s31
  s_lshl_b32 s31, s30, 5
  s_add_u32 s23, s31, 68190208
  s_mul_i32 s30, s30, 28
  s_lshl_b32 s31, s16, 1
  s_add_u32 s30, s30, s31
  s_lshl_b32 s31, s30, 8
  s_add_u32 s20, s31, 46137344
  s_lshl_b32 s30, s30, 10
  s_add_u32 s18, s30, 16777216
  s_mul_i32 s30, s17, 40960
  s_add_u32 s19, s30, 62914560
  s_lshl_b32 s30, s17, 7
  s_add_u32 s24, s30, 68321280
  s_mov_b32 s27, 0xffff0000
  s_mov_b32 s44, 0
  s_mov_b32 s28, 0
  s_mov_b32 s29, 68222976
  s_branch L_wl0_92
L_wl_91:
  s_sleep 16
L_wl0_92:
  buffer_load_dwordx4 v[0:3], v100, s[4:7], s29 offen offset:0 sc1
  buffer_load_dwordx4 v[4:7], v100, s[4:7], s29 offen offset:1024 sc1
  s_add_u32 s28, s28, 1
  s_cmp_gt_u32 s28, 2000000
  s_cbranch_scc1 L_fail
  s_waitcnt vmcnt(0)
  v_xor_b32 v0, s12, v0
  v_xor_b32 v1, s13, v1
  v_xor_b32 v2, s12, v2
  v_xor_b32 v3, s13, v3
  v_xor_b32 v4, s12, v4
  v_xor_b32 v5, s13, v5
  v_xor_b32 v6, s12, v6
  v_xor_b32 v7, s13, v7
  v_or_b32 v0, v0, v1
  v_or3_b32 v0, v0, v2, v3
  v_or3_b32 v0, v0, v4, v5
  v_or3_b32 v0, v0, v6, v7
  v_cmp_ne_u32 vcc, 0, v0
  s_cbranch_vccnz L_wl_91
  s_mov_b32 s29, 68225024
  s_mov_b32 s28, 0
  s_branch L_wf0_94
L_wf_93:
  s_sleep 16
L_wf0_94:
  buffer_load_dwordx2 v[104:105], v101, s[4:7], s29 offen offset:0 sc1
  s_add_u32 s28, s28, 1
  s_cmp_gt_u32 s28, 2000000
  s_cbranch_scc1 L_fail
  s_waitcnt vmcnt(0)
  v_xor_b32 v104, s12, v104
  v_xor_b32 v105, s13, v105
  v_or_b32 v104, v104, v105
  v_cmp_ne_u32 vcc, 0, v104
  s_cbranch_vccnz L_wf_93
  s_barrier
L_f_95:
  s_lshl_b32 s30, s8, 12
  s_add_u32 s30, s30, s44
  v_add_u32 v106, s30, v100
  s_lshl_b32 s30, s8, 10
  s_add_u32 s30, s30, s44
  v_add_u32 v107, s30, v100
  v_cmp_gt_u32 vcc, 16, v102
  s_sub_u32 s30, s24, 128
  v_mov_b32 v110, s30
  v_mov_b32 v111, s23
  v_cndmask_b32 v110, v110, v111, vcc
  v_add_u32 v110, v110, v101
  s_mov_b32 exec_lo, 0xffffffff
  s_mov_b32 exec_hi, 0x0
  s_mov_b32 s28, 0
  s_branch L_wf0_97
L_wf_96:
  s_sleep 8
L_wf0_97:
  buffer_load_dwordx2 v[104:105], v110, s[4:7], 0 offen offset:0 sc1
  s_add_u32 s28, s28, 1
  s_cmp_gt_u32 s28, 2000000
  s_cbranch_scc1 L_fail
  s_waitcnt vmcnt(0)
  v_xor_b32 v104, s12, v104
  v_xor_b32 v105, s13, v105
  v_or_b32 v104, v104, v105
  v_cmp_ne_u32 vcc, 0, v104
  s_cbranch_vccnz L_wf_96
  s_mov_b64 exec, -1
  s_add_u32 s30, s18, 0
  buffer_load_dwordx4 v[0:3], v100, s[4:7], s30 offen offset:0 sc1
  buffer_load_dwordx4 v[20:23], v100, s[4:7], s30 offen offset:1024 sc1
  s_add_u32 s30, s18, 28672
  buffer_load_dwordx4 v[4:7], v100, s[4:7], s30 offen offset:0 sc1
  buffer_load_dwordx4 v[24:27], v100, s[4:7], s30 offen offset:1024 sc1
  s_add_u32 s30, s18, 57344
  buffer_load_dwordx4 v[8:11], v100, s[4:7], s30 offen offset:0 sc1
  buffer_load_dwordx4 v[28:31], v100, s[4:7], s30 offen offset:1024 sc1
  s_add_u32 s30, s18, 86016
  buffer_load_dwordx4 v[12:15], v100, s[4:7], s30 offen offset:0 sc1
  buffer_load_dwordx4 v[32:35], v100, s[4:7], s30 offen offset:1024 sc1
  buffer_load_dwordx2 v[98:99], v108, s[32:35], s22 offen nt
  buffer_load_dwordx2 v[96:97], v101, s[4:7], s21 offen sc1
  s_mov_b32 s28, 0
  s_branch L_fp0_99
L_fp_98:
  s_sleep 1
L_fp0_99:
  s_lshl_b32 s30, s8, 13
  s_add_u32 s30, s30, s19
  s_add_u32 s31, s30, 4096
  buffer_load_dwordx4 v[40:43], v100, s[4:7], s30 offen offset:0 sc1
  buffer_load_dwordx4 v[60:63], v100, s[4:7], s30 offen offset:1024 sc1
  buffer_load_dwordx4 v[44:47], v100, s[4:7], s30 offen offset:2048 sc1
  buffer_load_dwordx4 v[64:67], v100, s[4:7], s30 offen offset:3072 sc1
  buffer_load_dwordx4 v[48:51], v100, s[4:7], s31 offen offset:0 sc1
  buffer_load_dwordx4 v[68:71], v100, s[4:7], s31 offen offset:1024 sc1
  buffer_load_dwordx4 v[52:55], v100, s[4:7], s31 offen offset:2048 sc1
  buffer_load_dwordx4 v[72:75], v100, s[4:7], s31 offen offset:3072 sc1
  s_lshl_b32 s30, s8, 11
  s_add_u32 s30, s30, s19
  s_add_u32 s30, s30, 32768
  buffer_load_dwordx4 v[56:59], v100, s[4:7], s30 offen offset:0 sc1
  buffer_load_dwordx4 v[76:79], v100, s[4:7], s30 offen offset:1024 sc1
  s_add_u32 s30, s20, 14336
  buffer_load_dwordx2 v[16:17], v109, s[4:7], s20 offen offset:0 sc1
  buffer_load_dwordx2 v[18:19], v109, s[4:7], s30 offen offset:0 sc1
  buffer_load_dwordx2 v[36:37], v109, s[4:7], s20 offen offset:256 sc1
  buffer_load_dwordx2 v[38:39], v109, s[4:7], s30 offen offset:256 sc1
  s_add_u32 s28, s28, 1
  s_cmp_gt_u32 s28, 2000000
  s_cbranch_scc1 L_fail
  s_waitcnt vmcnt(0)
  v_max3_u32 v104, v40, v44, v48
  v_max3_u32 v104, v104, v52, v56
  v_max3_u32 v104, v104, v60, v64
  v_max3_u32 v104, v104, v68, v72
  v_max3_u32 v104, v104, v76, v57
  v_max3_u32 v104, v104, v58, v59
  v_max3_u32 v104, v104, v77, v78
  v_max3_u32 v104, v104, v79, v16
  v_max3_u32 v104, v104, v17, v18
  v_max3_u32 v104, v104, v19, v36
  v_max3_u32 v104, v104, v37, v38
  v_max_u32 v104, v104, v39
  v_cmp_eq_u32 vcc, -1, v104
  s_cbranch_vccnz L_fp_98
  v_mfma_f32_16x16x32_bf16 v[80:83], v[0:3], v[40:43], 0
  v_mfma_f32_16x16x32_bf16 v[84:87], v[0:3], v[60:63], 0
  v_mfma_f32_16x16x32_bf16 v[88:91], v[20:23], v[40:43], 0
  v_mfma_f32_16x16x32_bf16 v[92:95], v[20:23], v[60:63], 0
  v_mfma_f32_16x16x32_bf16 v[80:83], v[4:7], v[44:47], v[80:83]
  v_mfma_f32_16x16x32_bf16 v[84:87], v[4:7], v[64:67], v[84:87]
  v_mfma_f32_16x16x32_bf16 v[88:91], v[24:27], v[44:47], v[88:91]
  v_mfma_f32_16x16x32_bf16 v[92:95], v[24:27], v[64:67], v[92:95]
  v_mfma_f32_16x16x32_bf16 v[80:83], v[8:11], v[48:51], v[80:83]
  v_mfma_f32_16x16x32_bf16 v[84:87], v[8:11], v[68:71], v[84:87]
  v_mfma_f32_16x16x32_bf16 v[88:91], v[28:31], v[48:51], v[88:91]
  v_mfma_f32_16x16x32_bf16 v[92:95], v[28:31], v[68:71], v[92:95]
  v_mfma_f32_16x16x32_bf16 v[80:83], v[12:15], v[52:55], v[80:83]
  v_mfma_f32_16x16x32_bf16 v[84:87], v[12:15], v[72:75], v[84:87]
  v_mfma_f32_16x16x32_bf16 v[88:91], v[32:35], v[52:55], v[88:91]
  v_mfma_f32_16x16x32_bf16 v[92:95], v[32:35], v[72:75], v[92:95]
  v_mfma_f32_16x16x32_bf16 v[80:83], v[16:19], v[56:59], v[80:83]
  v_mfma_f32_16x16x32_bf16 v[84:87], v[16:19], v[76:79], v[84:87]
  v_mfma_f32_16x16x32_bf16 v[88:91], v[36:39], v[56:59], v[88:91]
  v_mfma_f32_16x16x32_bf16 v[92:95], v[36:39], v[76:79], v[92:95]
  s_nop 4
  ds_write_b128 v106, v[80:83] offset:0
  ds_write_b128 v106, v[84:87] offset:1024
  ds_write_b128 v106, v[88:91] offset:2048
  ds_write_b128 v106, v[92:95] offset:3072
  s_waitcnt lgkmcnt(0)
  s_barrier
  ds_read_b128 v[80:83], v107 offset:0
  ds_read_b128 v[84:87], v107 offset:4096
  ds_read_b128 v[88:91], v107 offset:8192
  ds_read_b128 v[92:95], v107 offset:12288
  s_waitcnt lgkmcnt(0)
  v_pk_add_f32 v[80:81], v[80:81], v[84:85]
  v_pk_add_f32 v[82:83], v[82:83], v[86:87]
  v_pk_add_f32 v[88:89], v[88:89], v[92:93]
  v_pk_add_f32 v[90:91], v[90:91], v[94:95]
  v_pk_add_f32 v[80:81], v[80:81], v[88:89]
  v_pk_add_f32 v[82:83], v[82:83], v[90:91]
  v_cvt_pk_bf16_f32 v84, v80, v81
  v_lshlrev_b32 v80, 16, v84
  v_and_b32 v81, s27, v84
  v_lshlrev_b32 v86, 16, v96
  v_and_b32 v87, s27, v96
  v_pk_mul_f32 v[80:81], v[80:81], v[86:87]
  v_cvt_pk_bf16_f32 v84, v80, v81
  v_lshlrev_b32 v80, 16, v84
  v_and_b32 v81, s27, v84
  v_lshlrev_b32 v86, 16, v98
  v_and_b32 v87, s27, v98
  v_pk_add_f32 v[80:81], v[80:81], v[86:87]
  v_cvt_pk_bf16_f32 v88, v80, v81
  v_cvt_pk_bf16_f32 v84, v82, v83
  v_lshlrev_b32 v82, 16, v84
  v_and_b32 v83, s27, v84
  v_lshlrev_b32 v86, 16, v97
  v_and_b32 v87, s27, v97
  v_pk_mul_f32 v[82:83], v[82:83], v[86:87]
  v_cvt_pk_bf16_f32 v84, v82, v83
  v_lshlrev_b32 v82, 16, v84
  v_and_b32 v83, s27, v84
  v_lshlrev_b32 v86, 16, v99
  v_and_b32 v87, s27, v99
  v_pk_add_f32 v[82:83], v[82:83], v[86:87]
  v_cvt_pk_bf16_f32 v89, v82, v83
  buffer_store_dwordx2 v[88:89], v108, s[36:39], s22 offen
  s_xor_b32 s44, s44, 16384
  s_add_u32 s18, s18, 1835008
  s_add_u32 s19, s19, 163840
  s_add_u32 s20, s20, 458752
  s_add_u32 s21, s21, 114688
  s_add_u32 s22, s22, 114688
  s_add_u32 s23, s23, 2048
  s_add_u32 s24, s24, 512
  s_add_u32 s17, s17, 4
  s_cmp_lt_u32 s17, 64
  s_cbranch_scc1 L_f_95
  s_branch L_fin_20
L_rx_23:
  s_mov_b32 s9, s11
  v_mbcnt_lo_u32_b32 v40, -1, 0
  v_mbcnt_hi_u32_b32 v40, -1, v40
  v_mov_b32 v44, s12
  v_mov_b32 v45, s13
  v_mov_b32 v46, 0
  s_mov_b64 exec, 1
  buffer_store_dwordx2 v[44:45], v46, s[4:7], s77 offen offset:0 sc1
  s_mov_b64 exec, -1
  v_and_b32 v114, 15, v40
  v_lshrrev_b32 v115, 4, v40
  v_lshlrev_b32 v103, 4, v40
  s_lshl_b32 s30, s8, 10
  v_add_u32 v101, s30, v103
  v_add_u32 v99, 4096, v101
  s_add_u32 s30, s8, 4
  s_sub_u32 s31, s30, 7
  s_cmp_ge_u32 s30, 7
  s_cselect_b32 s30, s31, s30
  s_lshl_b32 s30, s30, 10
  v_add_u32 v102, s30, v103
  s_add_u32 s30, s8, 5
  s_sub_u32 s31, s30, 7
  s_cmp_ge_u32 s30, 7
  s_cselect_b32 s30, s31, s30
  s_lshl_b32 s30, s30, 10
  v_add_u32 v118, s30, v103
  s_add_u32 s30, s8, 6
  s_sub_u32 s31, s30, 7
  s_cmp_ge_u32 s30, 7
  s_cselect_b32 s30, s31, s30
  s_lshl_b32 s30, s30, 10
  v_add_u32 v119, s30, v103
  v_and_b32 v116, 8, v40
  v_mov_b32 v100, 0x44444444
  v_mov_b32 v117, 0xeeeeeeee
  v_cmp_ne_u32 vcc, 0, v116
  s_nop 1
  v_cndmask_b32 v100, v100, v117, vcc
  v_lshrrev_b32 v116, 2, v114
  v_and_b32 v117, 1, v114
  v_lshl_add_u32 v116, v116, 1, v117
  v_lshlrev_b32 v116, 4, v116
  s_mul_i32 s30, s8, 1792
  v_add_u32 v116, s30, v116
  v_lshl_add_u32 v104, v115, 7, v116
  v_lshrrev_b32 v117, 1, v115
  v_lshl_add_u32 v116, v117, 7, v116
  v_and_b32 v117, 1, v115
  v_lshl_add_u32 v116, v117, 3, v116
  v_add_u32 v105, 1536, v116
  v_lshrrev_b32 v116, 2, v114
  v_xor_b32 v116, v116, v115
  v_and_b32 v116, 1, v116
  v_lshrrev_b32 v117, 3, v114
  v_lshlrev_b32 v117, 1, v117
  v_bfe_u32 v0, v114, 1, 1
  v_add_u32 v117, v117, v0
  v_lshl_add_u32 v117, v116, 2, v117
  v_and_b32 v0, 1, v114
  v_lshlrev_b32 v0, 4, v0
  v_mov_b32 v1, 0x3f80
  v_lshlrev_b32 v0, v0, v1
  v_cmp_eq_u32 vcc, 0, v117
  s_nop 1
  v_cndmask_b32 v106, 0, v0, vcc
  v_cmp_eq_u32 vcc, 1, v117
  s_nop 1
  v_cndmask_b32 v107, 0, v0, vcc
  v_cmp_eq_u32 vcc, 2, v117
  s_nop 1
  v_cndmask_b32 v108, 0, v0, vcc
  v_cmp_eq_u32 vcc, 3, v117
  s_nop 1
  v_cndmask_b32 v109, 0, v0, vcc
  s_mul_i32 s30, s8, 7168
  s_add_u32 s19, s30, 15360
  s_mul_i32 s30, s8, 1664
  s_add_u32 s30, s30, 8192
  v_and_b32 v116, 7, v114
  v_mul_u32_u24 v116, 208, v116
  v_add_u32 v116, s30, v116
  v_lshrrev_b32 v117, 3, v114
  v_lshl_add_u32 v113, v117, 6, v116
  v_lshl_add_u32 v113, v115, 4, v113
  v_mul_u32_u24 v117, 48, v117
  v_add_u32 v116, v116, v117
  v_lshl_add_u32 v116, v115, 3, v116
  v_add_u32 v112, 128, v116
  v_and_b32 v116, 7, v114
  v_mul_u32_u24 v116, 208, v116
  v_add_u32 v116, s30, v116
  v_mov_b32 v0, 0xff800000
  v_mov_b32 v1, 0xff800000
  ds_write_b64 v116, v[0:1] offset:160
  v_and_b32 v114, 31, v40
  v_lshrrev_b32 v115, 5, v40
  s_lshl_b32 s31, s8, 1
  v_add_u32 v115, s31, v115
  v_mul_u32_u24 v116, 208, v115
  v_min_u32 v117, 20, v114
  v_lshl_add_u32 v116, v117, 3, v116
  v_add_u32 v110, 8192, v116
  v_add_u32 v1, 11520, v116
  v_lshrrev_b32 v116, 2, v114
  v_lshlrev_b32 v116, 7, v116
  v_lshl_add_u32 v116, v115, 4, v116
  v_and_b32 v117, 3, v114
  v_lshl_add_u32 v116, v117, 2, v116
  s_lshl_b32 s30, s9, 9
  v_add_u32 v111, s30, v116
  s_lshr_b32 s30, s9, 2
  s_lshl_b32 s30, s30, 9
  s_and_b32 s31, s9, 1
  s_lshl_b32 s31, s31, 8
  s_add_u32 s30, s30, s31
  s_lshr_b32 s31, s9, 1
  s_and_b32 s31, s31, 1
  s_lshl_b32 s31, s31, 7
  s_add_u32 s30, s30, s31
  s_add_u32 s30, s30, 8192
  v_lshlrev_b32 v116, 4, v115
  v_lshl_add_u32 v116, v117, 2, v116
  v_add_u32 v116, s30, v116
  v_cmp_le_u32 vcc, 16, v114
  s_nop 1
  v_cndmask_b32 v111, v111, v116, vcc
  v_mov_b32 v116, 0x80000000
  v_cmp_le_u32 vcc, 20, v114
  s_nop 1
  v_cndmask_b32 v111, v111, v116, vcc
  v_mov_b32 v98, v1
  v_mov_b32 v116, 0
  v_mov_b32 v117, 0
  s_mov_b32 s26, 66584576
  s_mov_b32 s16, 66060288
  s_mov_b32 s17, 67108864
  s_mul_i32 s30, s8, 7168
  s_add_u32 s18, s30, 12845056
  s_mov_b32 s20, 0
  v_lshlrev_b32 v41, 3, v40
  s_mov_b32 s16, 0xf0000000
  s_mov_b32 s17, 0xf0000000
  s_mov_b32 s18, 0xf0000000
  s_mov_b32 s26, 0xf0000000
  s_mov_b32 s20, 62
  s_mov_b32 s46, 1
  s_waitcnt lgkmcnt(0)
  s_barrier
  s_branch L_xbody_100
L_xback_101:
  s_waitcnt vmcnt(0) lgkmcnt(0)
  s_mov_b32 s26, 66584576
  s_mov_b32 s16, 66060288
  s_mov_b32 s17, 67108864
  s_mul_i32 s30, s8, 7168
  s_add_u32 s18, s30, 12845056
  s_mov_b32 s20, 0
  v_mbcnt_lo_u32_b32 v40, -1, 0
  v_mbcnt_hi_u32_b32 v40, -1, v40
  v_lshlrev_b32 v41, 3, v40
  s_mov_b32 s46, 0
  s_mov_b32 s28, 0
  s_mov_b32 s29, 68354048
  s_branch L_wl0_103
L_wl_102:
  s_sleep 1
L_wl0_103:
  buffer_load_dwordx4 v[44:47], v103, s[4:7], s29 offen offset:0 sc1
  s_add_u32 s28, s28, 1
  s_cmp_gt_u32 s28, 2000000
  s_cbranch_scc1 L_fail
  s_waitcnt vmcnt(0)
  v_xor_b32 v44, s12, v44
  v_xor_b32 v45, s13, v45
  v_xor_b32 v46, s12, v46
  v_xor_b32 v47, s13, v47
  v_or_b32 v44, v44, v45
  v_or3_b32 v44, v44, v46, v47
  v_cmp_ne_u32 vcc, 0, v44
  s_cbranch_vccnz L_wl_102
  s_mul_i32 s29, s9, 448
  s_add_u32 s29, s29, 68419584
  s_mov_b32 exec_lo, 0xffffffff
  s_mov_b32 exec_hi, 0xffffff
  s_mov_b32 s28, 0
  s_branch L_wf0_105
L_wf_104:
  s_sleep 1
L_wf0_105:
  buffer_load_dwordx2 v[42:43], v41, s[4:7], s29 offen offset:0 sc1
  s_add_u32 s28, s28, 1
  s_cmp_gt_u32 s28, 2000000
  s_cbranch_scc1 L_fail
  s_waitcnt vmcnt(0)
  v_xor_b32 v42, s12, v42
  v_xor_b32 v43, s13, v43
  v_or_b32 v42, v42, v43
  v_cmp_ne_u32 vcc, 0, v42
  s_cbranch_vccnz L_wf_104
  s_mov_b64 exec, -1
  s_add_u32 s44, s29, 14336
  s_mul_i32 s31, s9, 401408
  s_mul_i32 s30, s8, 100352
  s_add_u32 s31, s31, s30
  s_add_u32 s25, s31, 0
  s_mov_b32 s27, 0
L_grp_106:
  s_add_u32 s30, s8, 0
  s_sub_u32 s31, s30, 7
  s_cmp_ge_u32 s30, 7
  s_cselect_b32 s30, s31, s30
  s_lshl_b32 s30, s30, 1
  s_lshl_b32 s29, s30, 10
  s_sub_u32 s31, s30, 7
  s_cmp_ge_u32 s30, 7
  s_cselect_b32 s30, s31, s30
  s_lshr_b32 s30, s30, 2
  s_cmp_eq_u32 s30, s27
  s_cbranch_scc0 L_gs_108
  s_add_u32 s29, s29, s25
  buffer_load_dwordx4 a[0:3], v103, s[4:7], s29 offen sc1
  s_add_u32 s29, s29, 14336
  buffer_load_dwordx4 a[56:59], v103, s[4:7], s29 offen sc1
  s_add_u32 s29, s29, 14336
  buffer_load_dwordx4 a[112:115], v103, s[4:7], s29 offen sc1
  s_add_u32 s29, s29, 14336
  buffer_load_dwordx4 a[168:171], v103, s[4:7], s29 offen sc1
  s_add_u32 s29, s29, 14336
  buffer_load_dwordx4 a[224:227], v103, s[4:7], s29 offen sc1
  s_add_u32 s29, s29, 14336
  buffer_load_dwordx4 v[144:147], v103, s[4:7], s29 offen sc1
  s_add_u32 s29, s29, 14336
  buffer_load_dwordx4 v[200:203], v103, s[4:7], s29 offen sc1
L_gs_108:
  s_add_u32 s30, s8, 0
  s_sub_u32 s31, s30, 7
  s_cmp_ge_u32 s30, 7
  s_cselect_b32 s30, s31, s30
  s_lshl_b32 s30, s30, 1
  s_add_u32 s30, s30, 1
  s_lshl_b32 s29, s30, 10
  s_sub_u32 s31, s30, 7
  s_cmp_ge_u32 s30, 7
  s_cselect_b32 s30, s31, s30
  s_lshr_b32 s30, s30, 2
  s_cmp_eq_u32 s30, s27
  s_cbranch_scc0 L_gs_109
  s_add_u32 s29, s29, s25
  buffer_load_dwordx4 a[4:7], v103, s[4:7], s29 offen sc1
  s_add_u32 s29, s29, 14336
  buffer_load_dwordx4 a[60:63], v103, s[4:7], s29 offen sc1
  s_add_u32 s29, s29, 14336
  buffer_load_dwordx4 a[116:119], v103, s[4:7], s29 offen sc1
  s_add_u32 s29, s29, 14336
  buffer_load_dwordx4 a[172:175], v103, s[4:7], s29 offen sc1
  s_add_u32 s29, s29, 14336
  buffer_load_dwordx4 a[228:231], v103, s[4:7], s29 offen sc1
  s_add_u32 s29, s29, 14336
  buffer_load_dwordx4 v[148:151], v103, s[4:7], s29 offen sc1
  s_add_u32 s29, s29, 14336
  buffer_load_dwordx4 v[204:207], v103, s[4:7], s29 offen sc1
L_gs_109:
  s_add_u32 s30, s8, 4
  s_sub_u32 s31, s30, 7
  s_cmp_ge_u32 s30, 7
  s_cselect_b32 s30, s31, s30
  s_lshl_b32 s30, s30, 1
  s_lshl_b32 s29, s30, 10
  s_sub_u32 s31, s30, 7
  s_cmp_ge_u32 s30, 7
  s_cselect_b32 s30, s31, s30
  s_lshr_b32 s30, s30, 2
  s_cmp_eq_u32 s30, s27
  s_cbranch_scc0 L_gs_110
  s_add_u32 s29, s29, s25
  buffer_load_dwordx4 a[8:11], v103, s[4:7], s29 offen sc1
  s_add_u32 s29, s29, 14336
  buffer_load_dwordx4 a[64:67], v103, s[4:7], s29 offen sc1
  s_add_u32 s29, s29, 14336
  buffer_load_dwordx4 a[120:123], v103, s[4:7], s29 offen sc1
  s_add_u32 s29, s29, 14336
  buffer_load_dwordx4 a[176:179], v103, s[4:7], s29 offen sc1
  s_add_u32 s29, s29, 14336
  buffer_load_dwordx4 a[232:235], v103, s[4:7], s29 offen sc1
  s_add_u32 s29, s29, 14336
  buffer_load_dwordx4 v[152:155], v103, s[4:7], s29 offen sc1
  s_add_u32 s29, s29, 14336
  buffer_load_dwordx4 v[208:211], v103, s[4:7], s29 offen sc1
L_gs_110:
  s_add_u32 s30, s8, 4
  s_sub_u32 s31, s30, 7
  s_cmp_ge_u32 s30, 7
  s_cselect_b32 s30, s31, s30
  s_lshl_b32 s30, s30, 1
  s_add_u32 s30, s30, 1
  s_lshl_b32 s29, s30, 10
  s_sub_u32 s31, s30, 7
  s_cmp_ge_u32 s30, 7
  s_cselect_b32 s30, s31, s30
  s_lshr_b32 s30, s30, 2
  s_cmp_eq_u32 s30, s27
  s_cbranch_scc0 L_gs_111
  s_add_u32 s29, s29, s25
  buffer_load_dwordx4 a[12:15], v103, s[4:7], s29 offen sc1
  s_add_u32 s29, s29, 14336
  buffer_load_dwordx4 a[68:71], v103, s[4:7], s29 offen sc1
  s_add_u32 s29, s29, 14336
  buffer_load_dwordx4 a[124:127], v103, s[4:7], s29 offen sc1
  s_add_u32 s29, s29, 14336
  buffer_load_dwordx4 a[180:183], v103, s[4:7], s29 offen sc1
  s_add_u32 s29, s29, 14336
  buffer_load_dwordx4 a[236:239], v103, s[4:7], s29 offen sc1
  s_add_u32 s29, s29, 14336
  buffer_load_dwordx4 v[156:159], v103, s[4:7], s29 offen sc1
  s_add_u32 s29, s29, 14336
  buffer_load_dwordx4 v[212:215], v103, s[4:7], s29 offen sc1
L_gs_111:
  s_add_u32 s30, s8, 1
  s_sub_u32 s31, s30, 7
  s_cmp_ge_u32 s30, 7
  s_cselect_b32 s30, s31, s30
  s_lshl_b32 s30, s30, 1
  s_lshl_b32 s29, s30, 10
  s_sub_u32 s31, s30, 7
  s_cmp_ge_u32 s30, 7
  s_cselect_b32 s30, s31, s30
  s_lshr_b32 s30, s30, 2
  s_cmp_eq_u32 s30, s27
  s_cbranch_scc0 L_gs_112
  s_add_u32 s29, s29, s25
  buffer_load_dwordx4 a[16:19], v103, s[4:7], s29 offen sc1
  s_add_u32 s29, s29, 14336
  buffer_load_dwordx4 a[72:75], v103, s[4:7], s29 offen sc1
  s_add_u32 s29, s29, 14336
  buffer_load_dwordx4 a[128:131], v103, s[4:7], s29 offen sc1
  s_add_u32 s29, s29, 14336
  buffer_load_dwordx4 a[184:187], v103, s[4:7], s29 offen sc1
  s_add_u32 s29, s29, 14336
  buffer_load_dwordx4 a[240:243], v103, s[4:7], s29 offen sc1
  s_add_u32 s29, s29, 14336
  buffer_load_dwordx4 v[160:163], v103, s[4:7], s29 offen sc1
  s_add_u32 s29, s29, 14336
  buffer_load_dwordx4 v[216:219], v103, s[4:7], s29 offen sc1
L_gs_112:
  s_add_u32 s30, s8, 1
  s_sub_u32 s31, s30, 7
  s_cmp_ge_u32 s30, 7
  s_cselect_b32 s30, s31, s30
  s_lshl_b32 s30, s30, 1
  s_add_u32 s30, s30, 1
  s_lshl_b32 s29, s30, 10
  s_sub_u32 s31, s30, 7
  s_cmp_ge_u32 s30, 7
  s_cselect_b32 s30, s31, s30
  s_lshr_b32 s30, s30, 2
  s_cmp_eq_u32 s30, s27
  s_cbranch_scc0 L_gs_113
  s_add_u32 s29, s29, s25
  buffer_load_dwordx4 a[20:23], v103, s[4:7], s29 offen sc1
  s_add_u32 s29, s29, 14336
  buffer_load_dwordx4 a[76:79], v103, s[4:7], s29 offen sc1
  s_add_u32 s29, s29, 14336
  buffer_load_dwordx4 a[132:135], v103, s[4:7], s29 offen sc1
  s_add_u32 s29, s29, 14336
  buffer_load_dwordx4 a[188:191], v103, s[4:7], s29 offen sc1
  s_add_u32 s29, s29, 14336
  buffer_load_dwordx4 a[244:247], v103, s[4:7], s29 offen sc1
  s_add_u32 s29, s29, 14336
  buffer_load_dwordx4 v[164:167], v103, s[4:7], s29 offen sc1
  s_add_u32 s29, s29, 14336
  buffer_load_dwordx4 v[220:223], v103, s[4:7], s29 offen sc1
L_gs_113:
  s_add_u32 s30, s8, 2
  s_sub_u32 s31, s30, 7
  s_cmp_ge_u32 s30, 7
  s_cselect_b32 s30, s31, s30
  s_lshl_b32 s30, s30, 1
  s_lshl_b32 s29, s30, 10
  s_sub_u32 s31, s30, 7
  s_cmp_ge_u32 s30, 7
  s_cselect_b32 s30, s31, s30
  s_lshr_b32 s30, s30, 2
  s_cmp_eq_u32 s30, s27
  s_cbranch_scc0 L_gs_114
  s_add_u32 s29, s29, s25
  buffer_load_dwordx4 a[24:27], v103, s[4:7], s29 offen sc1
  s_add_u32 s29, s29, 14336
  buffer_load_dwordx4 a[80:83], v103, s[4:7], s29 offen sc1
  s_add_u32 s29, s29, 14336
  buffer_load_dwordx4 a[136:139], v103, s[4:7], s29 offen sc1
  s_add_u32 s29, s29, 14336
  buffer_load_dwordx4 a[192:195], v103, s[4:7], s29 offen sc1
  s_add_u32 s29, s29, 14336
  buffer_load_dwordx4 a[248:251], v103, s[4:7], s29 offen sc1
  s_add_u32 s29, s29, 14336
  buffer_load_dwordx4 v[168:171], v103, s[4:7], s29 offen sc1
  s_add_u32 s29, s29, 14336
  buffer_load_dwordx4 v[224:227], v103, s[4:7], s29 offen sc1
L_gs_114:
  buffer_load_dwordx2 v[42:43], v41, s[4:7], s44 offen sc1
  s_add_u32 s30, s8, 2
  s_sub_u32 s31, s30, 7
  s_cmp_ge_u32 s30, 7
  s_cselect_b32 s30, s31, s30
  s_lshl_b32 s30, s30, 1
  s_add_u32 s30, s30, 1
  s_lshl_b32 s29, s30, 10
  s_sub_u32 s31, s30, 7
  s_cmp_ge_u32 s30, 7
  s_cselect_b32 s30, s31, s30
  s_lshr_b32 s30, s30, 2
  s_cmp_eq_u32 s30, s27
  s_cbranch_scc0 L_gs_115
  s_add_u32 s29, s29, s25
  buffer_load_dwordx4 a[28:31], v103, s[4:7], s29 offen sc1
  s_add_u32 s29, s29, 14336
  buffer_load_dwordx4 a[84:87], v103, s[4:7], s29 offen sc1
  s_add_u32 s29, s29, 14336
  buffer_load_dwordx4 a[140:143], v103, s[4:7], s29 offen sc1
  s_add_u32 s29, s29, 14336
  buffer_load_dwordx4 a[196:199], v103, s[4:7], s29 offen sc1
  s_add_u32 s29, s29, 14336
  buffer_load_dwordx4 a[252:255], v103, s[4:7], s29 offen sc1
  s_add_u32 s29, s29, 14336
  buffer_load_dwordx4 v[172:175], v103, s[4:7], s29 offen sc1
  s_add_u32 s29, s29, 14336
  buffer_load_dwordx4 v[228:231], v103, s[4:7], s29 offen sc1
L_gs_115:
  s_add_u32 s30, s8, 3
  s_sub_u32 s31, s30, 7
  s_cmp_ge_u32 s30, 7
  s_cselect_b32 s30, s31, s30
  s_lshl_b32 s30, s30, 1
  s_lshl_b32 s29, s30, 10
  s_sub_u32 s31, s30, 7
  s_cmp_ge_u32 s30, 7
  s_cselect_b32 s30, s31, s30
  s_lshr_b32 s30, s30, 2
  s_cmp_eq_u32 s30, s27
  s_cbranch_scc0 L_gs_116
  s_add_u32 s29, s29, s25
  buffer_load_dwordx4 a[32:35], v103, s[4:7], s29 offen sc1
  s_add_u32 s29, s29, 14336
  buffer_load_dwordx4 a[88:91], v103, s[4:7], s29 offen sc1
  s_add_u32 s29, s29, 14336
  buffer_load_dwordx4 a[144:147], v103, s[4:7], s29 offen sc1
  s_add_u32 s29, s29, 14336
  buffer_load_dwordx4 a[200:203], v103, s[4:7], s29 offen sc1
  s_add_u32 s29, s29, 14336
  buffer_load_dwordx4 v[120:123], v103, s[4:7], s29 offen sc1
  s_add_u32 s29, s29, 14336
  buffer_load_dwordx4 v[176:179], v103, s[4:7], s29 offen sc1
  s_add_u32 s29, s29, 14336
  buffer_load_dwordx4 v[232:235], v103, s[4:7], s29 offen sc1
L_gs_116:
  s_add_u32 s30, s8, 3
  s_sub_u32 s31, s30, 7
  s_cmp_ge_u32 s30, 7
  s_cselect_b32 s30, s31, s30
  s_lshl_b32 s30, s30, 1
  s_add_u32 s30, s30, 1
  s_lshl_b32 s29, s30, 10
  s_sub_u32 s31, s30, 7
  s_cmp_ge_u32 s30, 7
  s_cselect_b32 s30, s31, s30
  s_lshr_b32 s30, s30, 2
  s_cmp_eq_u32 s30, s27
  s_cbranch_scc0 L_gs_117
  s_add_u32 s29, s29, s25
  buffer_load_dwordx4 a[36:39], v103, s[4:7], s29 offen sc1
  s_add_u32 s29, s29, 14336
  buffer_load_dwordx4 a[92:95], v103, s[4:7], s29 offen sc1
  s_add_u32 s29, s29, 14336
  buffer_load_dwordx4 a[148:151], v103, s[4:7], s29 offen sc1
  s_add_u32 s29, s29, 14336
  buffer_load_dwordx4 a[204:207], v103, s[4:7], s29 offen sc1
  s_add_u32 s29, s29, 14336
  buffer_load_dwordx4 v[124:127], v103, s[4:7], s29 offen sc1
  s_add_u32 s29, s29, 14336
  buffer_load_dwordx4 v[180:183], v103, s[4:7], s29 offen sc1
  s_add_u32 s29, s29, 14336
  buffer_load_dwordx4 v[236:239], v103, s[4:7], s29 offen sc1
L_gs_117:
  s_add_u32 s30, s8, 5
  s_sub_u32 s31, s30, 7
  s_cmp_ge_u32 s30, 7
  s_cselect_b32 s30, s31, s30
  s_lshl_b32 s30, s30, 1
  s_lshl_b32 s29, s30, 10
  s_sub_u32 s31, s30, 7
  s_cmp_ge_u32 s30, 7
  s_cselect_b32 s30, s31, s30
  s_lshr_b32 s30, s30, 2
  s_cmp_eq_u32 s30, s27
  s_cbranch_scc0 L_gs_118
  s_add_u32 s29, s29, s25
  buffer_load_dwordx4 a[40:43], v103, s[4:7], s29 offen sc1
  s_add_u32 s29, s29, 14336
  buffer_load_dwordx4 a[96:99], v103, s[4:7], s29 offen sc1
  s_add_u32 s29, s29, 14336
  buffer_load_dwordx4 a[152:155], v103, s[4:7], s29 offen sc1
  s_add_u32 s29, s29, 14336
  buffer_load_dwordx4 a[208:211], v103, s[4:7], s29 offen sc1
  s_add_u32 s29, s29, 14336
  buffer_load_dwordx4 v[128:131], v103, s[4:7], s29 offen sc1
  s_add_u32 s29, s29, 14336
  buffer_load_dwordx4 v[184:187], v103, s[4:7], s29 offen sc1
  s_add_u32 s29, s29, 14336
  buffer_load_dwordx4 v[240:243], v103, s[4:7], s29 offen sc1
L_gs_118:
  s_add_u32 s30, s8, 5
  s_sub_u32 s31, s30, 7
  s_cmp_ge_u32 s30, 7
  s_cselect_b32 s30, s31, s30
  s_lshl_b32 s30, s30, 1
  s_add_u32 s30, s30, 1
  s_lshl_b32 s29, s30, 10
  s_sub_u32 s31, s30, 7
  s_cmp_ge_u32 s30, 7
  s_cselect_b32 s30, s31, s30
  s_lshr_b32 s30, s30, 2
  s_cmp_eq_u32 s30, s27
  s_cbranch_scc0 L_gs_119
  s_add_u32 s29, s29, s25
  buffer_load_dwordx4 a[44:47], v103, s[4:7], s29 offen sc1
  s_add_u32 s29, s29, 14336
  buffer_load_dwordx4 a[100:103], v103, s[4:7], s29 offen sc1
  s_add_u32 s29, s29, 14336
  buffer_load_dwordx4 a[156:159], v103, s[4:7], s29 offen sc1
  s_add_u32 s29, s29, 14336
  buffer_load_dwordx4 a[212:215], v103, s[4:7], s29 offen sc1
  s_add_u32 s29, s29, 14336
  buffer_load_dwordx4 v[132:135], v103, s[4:7], s29 offen sc1
  s_add_u32 s29, s29, 14336
  buffer_load_dwordx4 v[188:191], v103, s[4:7], s29 offen sc1
  s_add_u32 s29, s29, 14336
  buffer_load_dwordx4 v[244:247], v103, s[4:7], s29 offen sc1
L_gs_119:
  s_add_u32 s30, s8, 6
  s_sub_u32 s31, s30, 7
  s_cmp_ge_u32 s30, 7
  s_cselect_b32 s30, s31, s30
  s_lshl_b32 s30, s30, 1
  s_lshl_b32 s29, s30, 10
  s_sub_u32 s31, s30, 7
  s_cmp_ge_u32 s30, 7
  s_cselect_b32 s30, s31, s30
  s_lshr_b32 s30, s30, 2
  s_cmp_eq_u32 s30, s27
  s_cbranch_scc0 L_gs_120
  s_add_u32 s29, s29, s25
  buffer_load_dwordx4 a[48:51], v103, s[4:7], s29 offen sc1
  s_add_u32 s29, s29, 14336
  buffer_load_dwordx4 a[104:107], v103, s[4:7], s29 offen sc1
  s_add_u32 s29, s29, 14336
  buffer_load_dwordx4 a[160:163], v103, s[4:7], s29 offen sc1
  s_add_u32 s29, s29, 14336
  buffer_load_dwordx4 a[216:219], v103, s[4:7], s29 offen sc1
  s_add_u32 s29, s29, 14336
  buffer_load_dwordx4 v[136:139], v103, s[4:7], s29 offen sc1
  s_add_u32 s29, s29, 14336
  buffer_load_dwordx4 v[192:195], v103, s[4:7], s29 offen sc1
  s_add_u32 s29, s29, 14336
  buffer_load_dwordx4 v[248:251], v103, s[4:7], s29 offen sc1
L_gs_120:
  s_add_u32 s30, s8, 6
  s_sub_u32 s31, s30, 7
  s_cmp_ge_u32 s30, 7
  s_cselect_b32 s30, s31, s30
  s_lshl_b32 s30, s30, 1
  s_add_u32 s30, s30, 1
  s_lshl_b32 s29, s30, 10
  s_sub_u32 s31, s30, 7
  s_cmp_ge_u32 s30, 7
  s_cselect_b32 s30, s31, s30
  s_lshr_b32 s30, s30, 2
  s_cmp_eq_u32 s30, s27
  s_cbranch_scc0 L_gs_121
  s_add_u32 s29, s29, s25
  buffer_load_dwordx4 a[52:55], v103, s[4:7], s29 offen sc1
  s_add_u32 s29, s29, 14336
  buffer_load_dwordx4 a[108:111], v103, s[4:7], s29 offen sc1
  s_add_u32 s29, s29, 14336
  buffer_load_dwordx4 a[164:167], v103, s[4:7], s29 offen sc1
  s_add_u32 s29, s29, 14336
  buffer_load_dwordx4 a[220:223], v103, s[4:7], s29 offen sc1
  s_add_u32 s29, s29, 14336
  buffer_load_dwordx4 v[140:143], v103, s[4:7], s29 offen sc1
  s_add_u32 s29, s29, 14336
  buffer_load_dwordx4 v[196:199], v103, s[4:7], s29 offen sc1
  s_add_u32 s29, s29, 14336
  buffer_load_dwordx4 v[252:255], v103, s[4:7], s29 offen sc1
L_gs_121:
  s_cmp_eq_u32 s27, 1
  s_cbranch_scc1 L_grpd_107
  s_waitcnt vmcnt(14)
  s_mov_b32 exec_lo, 0xffffffff
  s_mov_b32 exec_hi, 0xffffff
  v_xor_b32 v42, s12, v42
  v_xor_b32 v43, s13, v43
  v_or_b32 v42, v42, v43
  v_cmp_ne_u32 vcc, 0, v42
  s_mov_b64 exec, -1
  s_cbranch_vccz L_fok_122
  s_mov_b32 exec_lo, 0xffffffff
  s_mov_b32 exec_hi, 0xffffff
  s_mov_b32 s28, 0
  s_branch L_wf0_124
L_wf_123:
  s_sleep 1
L_wf0_124:
  buffer_load_dwordx2 v[42:43], v41, s[4:7], s44 offen offset:0 sc1
  s_add_u32 s28, s28, 1
  s_cmp_gt_u32 s28, 2000000
  s_cbranch_scc1 L_fail
  s_waitcnt vmcnt(0)
  v_xor_b32 v42, s12, v42
  v_xor_b32 v43, s13, v43
  v_or_b32 v42, v42, v43
  v_cmp_ne_u32 vcc, 0, v42
  s_cbranch_vccnz L_wf_123
  s_mov_b64 exec, -1
L_fok_122:
  s_mov_b32 s27, 1
  s_branch L_grp_106
L_grpd_107:
  s_mov_b32 s28, 0
  s_mov_b32 s29, 68173824
  s_branch L_wl0_126
L_wl_125:
  s_sleep 1
L_wl0_126:
  buffer_load_dwordx4 v[44:47], v103, s[4:7], s29 offen offset:0 sc1
  buffer_load_dwordx4 v[48:51], v103, s[4:7], s29 offen offset:1024 sc1
  s_add_u32 s28, s28, 1
  s_cmp_gt_u32 s28, 2000000
  s_cbranch_scc1 L_fail
  s_waitcnt vmcnt(0)
  v_xor_b32 v44, s12, v44
  v_xor_b32 v45, s13, v45
  v_xor_b32 v46, s12, v46
  v_xor_b32 v47, s13, v47
  v_xor_b32 v48, s12, v48
  v_xor_b32 v49, s13, v49
  v_xor_b32 v50, s12, v50
  v_xor_b32 v51, s13, v51
  v_or_b32 v44, v44, v45
  v_or3_b32 v44, v44, v46, v47
  v_or3_b32 v44, v44, v48, v49
  v_or3_b32 v44, v44, v50, v51
  v_cmp_ne_u32 vcc, 0, v44
  s_cbranch_vccnz L_wl_125
  s_waitcnt lgkmcnt(0)
  s_barrier
L_xbody_100:
  s_add_u32 s30, s18, 4096
  buffer_load_dwordx4 v[56:59], v103, s[4:7], s18 offen offset:0 sc1
  buffer_load_dwordx4 v[60:63], v103, s[4:7], s18 offen offset:1024 sc1
  buffer_load_dwordx4 v[64:67], v103, s[4:7], s18 offen offset:2048 sc1
  buffer_load_dwordx4 v[68:71], v103, s[4:7], s18 offen offset:3072 sc1
  buffer_load_dwordx4 v[72:75], v103, s[4:7], s30 offen offset:0 sc1
  buffer_load_dwordx4 v[76:79], v103, s[4:7], s30 offen offset:1024 sc1
  buffer_load_dwordx4 v[80:83], v103, s[4:7], s30 offen offset:2048 sc1
  s_add_u32 s18, s18, 28672
  v_mov_b32 v28, 0
  v_mov_b32 v29, 0
  v_mov_b32 v30, 0
  v_mov_b32 v31, 0
  v_mov_b32 v32, 0
  v_mov_b32 v33, 0
  v_mov_b32 v34, 0
  v_mov_b32 v35, 0
  v_mov_b32 v36, 0
  v_mov_b32 v37, 0
  v_mov_b32 v38, 0
  v_mov_b32 v39, 0
  v_mov_b32 v40, 0
  v_mov_b32 v41, 0
  v_mov_b32 v42, 0
  v_mov_b32 v43, 0
  v_mov_b32 v44, 0
  v_mov_b32 v45, 0
  v_mov_b32 v46, 0
  v_mov_b32 v47, 0
  v_mov_b32 v48, 0
  v_mov_b32 v49, 0
  v_mov_b32 v50, 0
  v_mov_b32 v51, 0
  v_mov_b32 v52, 0
  v_mov_b32 v53, 0
  v_mov_b32 v54, 0
  v_mov_b32 v55, 0
L_xloop_127:
  s_mov_b32 s24, 0
  buffer_load_dwordx4 v[0:3], v101, s[4:7], s16 offen offset:0 sc1
  buffer_load_dwordx4 v[4:7], v102, s[4:7], s16 offen offset:0 sc1
  s_nop 12
  s_nop 12
  buffer_load_dwordx4 v[84:87], v101, s[4:7], s16 offen offset:0 sc1
  buffer_load_dwordx4 v[88:91], v102, s[4:7], s16 offen offset:0 sc1
  s_branch L_poll0_131
L_poll_130:
  buffer_load_dwordx4 v[84:87], v101, s[4:7], s16 offen offset:0 sc1
  buffer_load_dwordx4 v[88:91], v102, s[4:7], s16 offen offset:0 sc1
  s_nop 3
  v_mov_b32 v28, 0
  v_mov_b32 v29, 0
  v_mov_b32 v30, 0
  v_mov_b32 v31, 0
  v_mov_b32 v32, 0
  v_mov_b32 v33, 0
  v_mov_b32 v34, 0
  v_mov_b32 v35, 0
L_poll0_131:
  s_add_u32 s24, s24, 1
  s_waitcnt vmcnt(2)
  v_max_u32 v114, v0, v4
  v_cmp_eq_u32 vcc, -1, v114
  v_smfmac_f32_16x16x64_bf16 v[28:31], v[0:3], a[0:7], v100
  v_smfmac_f32_16x16x64_bf16 v[32:35], v[0:3], a[56:63], v100
  s_cbranch_vccz L_xokA_128
  buffer_load_dwordx4 v[0:3], v101, s[4:7], s16 offen offset:0 sc1
  buffer_load_dwordx4 v[4:7], v102, s[4:7], s16 offen offset:0 sc1
  s_nop 3
  v_mov_b32 v28, 0
  v_mov_b32 v29, 0
  v_mov_b32 v30, 0
  v_mov_b32 v31, 0
  v_mov_b32 v32, 0
  v_mov_b32 v33, 0
  v_mov_b32 v34, 0
  v_mov_b32 v35, 0
  s_cmp_gt_u32 s24, 400000
  s_cbranch_scc1 L_fail
  s_waitcnt vmcnt(2)
  v_max_u32 v114, v84, v88
  v_cmp_eq_u32 vcc, -1, v114
  v_smfmac_f32_16x16x64_bf16 v[28:31], v[84:87], a[0:7], v100
  v_smfmac_f32_16x16x64_bf16 v[32:35], v[84:87], a[56:63], v100
  s_cbranch_vccnz L_poll_130
  ds_write_b128 v101, v[84:87]
  ds_write_b128 v99, v[88:91]
  v_smfmac_f32_16x16x64_bf16 v[36:39], v[84:87], a[112:119], v100
  v_smfmac_f32_16x16x64_bf16 v[40:43], v[84:87], a[168:175], v100
  v_smfmac_f32_16x16x64_bf16 v[44:47], v[84:87], a[224:231], v100
  v_smfmac_f32_16x16x64_bf16 v[48:51], v[84:87], v[144:151], v100
  s_waitcnt lgkmcnt(0)
  s_barrier
  ds_read_b128 v[8:11], v101 offset:1024
  v_smfmac_f32_16x16x64_bf16 v[52:55], v[84:87], v[200:207], v100
  ds_read_b128 v[12:15], v101 offset:2048
  v_smfmac_f32_16x16x64_bf16 v[28:31], v[88:91], a[8:15], v100
  ds_read_b128 v[16:19], v101 offset:3072
  v_smfmac_f32_16x16x64_bf16 v[32:35], v[88:91], a[64:71], v100
  ds_read_b128 v[20:23], v118
  v_smfmac_f32_16x16x64_bf16 v[36:39], v[88:91], a[120:127], v100
  ds_read_b128 v[24:27], v119
  v_smfmac_f32_16x16x64_bf16 v[40:43], v[88:91], a[176:183], v100
  v_smfmac_f32_16x16x64_bf16 v[44:47], v[88:91], a[232:239], v100
  v_smfmac_f32_16x16x64_bf16 v[48:51], v[88:91], v[152:159], v100
  v_smfmac_f32_16x16x64_bf16 v[52:55], v[88:91], v[208:215], v100
L_xjoin_129:
  s_waitcnt lgkmcnt(4)
  v_smfmac_f32_16x16x64_bf16 v[28:31], v[8:11], a[16:23], v100
  s_waitcnt lgkmcnt(3)
  v_smfmac_f32_16x16x64_bf16 v[28:31], v[12:15], a[24:31], v100
  s_waitcnt lgkmcnt(2)
  v_smfmac_f32_16x16x64_bf16 v[28:31], v[16:19], a[32:39], v100
  s_waitcnt lgkmcnt(1)
  v_smfmac_f32_16x16x64_bf16 v[28:31], v[20:23], a[40:47], v100
  s_waitcnt lgkmcnt(0)
  v_smfmac_f32_16x16x64_bf16 v[28:31], v[24:27], a[48:55], v100
  v_smfmac_f32_16x16x64_bf16 v[32:35], v[8:11], a[72:79], v100
  s_waitcnt vmcnt(0)
  ds_read_b128 v[84:87], v104
  v_smfmac_f32_16x16x64_bf16 v[32:35], v[12:15], a[80:87], v100
  ds_read_b128 v[88:91], v104 offset:512
  v_smfmac_f32_16x16x64_bf16 v[32:35], v[16:19], a[88:95], v100
  ds_read_b128 v[92:95], v104 offset:1024
  v_smfmac_f32_16x16x64_bf16 v[32:35], v[20:23], a[96:103], v100
  ds_read_b64 v[96:97], v105
  v_smfmac_f32_16x16x64_bf16 v[32:35], v[24:27], a[104:111], v100
  v_smfmac_f32_16x16x64_bf16 v[36:39], v[8:11], a[128:135], v100
  v_cvt_pk_bf16_f32 v28, v28, v29
  v_smfmac_f32_16x16x64_bf16 v[36:39], v[12:15], a[136:143], v100
  v_cvt_pk_bf16_f32 v29, v30, v31
  v_smfmac_f32_16x16x64_bf16 v[36:39], v[16:19], a[144:151], v100
  v_smfmac_f32_16x16x64_bf16 v[36:39], v[20:23], a[152:159], v100
  v_smfmac_f32_16x16x64_bf16 v[36:39], v[24:27], a[160:167], v100
  s_nop 0
  v_cvt_pk_bf16_f32 v30, v32, v33
  v_smfmac_f32_16x16x64_bf16 v[40:43], v[8:11], a[184:191], v100
  v_cvt_pk_bf16_f32 v31, v34, v35
  v_smfmac_f32_16x16x64_bf16 v[40:43], v[12:15], a[192:199], v100
  v_smfmac_f32_16x16x64_bf16 v[40:43], v[16:19], a[200:207], v100
  v_mfma_f32_16x16x32_bf16 v[32:35], v[28:31], v[106:109], 0
  v_smfmac_f32_16x16x64_bf16 v[40:43], v[20:23], a[208:215], v100
  v_smfmac_f32_16x16x64_bf16 v[40:43], v[24:27], a[216:223], v100
  v_smfmac_f32_16x16x64_bf16 v[44:47], v[8:11], a[240:247], v100
  v_cvt_pk_bf16_f32 v36, v36, v37
  v_smfmac_f32_16x16x64_bf16 v[44:47], v[12:15], a[248:255], v100
  v_cvt_pk_bf16_f32 v37, v38, v39
  v_smfmac_f32_16x16x64_bf16 v[44:47], v[16:19], v[120:127], v100
  v_smfmac_f32_16x16x64_bf16 v[44:47], v[20:23], v[128:135], v100
  v_cvt_pk_bf16_f32 v28, v32, v33
  v_smfmac_f32_16x16x64_bf16 v[44:47], v[24:27], v[136:143], v100
  v_cvt_pk_bf16_f32 v29, v34, v35
  v_smfmac_f32_16x16x64_bf16 v[48:51], v[8:11], v[160:167], v100
  v_cvt_pk_bf16_f32 v38, v40, v41
  v_smfmac_f32_16x16x64_bf16 v[48:51], v[12:15], v[168:175], v100
  v_cvt_pk_bf16_f32 v39, v42, v43
  v_smfmac_f32_16x16x64_bf16 v[48:51], v[16:19], v[176:183], v100
  v_mov_b32_dpp v30, v28 row_ror:8 row_mask:0xf bank_mask:0xf
  v_smfmac_f32_16x16x64_bf16 v[48:51], v[20:23], v[184:191], v100
  v_mov_b32_dpp v31, v29 row_ror:8 row_mask:0xf bank_mask:0xf
  v_mfma_f32_16x16x32_bf16 v[40:43], v[36:39], v[106:109], 0
  v_smfmac_f32_16x16x64_bf16 v[48:51], v[24:27], v[192:199], v100
  v_smfmac_f32_16x16x64_bf16 v[52:55], v[8:11], v[216:223], v100
  v_cvt_pk_bf16_f32 v44, v44, v45
  v_smfmac_f32_16x16x64_bf16 v[52:55], v[12:15], v[224:231], v100
  v_cvt_pk_bf16_f32 v45, v46, v47
  v_smfmac_f32_16x16x64_bf16 v[52:55], v[16:19], v[232:239], v100
  v_smfmac_f32_16x16x64_bf16 v[52:55], v[20:23], v[240:247], v100
  s_nop 1
  v_cvt_pk_bf16_f32 v46, v48, v49
  v_smfmac_f32_16x16x64_bf16 v[52:55], v[24:27], v[248:255], v100
  v_cvt_pk_bf16_f32 v47, v50, v51
  s_waitcnt lgkmcnt(0)
  v_mfma_f32_16x16x32_bf16 v[16:19], v[56:59], v[28:31], 0
  v_mfma_f32_16x16x32_bf16 v[48:51], v[44:47], v[106:109], 0
  v_cvt_pk_bf16_f32 v36, v40, v41
  v_cvt_pk_bf16_f32 v37, v42, v43
  v_mfma_f32_16x16x32_bf16 v[20:23], v[68:71], v[28:31], 0
  v_mov_b32_dpp v38, v36 row_ror:8 row_mask:0xf bank_mask:0xf
  v_mov_b32_dpp v39, v37 row_ror:8 row_mask:0xf bank_mask:0xf
  v_mfma_f32_16x16x32_bf16 v[24:27], v[84:87], v[28:31], 0
  v_cvt_pk_bf16_f32 v52, v52, v53
  v_cvt_pk_bf16_f32 v53, v54, v55
  v_mfma_f32_16x16x32_bf16 v[16:19], v[60:63], v[36:39], v[16:19]
  s_nop 0
  v_mfma_f32_16x16x16_bf16 v[0:3], v[52:53], v[106:107], 0
  v_cvt_pk_bf16_f32 v44, v48, v49
  v_cvt_pk_bf16_f32 v45, v50, v51
  v_mfma_f32_16x16x32_bf16 v[20:23], v[72:75], v[36:39], v[20:23]
  v_mov_b32_dpp v46, v44 row_ror:8 row_mask:0xf bank_mask:0xf
  v_mov_b32_dpp v47, v45 row_ror:8 row_mask:0xf bank_mask:0xf
  v_mfma_f32_16x16x32_bf16 v[24:27], v[88:91], v[36:39], v[24:27]
  s_nop 0
  v_mfma_f32_16x16x32_bf16 v[16:19], v[64:67], v[44:47], v[16:19]
  v_mfma_f32_16x16x32_bf16 v[20:23], v[76:79], v[44:47], v[20:23]
  v_cvt_pk_bf16_f32 v114, v0, v1
  v_cvt_pk_bf16_f32 v115, v2, v3
  v_mfma_f32_16x16x32_bf16 v[24:27], v[92:95], v[44:47], v[24:27]
  s_nop 0
  v_mfma_f32_16x16x32_bf16 v[24:27], v[96:99], v[114:117], v[24:27]
  v_mfma_f32_16x16x32_bf16 v[16:19], v[80:83], v[114:117], v[16:19]
  v_mfma_f32_16x16x32_bf16 v[20:23], v[82:85], v[114:117], v[20:23]
  s_nop 5
  ds_write_b64 v112, v[24:25]
  s_nop 0
  v_mov_b32_dpp v16, v20 row_ror:8 row_mask:0xf bank_mask:0xc
  v_mov_b32_dpp v17, v21 row_ror:8 row_mask:0xf bank_mask:0xc
  v_mov_b32_dpp v18, v22 row_ror:8 row_mask:0xf bank_mask:0xc
  v_mov_b32_dpp v19, v23 row_ror:8 row_mask:0xf bank_mask:0xc
  ds_write_b128 v113, v[16:19]
  s_waitcnt lgkmcnt(0)
  s_barrier
  ds_read2_b64 v[28:31], v110 offset0:0 offset1:208
  ds_read2_b64 v[32:35], v98 offset0:0 offset1:208
  s_waitcnt lgkmcnt(1)
  v_pk_add_f32 v[28:29], v[28:29], v[30:31]
  s_waitcnt lgkmcnt(0)
  v_pk_add_f32 v[32:33], v[32:33], v[34:35]
  v_pk_add_f32 v[28:29], v[28:29], v[32:33]
  v_max_f32 v36, v28, v29
  v_max_f32 v37, v28, v29
  s_nop 1
  v_permlane16_swap_b32 v36, v37
  v_max_f32 v36, v36, v37
  s_nop 1
  v_max_f32_dpp v36, v36, v36 row_ror:8 row_mask:0xf bank_mask:0xf
  s_nop 1
  v_max_f32_dpp v36, v36, v36 row_ror:4 row_mask:0xf bank_mask:0xf
  s_nop 1
  v_max_f32_dpp v36, v36, v36 row_ror:2 row_mask:0xf bank_mask:0xf
  s_nop 1
  v_max_f32_dpp v36, v36, v36 row_ror:1 row_mask:0xf bank_mask:0xf
  v_pk_add_f32 v[28:29], v[28:29], v[36:37] op_sel_hi:[1,0] neg_lo:[0,1] neg_hi:[0,1]
  v_exp_f32 v28, v28
  v_exp_f32 v29, v29
  s_nop 0
  v_add_f32 v36, v28, v29
  v_add_f32 v37, v28, v29
  s_nop 1
  v_permlane16_swap_b32 v36, v37
  v_add_f32 v36, v36, v37
  s_nop 1
  v_add_f32_dpp v36, v36, v36 row_ror:8 row_mask:0xf bank_mask:0xf
  s_nop 1
  v_add_f32_dpp v36, v36, v36 row_ror:4 row_mask:0xf bank_mask:0xf
  s_nop 1
  v_add_f32_dpp v36, v36, v36 row_ror:2 row_mask:0xf bank_mask:0xf
  s_nop 1
  v_add_f32_dpp v36, v36, v36 row_ror:1 row_mask:0xf bank_mask:0xf
  v_rcp_f32 v36, v36
  s_nop 0
  v_pk_mul_f32 v[28:29], v[28:29], v[36:37] op_sel_hi:[1,0]
  v_cvt_pk_bf16_f32 v32, v28, v29
  v_min_u32 v32, -2, v32
  buffer_store_dword v32, v111, s[4:7], s17 offen
  s_add_u32 s16, s16, 8192
  s_add_u32 s17, s17, 10240
  s_add_u32 s20, s20, 1
  s_add_u32 s26, s26, 8192
  v_mov_b32 v28, 0
  v_mov_b32 v29, 0
  v_mov_b32 v30, 0
  v_mov_b32 v31, 0
  v_mov_b32 v32, 0
  v_mov_b32 v33, 0
  v_mov_b32 v34, 0
  v_mov_b32 v35, 0
  v_mov_b32 v36, 0
  v_mov_b32 v37, 0
  v_mov_b32 v38, 0
  v_mov_b32 v39, 0
  v_mov_b32 v40, 0
  v_mov_b32 v41, 0
  v_mov_b32 v42, 0
  v_mov_b32 v43, 0
  v_mov_b32 v44, 0
  v_mov_b32 v45, 0
  v_mov_b32 v46, 0
  v_mov_b32 v47, 0
  v_mov_b32 v48, 0
  v_mov_b32 v49, 0
  v_mov_b32 v50, 0
  v_mov_b32 v51, 0
  v_mov_b32 v52, 0
  v_mov_b32 v53, 0
  v_mov_b32 v54, 0
  v_mov_b32 v55, 0
  s_sleep 5
  s_add_u32 s30, s18, 4096
  buffer_load_dwordx4 v[56:59], v103, s[4:7], s18 offen offset:0 sc1
  buffer_load_dwordx4 v[60:63], v103, s[4:7], s18 offen offset:1024 sc1
  buffer_load_dwordx4 v[64:67], v103, s[4:7], s18 offen offset:2048 sc1
  buffer_load_dwordx4 v[68:71], v103, s[4:7], s18 offen offset:3072 sc1
  buffer_load_dwordx4 v[72:75], v103, s[4:7], s30 offen offset:0 sc1
  buffer_load_dwordx4 v[76:79], v103, s[4:7], s30 offen offset:1024 sc1
  buffer_load_dwordx4 v[80:83], v103, s[4:7], s30 offen offset:2048 sc1
  s_add_u32 s18, s18, 28672
  s_cmp_lt_u32 s20, 63
  s_cbranch_scc1 L_xloop_127
  s_cmp_eq_u32 s46, 1
  s_cbranch_scc1 L_xback_101
  s_branch L_fin_20
L_xokA_128:
  ds_write_b128 v101, v[0:3]
  ds_write_b128 v99, v[4:7]
  v_smfmac_f32_16x16x64_bf16 v[36:39], v[0:3], a[112:119], v100
  v_smfmac_f32_16x16x64_bf16 v[40:43], v[0:3], a[168:175], v100
  v_smfmac_f32_16x16x64_bf16 v[44:47], v[0:3], a[224:231], v100
  v_smfmac_f32_16x16x64_bf16 v[48:51], v[0:3], v[144:151], v100
  s_waitcnt lgkmcnt(0)
  s_barrier
  ds_read_b128 v[8:11], v101 offset:1024
  v_smfmac_f32_16x16x64_bf16 v[52:55], v[0:3], v[200:207], v100
  ds_read_b128 v[12:15], v101 offset:2048
  v_smfmac_f32_16x16x64_bf16 v[28:31], v[4:7], a[8:15], v100
  ds_read_b128 v[16:19], v101 offset:3072
  v_smfmac_f32_16x16x64_bf16 v[32:35], v[4:7], a[64:71], v100
  ds_read_b128 v[20:23], v118
  v_smfmac_f32_16x16x64_bf16 v[36:39], v[4:7], a[120:127], v100
  ds_read_b128 v[24:27], v119
  v_smfmac_f32_16x16x64_bf16 v[40:43], v[4:7], a[176:183], v100
  v_smfmac_f32_16x16x64_bf16 v[44:47], v[4:7], a[232:239], v100
  v_smfmac_f32_16x16x64_bf16 v[48:51], v[4:7], v[152:159], v100
  v_smfmac_f32_16x16x64_bf16 v[52:55], v[4:7], v[208:215], v100
  s_branch L_xjoin_129
L_ry_24:
  s_sub_u32 s9, s11, 16
  v_mbcnt_lo_u32_b32 v175, -1, 0
  v_mbcnt_hi_u32_b32 v175, -1, v175
  v_and_b32 v171, 15, v175
  v_lshrrev_b32 v172, 4, v175
  v_lshlrev_b32 v163, 4, v175
  s_lshl_b32 s30, s8, 10
  v_add_u32 v161, s30, v163
  v_add_u32 v170, 4096, v161
  s_add_u32 s30, s8, 4
  s_sub_u32 s31, s30, 7
  s_cmp_ge_u32 s30, 7
  s_cselect_b32 s30, s31, s30
  s_lshl_b32 s30, s30, 10
  v_add_u32 v162, s30, v163
  s_add_u32 s30, s8, 5
  s_sub_u32 s31, s30, 7
  s_cmp_ge_u32 s30, 7
  s_cselect_b32 s30, s31, s30
  s_lshl_b32 s30, s30, 10
  v_add_u32 v182, s30, v163
  s_add_u32 s30, s8, 6
  s_sub_u32 s31, s30, 7
  s_cmp_ge_u32 s30, 7
  s_cselect_b32 s30, s31, s30
  s_lshl_b32 s30, s30, 10
  v_add_u32 v183, s30, v163
  v_and_b32 v173, 8, v175
  v_mov_b32 v160, 0x44444444
  v_mov_b32 v174, 0xeeeeeeee
  v_cmp_ne_u32 vcc, 0, v173
  s_nop 1
  v_cndmask_b32 v160, v160, v174, vcc
  s_lshl_b32 s30, s8, 15
  s_add_u32 s30, s30, 13312
  v_add_u32 v164, s30, v163
  s_lshl_b32 s30, s8, 11
  v_add_u32 v165, s30, v163
  s_lshl_b32 s30, s8, 9
  s_add_u32 s30, s30, 8192
  v_add_u32 v173, s30, v163
  v_mov_b32 v174, 0x80000000
  v_cmp_gt_u32 vcc, 32, v175
  s_nop 1
  v_cndmask_b32 v166, v174, v173, vcc
  v_and_b32 v173, 1, v172
  v_mul_u32_u24 v173, 576, v173
  v_lshrrev_b32 v174, 1, v172
  v_lshl_add_u32 v174, v174, 4, v171
  v_lshl_add_u32 v173, v174, 2, v173
  s_mul_i32 s30, s8, 1152
  s_add_u32 s30, s30, 8192
  v_add_u32 v167, s30, v173
  s_and_b32 s31, s8, 1
  s_lshl_b32 s31, s31, 6
  v_add_u32 v171, s31, v175
  v_lshrrev_b32 v173, 2, v171
  v_and_b32 v173, 7, v173
  v_mul_u32_u24 v173, 144, v173
  v_lshrrev_b32 v174, 5, v171
  v_lshl_add_u32 v173, v174, 5, v173
  v_and_b32 v174, 3, v171
  v_lshl_add_u32 v173, v174, 3, v173
  v_add_u32 v168, 8192, v173
  v_add_u32 v177, 10496, v173
  s_lshl_b32 s30, s9, 9
  v_lshlrev_b32 v173, 2, v171
  s_cmp_lt_u32 s8, 2
  s_cselect_b32 s30, s30, 0x80000000
  v_add_u32 v169, s30, v173
  s_mov_b32 s16, 66060288
  s_mov_b32 s26, 66068480
  s_mov_b32 s17, 67108864
  s_mul_i32 s30, s8, 112
  s_lshl_b32 s31, s9, 1
  s_add_u32 s30, s30, s31
  s_lshl_b32 s30, s30, 10
  s_add_u32 s18, s30, 16777216
  s_mov_b32 s20, 0
  v_lshlrev_b32 v186, 3, v175
  v_and_b32 v178, 15, v175
  v_lshlrev_b32 v178, 3, v178
  s_mov_b32 s16, 0xf0000000
  s_mov_b32 s17, 0xf0000000
  s_mov_b32 s26, 0xf0000000
  s_mov_b32 s18, 0xf0000000
  s_mov_b32 s44, 0xf0000000
  s_mov_b32 s20, 62
  s_mov_b32 s46, 1
  s_branch L_ybody_132
L_yback_133:
  s_waitcnt vmcnt(0) lgkmcnt(0)
  s_barrier
  s_mov_b32 s16, 66060288
  s_mov_b32 s26, 66068480
  s_mov_b32 s17, 67108864
  s_mul_i32 s30, s8, 112
  s_lshl_b32 s31, s9, 1
  s_add_u32 s30, s30, s31
  s_lshl_b32 s30, s30, 10
  s_add_u32 s18, s30, 16777216
  s_mov_b32 s20, 0
  v_lshlrev_b32 v186, 3, v175
  s_mov_b32 s46, 0
  s_waitcnt vmcnt(0)
  v_mov_b32 v188, s12
  v_mov_b32 v189, s13
  v_mov_b32 v190, 0
  s_mov_b64 exec, 1
  buffer_store_dwordx2 v[188:189], v190, s[4:7], s77 offen offset:0 sc1
  s_mov_b64 exec, -1
  v_lshrrev_b32 v0, 3, v175
  v_mul_u32_u24 v0, 448, v0
  v_and_b32 v1, 7, v175
  v_lshl_add_u32 v0, v1, 3, v0
  s_mul_i32 s29, s8, 1792
  s_lshr_b32 s30, s9, 1
  s_lshl_b32 s30, s30, 6
  s_add_u32 s29, s29, s30
  s_add_u32 s29, s29, 68426752
  s_mov_b32 exec_lo, 0xffffffff
  s_mov_b32 exec_hi, 0x0
  s_mov_b32 s28, 0
  s_branch L_wf0_135
L_wf_134:
  s_sleep 1
L_wf0_135:
  buffer_load_dwordx2 v[188:189], v0, s[4:7], s29 offen offset:0 sc1
  s_add_u32 s28, s28, 1
  s_cmp_gt_u32 s28, 2000000
  s_cbranch_scc1 L_fail
  s_waitcnt vmcnt(0)
  v_xor_b32 v188, s12, v188
  v_xor_b32 v189, s13, v189
  v_or_b32 v188, v188, v189
  v_cmp_ne_u32 vcc, 0, v188
  s_cbranch_vccnz L_wf_134
  s_mov_b64 exec, -1
  s_add_u32 s45, s29, 14336
  v_mov_b32 v184, v0
  s_lshl_b32 s30, s8, 7
  s_add_u32 s44, s30, 68190208
  s_lshl_b32 s30, s8, 2
  s_add_u32 s30, s30, 16
  s_mul_i32 s30, s30, 28
  s_lshl_b32 s31, s9, 1
  s_add_u32 s30, s30, s31
  s_mul_i32 s30, s30, 14336
  s_add_u32 s25, s30, 0
  s_mov_b32 s27, 0
L_grp_136:
  s_add_u32 s30, s8, 2
  s_sub_u32 s31, s30, 7
  s_cmp_ge_u32 s30, 7
  s_cselect_b32 s30, s31, s30
  s_lshl_b32 s30, s30, 1
  s_lshl_b32 s29, s30, 10
  s_sub_u32 s31, s30, 7
  s_cmp_ge_u32 s30, 7
  s_cselect_b32 s30, s31, s30
  s_lshr_b32 s30, s30, 2
  s_cmp_eq_u32 s30, s27
  s_cbranch_scc0 L_gs_138
  s_add_u32 s29, s29, s25
  buffer_load_dwordx4 v[0:3], v163, s[4:7], s29 offen sc1
  s_add_u32 s29, s29, 14336
  buffer_load_dwordx4 v[8:11], v163, s[4:7], s29 offen sc1
  s_add_u32 s29, s29, 387072
  buffer_load_dwordx4 v[16:19], v163, s[4:7], s29 offen sc1
  s_add_u32 s29, s29, 14336
  buffer_load_dwordx4 v[24:27], v163, s[4:7], s29 offen sc1
  s_add_u32 s29, s29, 387072
  buffer_load_dwordx4 v[32:35], v163, s[4:7], s29 offen sc1
  s_add_u32 s29, s29, 14336
  buffer_load_dwordx4 v[40:43], v163, s[4:7], s29 offen sc1
  s_add_u32 s29, s29, 387072
  buffer_load_dwordx4 v[48:51], v163, s[4:7], s29 offen sc1
  s_add_u32 s29, s29, 14336
  buffer_load_dwordx4 v[56:59], v163, s[4:7], s29 offen sc1
L_gs_138:
  s_add_u32 s30, s8, 2
  s_sub_u32 s31, s30, 7
  s_cmp_ge_u32 s30, 7
  s_cselect_b32 s30, s31, s30
  s_lshl_b32 s30, s30, 1
  s_add_u32 s30, s30, 1
  s_lshl_b32 s29, s30, 10
  s_sub_u32 s31, s30, 7
  s_cmp_ge_u32 s30, 7
  s_cselect_b32 s30, s31, s30
  s_lshr_b32 s30, s30, 2
  s_cmp_eq_u32 s30, s27
  s_cbranch_scc0 L_gs_139
  s_add_u32 s29, s29, s25
  buffer_load_dwordx4 v[4:7], v163, s[4:7], s29 offen sc1
  s_add_u32 s29, s29, 14336
  buffer_load_dwordx4 v[12:15], v163, s[4:7], s29 offen sc1
  s_add_u32 s29, s29, 387072
  buffer_load_dwordx4 v[20:23], v163, s[4:7], s29 offen sc1
  s_add_u32 s29, s29, 14336
  buffer_load_dwordx4 v[28:31], v163, s[4:7], s29 offen sc1
  s_add_u32 s29, s29, 387072
  buffer_load_dwordx4 v[36:39], v163, s[4:7], s29 offen sc1
  s_add_u32 s29, s29, 14336
  buffer_load_dwordx4 v[44:47], v163, s[4:7], s29 offen sc1
  s_add_u32 s29, s29, 387072
  buffer_load_dwordx4 v[52:55], v163, s[4:7], s29 offen sc1
  s_add_u32 s29, s29, 14336
  buffer_load_dwordx4 v[60:63], v163, s[4:7], s29 offen sc1
L_gs_139:
  s_add_u32 s30, s8, 5
  s_sub_u32 s31, s30, 7
  s_cmp_ge_u32 s30, 7
  s_cselect_b32 s30, s31, s30
  s_lshl_b32 s30, s30, 1
  s_lshl_b32 s29, s30, 10
  s_sub_u32 s31, s30, 7
  s_cmp_ge_u32 s30, 7
  s_cselect_b32 s30, s31, s30
  s_lshr_b32 s30, s30, 2
  s_cmp_eq_u32 s30, s27
  s_cbranch_scc0 L_gs_140
  s_add_u32 s29, s29, s25
  buffer_load_dwordx4 v[64:67], v163, s[4:7], s29 offen sc1
  s_add_u32 s29, s29, 14336
  buffer_load_dwordx4 v[72:75], v163, s[4:7], s29 offen sc1
  s_add_u32 s29, s29, 387072
  buffer_load_dwordx4 v[80:83], v163, s[4:7], s29 offen sc1
  s_add_u32 s29, s29, 14336
  buffer_load_dwordx4 v[88:91], v163, s[4:7], s29 offen sc1
  s_add_u32 s29, s29, 387072
  buffer_load_dwordx4 v[96:99], v163, s[4:7], s29 offen sc1
  s_add_u32 s29, s29, 14336
  buffer_load_dwordx4 v[104:107], v163, s[4:7], s29 offen sc1
  s_add_u32 s29, s29, 387072
  buffer_load_dwordx4 v[112:115], v163, s[4:7], s29 offen sc1
  s_add_u32 s29, s29, 14336
  buffer_load_dwordx4 v[120:123], v163, s[4:7], s29 offen sc1
L_gs_140:
  s_add_u32 s30, s8, 5
  s_sub_u32 s31, s30, 7
  s_cmp_ge_u32 s30, 7
  s_cselect_b32 s30, s31, s30
  s_lshl_b32 s30, s30, 1
  s_add_u32 s30, s30, 1
  s_lshl_b32 s29, s30, 10
  s_sub_u32 s31, s30, 7
  s_cmp_ge_u32 s30, 7
  s_cselect_b32 s30, s31, s30
  s_lshr_b32 s30, s30, 2
  s_cmp_eq_u32 s30, s27
  s_cbranch_scc0 L_gs_141
  s_add_u32 s29, s29, s25
  buffer_load_dwordx4 v[68:71], v163, s[4:7], s29 offen sc1
  s_add_u32 s29, s29, 14336
  buffer_load_dwordx4 v[76:79], v163, s[4:7], s29 offen sc1
  s_add_u32 s29, s29, 387072
  buffer_load_dwordx4 v[84:87], v163, s[4:7], s29 offen sc1
  s_add_u32 s29, s29, 14336
  buffer_load_dwordx4 v[92:95], v163, s[4:7], s29 offen sc1
  s_add_u32 s29, s29, 387072
  buffer_load_dwordx4 v[100:103], v163, s[4:7], s29 offen sc1
  s_add_u32 s29, s29, 14336
  buffer_load_dwordx4 v[108:111], v163, s[4:7], s29 offen sc1
  s_add_u32 s29, s29, 387072
  buffer_load_dwordx4 v[116:119], v163, s[4:7], s29 offen sc1
  s_add_u32 s29, s29, 14336
  buffer_load_dwordx4 v[124:127], v163, s[4:7], s29 offen sc1
L_gs_141:
  s_add_u32 s30, s8, 0
  s_sub_u32 s31, s30, 7
  s_cmp_ge_u32 s30, 7
  s_cselect_b32 s30, s31, s30
  s_lshl_b32 s30, s30, 1
  s_lshl_b32 s29, s30, 10
  s_sub_u32 s31, s30, 7
  s_cmp_ge_u32 s30, 7
  s_cselect_b32 s30, s31, s30
  s_lshr_b32 s30, s30, 2
  s_cmp_eq_u32 s30, s27
  s_cbranch_scc0 L_gs_142
  s_add_u32 s29, s29, s25
  buffer_load_dwordx4 a[0:3], v163, s[4:7], s29 offen sc1
  s_add_u32 s29, s29, 14336
  buffer_load_dwordx4 a[40:43], v163, s[4:7], s29 offen sc1
  s_add_u32 s29, s29, 387072
  buffer_load_dwordx4 a[80:83], v163, s[4:7], s29 offen sc1
  s_add_u32 s29, s29, 14336
  buffer_load_dwordx4 a[120:123], v163, s[4:7], s29 offen sc1
  s_add_u32 s29, s29, 387072
  buffer_load_dwordx4 a[160:163], v163, s[4:7], s29 offen sc1
  s_add_u32 s29, s29, 14336
  buffer_load_dwordx4 a[200:203], v163, s[4:7], s29 offen sc1
  s_add_u32 s29, s29, 387072
  buffer_load_dwordx4 a[240:243], v163, s[4:7], s29 offen sc1
  s_add_u32 s29, s29, 14336
  buffer_load_dwordx4 v[216:219], v163, s[4:7], s29 offen sc1
L_gs_142:
  s_add_u32 s30, s8, 0
  s_sub_u32 s31, s30, 7
  s_cmp_ge_u32 s30, 7
  s_cselect_b32 s30, s31, s30
  s_lshl_b32 s30, s30, 1
  s_add_u32 s30, s30, 1
  s_lshl_b32 s29, s30, 10
  s_sub_u32 s31, s30, 7
  s_cmp_ge_u32 s30, 7
  s_cselect_b32 s30, s31, s30
  s_lshr_b32 s30, s30, 2
  s_cmp_eq_u32 s30, s27
  s_cbranch_scc0 L_gs_143
  s_add_u32 s29, s29, s25
  buffer_load_dwordx4 a[4:7], v163, s[4:7], s29 offen sc1
  s_add_u32 s29, s29, 14336
  buffer_load_dwordx4 a[44:47], v163, s[4:7], s29 offen sc1
  s_add_u32 s29, s29, 387072
  buffer_load_dwordx4 a[84:87], v163, s[4:7], s29 offen sc1
  s_add_u32 s29, s29, 14336
  buffer_load_dwordx4 a[124:127], v163, s[4:7], s29 offen sc1
  s_add_u32 s29, s29, 387072
  buffer_load_dwordx4 a[164:167], v163, s[4:7], s29 offen sc1
  s_add_u32 s29, s29, 14336
  buffer_load_dwordx4 a[204:207], v163, s[4:7], s29 offen sc1
  s_add_u32 s29, s29, 387072
  buffer_load_dwordx4 a[244:247], v163, s[4:7], s29 offen sc1
  s_add_u32 s29, s29, 14336
  buffer_load_dwordx4 v[220:223], v163, s[4:7], s29 offen sc1
L_gs_143:
  s_add_u32 s30, s8, 4
  s_sub_u32 s31, s30, 7
  s_cmp_ge_u32 s30, 7
  s_cselect_b32 s30, s31, s30
  s_lshl_b32 s30, s30, 1
  s_lshl_b32 s29, s30, 10
  s_sub_u32 s31, s30, 7
  s_cmp_ge_u32 s30, 7
  s_cselect_b32 s30, s31, s30
  s_lshr_b32 s30, s30, 2
  s_cmp_eq_u32 s30, s27
  s_cbranch_scc0 L_gs_144
  s_add_u32 s29, s29, s25
  buffer_load_dwordx4 a[8:11], v163, s[4:7], s29 offen sc1
  s_add_u32 s29, s29, 14336
  buffer_load_dwordx4 a[48:51], v163, s[4:7], s29 offen sc1
  s_add_u32 s29, s29, 387072
  buffer_load_dwordx4 a[88:91], v163, s[4:7], s29 offen sc1
  s_add_u32 s29, s29, 14336
  buffer_load_dwordx4 a[128:131], v163, s[4:7], s29 offen sc1
  s_add_u32 s29, s29, 387072
  buffer_load_dwordx4 a[168:171], v163, s[4:7], s29 offen sc1
  s_add_u32 s29, s29, 14336
  buffer_load_dwordx4 a[208:211], v163, s[4:7], s29 offen sc1
  s_add_u32 s29, s29, 387072
  buffer_load_dwordx4 a[248:251], v163, s[4:7], s29 offen sc1
  s_add_u32 s29, s29, 14336
  buffer_load_dwordx4 v[224:227], v163, s[4:7], s29 offen sc1
L_gs_144:
  buffer_load_dwordx2 v[188:189], v184, s[4:7], s45 offen sc1
  s_add_u32 s30, s8, 4
  s_sub_u32 s31, s30, 7
  s_cmp_ge_u32 s30, 7
  s_cselect_b32 s30, s31, s30
  s_lshl_b32 s30, s30, 1
  s_add_u32 s30, s30, 1
  s_lshl_b32 s29, s30, 10
  s_sub_u32 s31, s30, 7
  s_cmp_ge_u32 s30, 7
  s_cselect_b32 s30, s31, s30
  s_lshr_b32 s30, s30, 2
  s_cmp_eq_u32 s30, s27
  s_cbranch_scc0 L_gs_145
  s_add_u32 s29, s29, s25
  buffer_load_dwordx4 a[12:15], v163, s[4:7], s29 offen sc1
  s_add_u32 s29, s29, 14336
  buffer_load_dwordx4 a[52:55], v163, s[4:7], s29 offen sc1
  s_add_u32 s29, s29, 387072
  buffer_load_dwordx4 a[92:95], v163, s[4:7], s29 offen sc1
  s_add_u32 s29, s29, 14336
  buffer_load_dwordx4 a[132:135], v163, s[4:7], s29 offen sc1
  s_add_u32 s29, s29, 387072
  buffer_load_dwordx4 a[172:175], v163, s[4:7], s29 offen sc1
  s_add_u32 s29, s29, 14336
  buffer_load_dwordx4 a[212:215], v163, s[4:7], s29 offen sc1
  s_add_u32 s29, s29, 387072
  buffer_load_dwordx4 a[252:255], v163, s[4:7], s29 offen sc1
  s_add_u32 s29, s29, 14336
  buffer_load_dwordx4 v[228:231], v163, s[4:7], s29 offen sc1
L_gs_145:
  s_add_u32 s30, s8, 1
  s_sub_u32 s31, s30, 7
  s_cmp_ge_u32 s30, 7
  s_cselect_b32 s30, s31, s30
  s_lshl_b32 s30, s30, 1
  s_lshl_b32 s29, s30, 10
  s_sub_u32 s31, s30, 7
  s_cmp_ge_u32 s30, 7
  s_cselect_b32 s30, s31, s30
  s_lshr_b32 s30, s30, 2
  s_cmp_eq_u32 s30, s27
  s_cbranch_scc0 L_gs_146
  s_add_u32 s29, s29, s25
  buffer_load_dwordx4 a[16:19], v163, s[4:7], s29 offen sc1
  s_add_u32 s29, s29, 14336
  buffer_load_dwordx4 a[56:59], v163, s[4:7], s29 offen sc1
  s_add_u32 s29, s29, 387072
  buffer_load_dwordx4 a[96:99], v163, s[4:7], s29 offen sc1
  s_add_u32 s29, s29, 14336
  buffer_load_dwordx4 a[136:139], v163, s[4:7], s29 offen sc1
  s_add_u32 s29, s29, 387072
  buffer_load_dwordx4 a[176:179], v163, s[4:7], s29 offen sc1
  s_add_u32 s29, s29, 14336
  buffer_load_dwordx4 a[216:219], v163, s[4:7], s29 offen sc1
  s_add_u32 s29, s29, 387072
  buffer_load_dwordx4 v[192:195], v163, s[4:7], s29 offen sc1
  s_add_u32 s29, s29, 14336
  buffer_load_dwordx4 v[232:235], v163, s[4:7], s29 offen sc1
L_gs_146:
  s_add_u32 s30, s8, 1
  s_sub_u32 s31, s30, 7
  s_cmp_ge_u32 s30, 7
  s_cselect_b32 s30, s31, s30
  s_lshl_b32 s30, s30, 1
  s_add_u32 s30, s30, 1
  s_lshl_b32 s29, s30, 10
  s_sub_u32 s31, s30, 7
  s_cmp_ge_u32 s30, 7
  s_cselect_b32 s30, s31, s30
  s_lshr_b32 s30, s30, 2
  s_cmp_eq_u32 s30, s27
  s_cbranch_scc0 L_gs_147
  s_add_u32 s29, s29, s25
  buffer_load_dwordx4 a[20:23], v163, s[4:7], s29 offen sc1
  s_add_u32 s29, s29, 14336
  buffer_load_dwordx4 a[60:63], v163, s[4:7], s29 offen sc1
  s_add_u32 s29, s29, 387072
  buffer_load_dwordx4 a[100:103], v163, s[4:7], s29 offen sc1
  s_add_u32 s29, s29, 14336
  buffer_load_dwordx4 a[140:143], v163, s[4:7], s29 offen sc1
  s_add_u32 s29, s29, 387072
  buffer_load_dwordx4 a[180:183], v163, s[4:7], s29 offen sc1
  s_add_u32 s29, s29, 14336
  buffer_load_dwordx4 a[220:223], v163, s[4:7], s29 offen sc1
  s_add_u32 s29, s29, 387072
  buffer_load_dwordx4 v[196:199], v163, s[4:7], s29 offen sc1
  s_add_u32 s29, s29, 14336
  buffer_load_dwordx4 v[236:239], v163, s[4:7], s29 offen sc1
L_gs_147:
  s_add_u32 s30, s8, 3
  s_sub_u32 s31, s30, 7
  s_cmp_ge_u32 s30, 7
  s_cselect_b32 s30, s31, s30
  s_lshl_b32 s30, s30, 1
  s_lshl_b32 s29, s30, 10
  s_sub_u32 s31, s30, 7
  s_cmp_ge_u32 s30, 7
  s_cselect_b32 s30, s31, s30
  s_lshr_b32 s30, s30, 2
  s_cmp_eq_u32 s30, s27
  s_cbranch_scc0 L_gs_148
  s_add_u32 s29, s29, s25
  buffer_load_dwordx4 a[24:27], v163, s[4:7], s29 offen sc1
  s_add_u32 s29, s29, 14336
  buffer_load_dwordx4 a[64:67], v163, s[4:7], s29 offen sc1
  s_add_u32 s29, s29, 387072
  buffer_load_dwordx4 a[104:107], v163, s[4:7], s29 offen sc1
  s_add_u32 s29, s29, 14336
  buffer_load_dwordx4 a[144:147], v163, s[4:7], s29 offen sc1
  s_add_u32 s29, s29, 387072
  buffer_load_dwordx4 a[184:187], v163, s[4:7], s29 offen sc1
  s_add_u32 s29, s29, 14336
  buffer_load_dwordx4 a[224:227], v163, s[4:7], s29 offen sc1
  s_add_u32 s29, s29, 387072
  buffer_load_dwordx4 v[200:203], v163, s[4:7], s29 offen sc1
  s_add_u32 s29, s29, 14336
  buffer_load_dwordx4 v[240:243], v163, s[4:7], s29 offen sc1
L_gs_148:
  s_add_u32 s30, s8, 3
  s_sub_u32 s31, s30, 7
  s_cmp_ge_u32 s30, 7
  s_cselect_b32 s30, s31, s30
  s_lshl_b32 s30, s30, 1
  s_add_u32 s30, s30, 1
  s_lshl_b32 s29, s30, 10
  s_sub_u32 s31, s30, 7
  s_cmp_ge_u32 s30, 7
  s_cselect_b32 s30, s31, s30
  s_lshr_b32 s30, s30, 2
  s_cmp_eq_u32 s30, s27
  s_cbranch_scc0 L_gs_149
  s_add_u32 s29, s29, s25
  buffer_load_dwordx4 a[28:31], v163, s[4:7], s29 offen sc1
  s_add_u32 s29, s29, 14336
  buffer_load_dwordx4 a[68:71], v163, s[4:7], s29 offen sc1
  s_add_u32 s29, s29, 387072
  buffer_load_dwordx4 a[108:111], v163, s[4:7], s29 offen sc1
  s_add_u32 s29, s29, 14336
  buffer_load_dwordx4 a[148:151], v163, s[4:7], s29 offen sc1
  s_add_u32 s29, s29, 387072
  buffer_load_dwordx4 a[188:191], v163, s[4:7], s29 offen sc1
  s_add_u32 s29, s29, 14336
  buffer_load_dwordx4 a[228:231], v163, s[4:7], s29 offen sc1
  s_add_u32 s29, s29, 387072
  buffer_load_dwordx4 v[204:207], v163, s[4:7], s29 offen sc1
  s_add_u32 s29, s29, 14336
  buffer_load_dwordx4 v[244:247], v163, s[4:7], s29 offen sc1
L_gs_149:
  s_add_u32 s30, s8, 6
  s_sub_u32 s31, s30, 7
  s_cmp_ge_u32 s30, 7
  s_cselect_b32 s30, s31, s30
  s_lshl_b32 s30, s30, 1
  s_lshl_b32 s29, s30, 10
  s_sub_u32 s31, s30, 7
  s_cmp_ge_u32 s30, 7
  s_cselect_b32 s30, s31, s30
  s_lshr_b32 s30, s30, 2
  s_cmp_eq_u32 s30, s27
  s_cbranch_scc0 L_gs_150
  s_add_u32 s29, s29, s25
  buffer_load_dwordx4 a[32:35], v163, s[4:7], s29 offen sc1
  s_add_u32 s29, s29, 14336
  buffer_load_dwordx4 a[72:75], v163, s[4:7], s29 offen sc1
  s_add_u32 s29, s29, 387072
  buffer_load_dwordx4 a[112:115], v163, s[4:7], s29 offen sc1
  s_add_u32 s29, s29, 14336
  buffer_load_dwordx4 a[152:155], v163, s[4:7], s29 offen sc1
  s_add_u32 s29, s29, 387072
  buffer_load_dwordx4 a[192:195], v163, s[4:7], s29 offen sc1
  s_add_u32 s29, s29, 14336
  buffer_load_dwordx4 a[232:235], v163, s[4:7], s29 offen sc1
  s_add_u32 s29, s29, 387072
  buffer_load_dwordx4 v[208:211], v163, s[4:7], s29 offen sc1
  s_add_u32 s29, s29, 14336
  buffer_load_dwordx4 v[248:251], v163, s[4:7], s29 offen sc1
L_gs_150:
  s_add_u32 s30, s8, 6
  s_sub_u32 s31, s30, 7
  s_cmp_ge_u32 s30, 7
  s_cselect_b32 s30, s31, s30
  s_lshl_b32 s30, s30, 1
  s_add_u32 s30, s30, 1
  s_lshl_b32 s29, s30, 10
  s_sub_u32 s31, s30, 7
  s_cmp_ge_u32 s30, 7
  s_cselect_b32 s30, s31, s30
  s_lshr_b32 s30, s30, 2
  s_cmp_eq_u32 s30, s27
  s_cbranch_scc0 L_gs_151
  s_add_u32 s29, s29, s25
  buffer_load_dwordx4 a[36:39], v163, s[4:7], s29 offen sc1
  s_add_u32 s29, s29, 14336
  buffer_load_dwordx4 a[76:79], v163, s[4:7], s29 offen sc1
  s_add_u32 s29, s29, 387072
  buffer_load_dwordx4 a[116:119], v163, s[4:7], s29 offen sc1
  s_add_u32 s29, s29, 14336
  buffer_load_dwordx4 a[156:159], v163, s[4:7], s29 offen sc1
  s_add_u32 s29, s29, 387072
  buffer_load_dwordx4 a[196:199], v163, s[4:7], s29 offen sc1
  s_add_u32 s29, s29, 14336
  buffer_load_dwordx4 a[236:239], v163, s[4:7], s29 offen sc1
  s_add_u32 s29, s29, 387072
  buffer_load_dwordx4 v[212:215], v163, s[4:7], s29 offen sc1
  s_add_u32 s29, s29, 14336
  buffer_load_dwordx4 v[252:255], v163, s[4:7], s29 offen sc1
L_gs_151:
  s_cmp_eq_u32 s27, 1
  s_cbranch_scc1 L_grpd_137
  s_waitcnt vmcnt(24)
  s_mov_b32 exec_lo, 0xffffffff
  s_mov_b32 exec_hi, 0x0
  v_xor_b32 v188, s12, v188
  v_xor_b32 v189, s13, v189
  v_or_b32 v188, v188, v189
  v_cmp_ne_u32 vcc, 0, v188
  s_mov_b64 exec, -1
  s_cbranch_vccz L_fok_152
  s_mov_b32 exec_lo, 0xffffffff
  s_mov_b32 exec_hi, 0x0
  s_mov_b32 s28, 0
  s_branch L_wf0_154
L_wf_153:
  s_sleep 1
L_wf0_154:
  buffer_load_dwordx2 v[188:189], v184, s[4:7], s45 offen offset:0 sc1
  s_add_u32 s28, s28, 1
  s_cmp_gt_u32 s28, 2000000
  s_cbranch_scc1 L_fail
  s_waitcnt vmcnt(0)
  v_xor_b32 v188, s12, v188
  v_xor_b32 v189, s13, v189
  v_or_b32 v188, v188, v189
  v_cmp_ne_u32 vcc, 0, v188
  s_cbranch_vccnz L_wf_153
  s_mov_b64 exec, -1
L_fok_152:
  s_mov_b32 s27, 1
  s_branch L_grp_136
L_grpd_137:
  s_mov_b32 s28, 0
  s_mov_b32 s29, 68354048
  s_branch L_wl0_156
L_wl_155:
  s_sleep 1
L_wl0_156:
  buffer_load_dwordx4 v[188:191], v163, s[4:7], s29 offen offset:0 sc1
  s_add_u32 s28, s28, 1
  s_cmp_gt_u32 s28, 2000000
  s_cbranch_scc1 L_fail
  s_waitcnt vmcnt(0)
  v_xor_b32 v188, s12, v188
  v_xor_b32 v189, s13, v189
  v_xor_b32 v190, s12, v190
  v_xor_b32 v191, s13, v191
  v_or_b32 v188, v188, v189
  v_or3_b32 v188, v188, v190, v191
  v_cmp_ne_u32 vcc, 0, v188
  s_cbranch_vccnz L_wl_155
  ds_write_b128 v164, v[0:3] offset:0
  ds_write_b128 v164, v[4:7] offset:1024
  ds_write_b128 v164, v[8:11] offset:4096
  ds_write_b128 v164, v[12:15] offset:5120
  ds_write_b128 v164, v[16:19] offset:8192
  ds_write_b128 v164, v[20:23] offset:9216
  ds_write_b128 v164, v[24:27] offset:12288
  ds_write_b128 v164, v[28:31] offset:13312
  ds_write_b128 v164, v[32:35] offset:16384
  ds_write_b128 v164, v[36:39] offset:17408
  ds_write_b128 v164, v[40:43] offset:20480
  ds_write_b128 v164, v[44:47] offset:21504
  ds_write_b128 v164, v[48:51] offset:24576
  ds_write_b128 v164, v[52:55] offset:25600
  ds_write_b128 v164, v[56:59] offset:28672
  ds_write_b128 v164, v[60:63] offset:29696
  ds_write_b128 v164, v[64:67] offset:2048
  ds_write_b128 v164, v[68:71] offset:3072
  ds_write_b128 v164, v[72:75] offset:6144
  ds_write_b128 v164, v[76:79] offset:7168
  ds_write_b128 v164, v[80:83] offset:10240
  ds_write_b128 v164, v[84:87] offset:11264
  ds_write_b128 v164, v[88:91] offset:14336
  ds_write_b128 v164, v[92:95] offset:15360
  ds_write_b128 v164, v[96:99] offset:18432
  ds_write_b128 v164, v[100:103] offset:19456
  ds_write_b128 v164, v[104:107] offset:22528
  ds_write_b128 v164, v[108:111] offset:23552
  ds_write_b128 v164, v[112:115] offset:26624
  ds_write_b128 v164, v[116:119] offset:27648
  ds_write_b128 v164, v[120:123] offset:30720
  ds_write_b128 v164, v[124:127] offset:31744
  s_mov_b32 s28, 0
  s_branch L_wf0_158
L_wf_157:
  s_sleep 1
L_wf0_158:
  buffer_load_dwordx2 v[188:189], v178, s[4:7], s44 offen offset:0 sc1
  s_add_u32 s28, s28, 1
  s_cmp_gt_u32 s28, 2000000
  s_cbranch_scc1 L_fail
  s_waitcnt vmcnt(0)
  v_xor_b32 v188, s12, v188
  v_xor_b32 v189, s13, v189
  v_or_b32 v188, v188, v189
  v_cmp_ne_u32 vcc, 0, v188
  s_cbranch_vccnz L_wf_157
  s_waitcnt lgkmcnt(0)
  s_barrier
L_ybody_132:
  v_mov_b32 v116, 0
  v_mov_b32 v117, 0
  v_mov_b32 v118, 0
  v_mov_b32 v119, 0
  ds_read_b128 v[60:63], v164 offset:0
  ds_read_b128 v[64:67], v164 offset:1024
  ds_read_b128 v[68:71], v164 offset:2048
  ds_read_b128 v[72:75], v164 offset:3072
  ds_read_b128 v[144:147], v164 offset:8192
  ds_read_b128 v[148:151], v164 offset:9216
  ds_read_b128 v[152:155], v164 offset:10240
  ds_read_b128 v[156:159], v164 offset:11264
  v_mov_b32 v28, 0
  v_mov_b32 v29, 0
  v_mov_b32 v30, 0
  v_mov_b32 v31, 0
  v_mov_b32 v32, 0
  v_mov_b32 v33, 0
  v_mov_b32 v34, 0
  v_mov_b32 v35, 0
  v_mov_b32 v36, 0
  v_mov_b32 v37, 0
  v_mov_b32 v38, 0
  v_mov_b32 v39, 0
  v_mov_b32 v40, 0
  v_mov_b32 v41, 0
  v_mov_b32 v42, 0
  v_mov_b32 v43, 0
  v_mov_b32 v44, 0
  v_mov_b32 v45, 0
  v_mov_b32 v46, 0
  v_mov_b32 v47, 0
  v_mov_b32 v48, 0
  v_mov_b32 v49, 0
  v_mov_b32 v50, 0
  v_mov_b32 v51, 0
  v_mov_b32 v52, 0
  v_mov_b32 v53, 0
  v_mov_b32 v54, 0
  v_mov_b32 v55, 0
  v_mov_b32 v56, 0
  v_mov_b32 v57, 0
  v_mov_b32 v58, 0
  v_mov_b32 v59, 0
  v_mov_b32 v184, 0
  v_mov_b32 v185, 0
  v_mov_b32 v186, 0
  v_mov_b32 v187, 0
  v_mov_b32 v188, 0
  v_mov_b32 v189, 0
  v_mov_b32 v190, 0
  v_mov_b32 v191, 0
L_yloop_159:
  s_mov_b32 s24, 0
L_poll_161:
  buffer_load_dwordx4 v[0:3], v161, s[4:7], s16 offen offset:0 sc1
  buffer_load_dwordx4 v[4:7], v162, s[4:7], s16 offen offset:0 sc1
  s_add_u32 s24, s24, 1
  s_cmp_gt_u32 s24, 400000
  s_cbranch_scc1 L_fail
  s_waitcnt vmcnt(1)
  ds_write_b128 v161, v[0:3]
  s_waitcnt vmcnt(0)
  ds_write_b128 v170, v[4:7]
  v_max_u32 v171, v0, v4
  v_cmp_eq_u32 vcc, -1, v171
  s_cbranch_vccnz L_poll_161
  v_smfmac_f32_16x16x64_bf16 v[28:31], v[0:3], a[0:7], v160
  v_smfmac_f32_16x16x64_bf16 v[36:39], v[0:3], a[80:87], v160
  buffer_load_dwordx4 v[76:79], v163, s[4:7], s18 offen offset:0 sc1
  v_smfmac_f32_16x16x64_bf16 v[44:47], v[0:3], a[160:167], v160
  v_smfmac_f32_16x16x64_bf16 v[52:55], v[0:3], a[240:247], v160
  buffer_load_dwordx4 v[84:87], v163, s[4:7], s18 offen offset:1024 sc1
  v_smfmac_f32_16x16x64_bf16 v[32:35], v[0:3], a[40:47], v160
  v_smfmac_f32_16x16x64_bf16 v[40:43], v[0:3], a[120:127], v160
  s_waitcnt lgkmcnt(0)
  s_barrier
  ds_read_b128 v[8:11], v161 offset:1024
  v_smfmac_f32_16x16x64_bf16 v[48:51], v[0:3], a[200:207], v160
  ds_read_b128 v[12:15], v161 offset:2048
  v_smfmac_f32_16x16x64_bf16 v[56:59], v[0:3], v[216:223], v160
  ds_read_b128 v[16:19], v161 offset:3072
  v_smfmac_f32_16x16x64_bf16 v[28:31], v[4:7], a[8:15], v160
  ds_read_b128 v[20:23], v182
  v_smfmac_f32_16x16x64_bf16 v[36:39], v[4:7], a[88:95], v160
  ds_read_b128 v[24:27], v183
  v_smfmac_f32_16x16x64_bf16 v[44:47], v[4:7], a[168:175], v160
  s_add_u32 s30, s18, 28672
  buffer_load_dwordx4 v[80:83], v163, s[4:7], s30 offen offset:0 sc1
  v_smfmac_f32_16x16x64_bf16 v[52:55], v[4:7], a[248:255], v160
  v_smfmac_f32_16x16x64_bf16 v[32:35], v[4:7], a[48:55], v160
  buffer_load_dwordx4 v[88:91], v163, s[4:7], s30 offen offset:1024 sc1
  v_smfmac_f32_16x16x64_bf16 v[40:43], v[4:7], a[128:135], v160
  v_smfmac_f32_16x16x64_bf16 v[48:51], v[4:7], a[208:215], v160
  s_add_u32 s30, s18, 57344
  buffer_load_dwordx4 v[92:95], v163, s[4:7], s30 offen offset:0 sc1
  v_smfmac_f32_16x16x64_bf16 v[56:59], v[4:7], v[224:231], v160
  s_waitcnt lgkmcnt(4)
  v_smfmac_f32_16x16x64_bf16 v[28:31], v[8:11], a[16:23], v160
  buffer_load_dwordx4 v[100:103], v163, s[4:7], s30 offen offset:1024 sc1
  s_waitcnt lgkmcnt(3)
  v_smfmac_f32_16x16x64_bf16 v[28:31], v[12:15], v[60:67], v160
  ds_read_b128 v[60:63], v164 offset:16384
  ds_read_b128 v[64:67], v164 offset:17408
  s_waitcnt lgkmcnt(4)
  v_smfmac_f32_16x16x64_bf16 v[28:31], v[16:19], a[24:31], v160
  s_add_u32 s30, s18, 86016
  buffer_load_dwordx4 v[96:99], v163, s[4:7], s30 offen offset:0 sc1
  s_waitcnt lgkmcnt(3)
  v_smfmac_f32_16x16x64_bf16 v[28:31], v[20:23], v[68:75], v160
  ds_read_b128 v[68:71], v164 offset:18432
  ds_read_b128 v[72:75], v164 offset:19456
  s_waitcnt lgkmcnt(4)
  v_smfmac_f32_16x16x64_bf16 v[28:31], v[24:27], a[32:39], v160
  buffer_load_dwordx4 v[104:107], v163, s[4:7], s30 offen offset:1024 sc1
  v_smfmac_f32_16x16x64_bf16 v[36:39], v[8:11], a[96:103], v160
  v_smfmac_f32_16x16x64_bf16 v[36:39], v[12:15], v[144:151], v160
  ds_read_b128 v[144:147], v164 offset:24576
  ds_read_b128 v[148:151], v164 offset:25600
  v_smfmac_f32_16x16x64_bf16 v[36:39], v[16:19], a[104:111], v160
  buffer_load_dwordx2 v[180:181], v178, s[4:7], s44 offen offset:512 sc1
  v_smfmac_f32_16x16x64_bf16 v[36:39], v[20:23], v[152:159], v160
  ds_read_b128 v[152:155], v164 offset:26624
  ds_read_b128 v[156:159], v164 offset:27648
  v_smfmac_f32_16x16x64_bf16 v[36:39], v[24:27], a[112:119], v160
  v_smfmac_f32_16x16x64_bf16 v[44:47], v[8:11], a[176:183], v160
  s_waitcnt lgkmcnt(6)
  v_smfmac_f32_16x16x64_bf16 v[44:47], v[12:15], v[60:67], v160
  ds_read_b128 v[60:63], v164 offset:4096
  ds_read_b128 v[64:67], v164 offset:5120
  v_smfmac_f32_16x16x64_bf16 v[44:47], v[16:19], a[184:191], v160
  s_waitcnt lgkmcnt(6)
  v_smfmac_f32_16x16x64_bf16 v[44:47], v[20:23], v[68:75], v160
  ds_read_b128 v[68:71], v164 offset:6144
  ds_read_b128 v[72:75], v164 offset:7168
  v_smfmac_f32_16x16x64_bf16 v[44:47], v[24:27], a[192:199], v160
  v_permlane32_swap_b32 v28, v36
  v_smfmac_f32_16x16x64_bf16 v[52:55], v[8:11], v[192:199], v160
  v_permlane32_swap_b32 v29, v37
  s_waitcnt lgkmcnt(6)
  v_smfmac_f32_16x16x64_bf16 v[52:55], v[12:15], v[144:151], v160
  ds_read_b128 v[144:147], v164 offset:12288
  ds_read_b128 v[148:151], v164 offset:13312
  v_smfmac_f32_16x16x64_bf16 v[52:55], v[16:19], v[200:207], v160
  v_permlane32_swap_b32 v30, v38
  s_waitcnt lgkmcnt(6)
  v_smfmac_f32_16x16x64_bf16 v[52:55], v[20:23], v[152:159], v160
  ds_read_b128 v[152:155], v164 offset:14336
  ds_read_b128 v[156:159], v164 offset:15360
  v_smfmac_f32_16x16x64_bf16 v[52:55], v[24:27], v[208:215], v160
  v_permlane32_swap_b32 v31, v39
  v_smfmac_f32_16x16x64_bf16 v[32:35], v[8:11], a[56:63], v160
  v_pk_add_f32 v[28:29], v[28:29], v[36:37]
  s_waitcnt lgkmcnt(6)
  v_smfmac_f32_16x16x64_bf16 v[32:35], v[12:15], v[60:67], v160
  ds_read_b128 v[60:63], v164 offset:20480
  ds_read_b128 v[64:67], v164 offset:21504
  v_smfmac_f32_16x16x64_bf16 v[32:35], v[16:19], a[64:71], v160
  v_pk_add_f32 v[30:31], v[30:31], v[38:39]
  s_waitcnt lgkmcnt(6)
  v_smfmac_f32_16x16x64_bf16 v[32:35], v[20:23], v[68:75], v160
  ds_read_b128 v[68:71], v164 offset:22528
  ds_read_b128 v[72:75], v164 offset:23552
  v_smfmac_f32_16x16x64_bf16 v[32:35], v[24:27], a[72:79], v160
  v_cvt_pk_bf16_f32 v108, v28, v29
  v_smfmac_f32_16x16x64_bf16 v[40:43], v[8:11], a[136:143], v160
  v_cvt_pk_bf16_f32 v110, v30, v31
  s_waitcnt lgkmcnt(6)
  v_smfmac_f32_16x16x64_bf16 v[40:43], v[12:15], v[144:151], v160
  ds_read_b128 v[144:147], v164 offset:28672
  ds_read_b128 v[148:151], v164 offset:29696
  v_smfmac_f32_16x16x64_bf16 v[40:43], v[16:19], a[144:151], v160
  v_permlane32_swap_b32 v44, v52
  s_waitcnt lgkmcnt(6)
  v_smfmac_f32_16x16x64_bf16 v[40:43], v[20:23], v[152:159], v160
  ds_read_b128 v[152:155], v164 offset:30720
  ds_read_b128 v[156:159], v164 offset:31744
  v_smfmac_f32_16x16x64_bf16 v[40:43], v[24:27], a[152:159], v160
  v_permlane32_swap_b32 v45, v53
  v_smfmac_f32_16x16x64_bf16 v[48:51], v[8:11], a[216:223], v160
  v_permlane32_swap_b32 v46, v54
  s_waitcnt lgkmcnt(6)
  v_smfmac_f32_16x16x64_bf16 v[48:51], v[12:15], v[60:67], v160
  v_smfmac_f32_16x16x64_bf16 v[48:51], v[16:19], a[224:231], v160
  v_permlane32_swap_b32 v47, v55
  s_waitcnt lgkmcnt(4)
  v_smfmac_f32_16x16x64_bf16 v[48:51], v[20:23], v[68:75], v160
  v_smfmac_f32_16x16x64_bf16 v[48:51], v[24:27], a[232:239], v160
  v_pk_add_f32 v[44:45], v[44:45], v[52:53]
  v_smfmac_f32_16x16x64_bf16 v[56:59], v[8:11], v[232:239], v160
  v_pk_add_f32 v[46:47], v[46:47], v[54:55]
  s_waitcnt lgkmcnt(2)
  v_smfmac_f32_16x16x64_bf16 v[56:59], v[12:15], v[144:151], v160
  v_smfmac_f32_16x16x64_bf16 v[56:59], v[16:19], v[240:247], v160
  v_cvt_pk_bf16_f32 v109, v44, v45
  s_waitcnt lgkmcnt(0)
  v_smfmac_f32_16x16x64_bf16 v[56:59], v[20:23], v[152:159], v160
  v_smfmac_f32_16x16x64_bf16 v[56:59], v[24:27], v[248:255], v160
  v_cvt_pk_bf16_f32 v111, v46, v47
  v_permlane32_swap_b32 v32, v40
  v_permlane32_swap_b32 v33, v41
  v_permlane32_swap_b32 v34, v42
  v_permlane32_swap_b32 v35, v43
  v_pk_add_f32 v[32:33], v[32:33], v[40:41]
  v_pk_add_f32 v[34:35], v[34:35], v[42:43]
  v_cvt_pk_bf16_f32 v112, v32, v33
  v_cvt_pk_bf16_f32 v114, v34, v35
  v_permlane32_swap_b32 v48, v56
  v_permlane32_swap_b32 v49, v57
  v_permlane32_swap_b32 v50, v58
  v_permlane32_swap_b32 v51, v59
  v_pk_add_f32 v[48:49], v[48:49], v[56:57]
  v_pk_add_f32 v[50:51], v[50:51], v[58:59]
  v_cvt_pk_bf16_f32 v113, v48, v49
  v_cvt_pk_bf16_f32 v115, v50, v51
  ds_read_b128 v[60:63], v164 offset:0
  ds_read_b128 v[64:67], v164 offset:1024
  ds_read_b128 v[68:71], v164 offset:2048
  ds_read_b128 v[72:75], v164 offset:3072
  ds_read_b128 v[144:147], v164 offset:8192
  ds_read_b128 v[148:151], v164 offset:9216
  ds_read_b128 v[152:155], v164 offset:10240
  ds_read_b128 v[156:159], v164 offset:11264
  v_mov_b32 v28, 0
  v_mov_b32 v29, 0
  v_mov_b32 v30, 0
  v_mov_b32 v31, 0
  v_mov_b32 v32, 0
  v_mov_b32 v33, 0
  v_mov_b32 v34, 0
  v_mov_b32 v35, 0
  v_mov_b32 v36, 0
  v_mov_b32 v37, 0
  v_mov_b32 v38, 0
  v_mov_b32 v39, 0
  v_mov_b32 v40, 0
  v_mov_b32 v41, 0
  v_mov_b32 v42, 0
  v_mov_b32 v43, 0
  v_mov_b32 v44, 0
  v_mov_b32 v45, 0
  v_mov_b32 v46, 0
  v_mov_b32 v47, 0
  v_mov_b32 v48, 0
  v_mov_b32 v49, 0
  v_mov_b32 v50, 0
  v_mov_b32 v51, 0
  v_mov_b32 v52, 0
  v_mov_b32 v53, 0
  v_mov_b32 v54, 0
  v_mov_b32 v55, 0
  v_mov_b32 v56, 0
  v_mov_b32 v57, 0
  v_mov_b32 v58, 0
  v_mov_b32 v59, 0
  v_mov_b32 v184, 0
  v_mov_b32 v185, 0
  v_mov_b32 v186, 0
  v_mov_b32 v187, 0
  v_mov_b32 v188, 0
  v_mov_b32 v189, 0
  v_mov_b32 v190, 0
  v_mov_b32 v191, 0
  s_sleep 1
  s_mov_b32 s24, 0
  buffer_load_dwordx4 v[120:123], v165, s[4:7], s17 offen offset:0 sc1
  buffer_load_dwordx4 v[124:127], v165, s[4:7], s17 offen offset:1024 sc1
  buffer_load_dwordx4 v[128:131], v166, s[4:7], s17 offen offset:0 sc1
  s_nop 12
  s_nop 12
  buffer_load_dwordx4 v[132:135], v165, s[4:7], s17 offen offset:0 sc1
  buffer_load_dwordx4 v[136:139], v165, s[4:7], s17 offen offset:1024 sc1
  buffer_load_dwordx4 v[140:143], v166, s[4:7], s17 offen offset:0 sc1
  s_branch L_poll0_165
L_poll_164:
  buffer_load_dwordx4 v[132:135], v165, s[4:7], s17 offen offset:0 sc1
  buffer_load_dwordx4 v[136:139], v165, s[4:7], s17 offen offset:1024 sc1
  buffer_load_dwordx4 v[140:143], v166, s[4:7], s17 offen offset:0 sc1
  s_nop 2
  v_mov_b32 v184, 0
  v_mov_b32 v185, 0
  v_mov_b32 v186, 0
  v_mov_b32 v187, 0
  v_mov_b32 v188, 0
  v_mov_b32 v189, 0
  v_mov_b32 v190, 0
  v_mov_b32 v191, 0
L_poll0_165:
  s_add_u32 s24, s24, 1
  s_waitcnt vmcnt(3)
  v_max3_u32 v171, v120, v124, v128
  v_cmp_eq_u32 vcc, -1, v171
  v_smfmac_f32_16x16x64_bf16 v[184:187], v[120:123], v[76:83], v160
  v_smfmac_f32_16x16x64_bf16 v[188:191], v[120:123], v[84:91], v160
  s_cbranch_vccz L_ypA_162
  buffer_load_dwordx4 v[120:123], v165, s[4:7], s17 offen offset:0 sc1
  buffer_load_dwordx4 v[124:127], v165, s[4:7], s17 offen offset:1024 sc1
  buffer_load_dwordx4 v[128:131], v166, s[4:7], s17 offen offset:0 sc1
  s_nop 2
  v_mov_b32 v184, 0
  v_mov_b32 v185, 0
  v_mov_b32 v186, 0
  v_mov_b32 v187, 0
  v_mov_b32 v188, 0
  v_mov_b32 v189, 0
  v_mov_b32 v190, 0
  v_mov_b32 v191, 0
  s_cmp_gt_u32 s24, 400000
  s_cbranch_scc1 L_fail
  s_waitcnt vmcnt(3)
  v_max3_u32 v171, v132, v136, v140
  v_cmp_eq_u32 vcc, -1, v171
  v_smfmac_f32_16x16x64_bf16 v[184:187], v[132:135], v[76:83], v160
  v_smfmac_f32_16x16x64_bf16 v[188:191], v[132:135], v[84:91], v160
  s_cbranch_vccnz L_poll_164
  v_smfmac_f32_16x16x64_bf16 v[184:187], v[136:139], v[92:99], v160
  v_smfmac_f32_16x16x64_bf16 v[188:191], v[136:139], v[100:107], v160
  v_smfmac_f32_16x16x64_bf16 v[184:187], v[140:143], v[108:115], v160
  v_smfmac_f32_16x16x64_bf16 v[188:191], v[140:143], v[112:119], v160
  s_nop 7
  v_permlane32_swap_b32 v184, v188
  v_permlane32_swap_b32 v185, v189
  v_pk_add_f32 v[184:185], v[184:185], v[188:189]
  ds_write2_b32 v167, v184, v185 offset0:0 offset1:36
  v_permlane32_swap_b32 v186, v190
  v_permlane32_swap_b32 v187, v191
  v_pk_add_f32 v[186:187], v[186:187], v[190:191]
  ds_write2_b32 v167, v186, v187 offset0:72 offset1:108
L_ypJ_163:
  s_cmp_lt_u32 s8, 2
  s_cbranch_scc0 L_yskip_167
  s_waitcnt lgkmcnt(0)
  s_barrier
  ds_read2_b64 v[8:11], v168 offset0:0 offset1:144
  ds_read2_b64 v[12:15], v177 offset0:0 offset1:144
  s_waitcnt lgkmcnt(1)
  v_pk_add_f32 v[8:9], v[8:9], v[10:11]
  s_waitcnt lgkmcnt(0)
  v_pk_add_f32 v[12:13], v[12:13], v[14:15]
  v_pk_add_f32 v[8:9], v[8:9], v[12:13]
  v_cvt_pk_bf16_f32 v176, v8, v9
  v_min_u32 v176, -2, v176
  buffer_store_dword v176, v169, s[4:7], s26 offen
L_yskip_166:
  s_add_u32 s20, s20, 1
  s_cmp_eq_u32 s20, 63
  s_cbranch_scc1 L_ydone_160
  s_add_u32 s16, s16, 8192
  s_add_u32 s26, s26, 8192
  s_add_u32 s17, s17, 10240
  s_add_u32 s18, s18, 458752
  s_add_u32 s44, s44, 512
  v_xor_b32 v180, s12, v180
  v_xor_b32 v181, s13, v181
  v_or_b32 v180, v180, v181
  v_cmp_ne_u32 vcc, 0, v180
  s_cbranch_vccz L_yvxok_168
  s_cmp_ge_u32 s20, 63
  s_cbranch_scc1 L_yvxok_168
  s_mov_b32 s28, 0
  s_branch L_wf0_170
L_wf_169:
  s_sleep 1
L_wf0_170:
  buffer_load_dwordx2 v[180:181], v178, s[4:7], s44 offen offset:0 sc1
  s_add_u32 s28, s28, 1
  s_cmp_gt_u32 s28, 2000000
  s_cbranch_scc1 L_fail
  s_waitcnt vmcnt(0)
  v_xor_b32 v180, s12, v180
  v_xor_b32 v181, s13, v181
  v_or_b32 v180, v180, v181
  v_cmp_ne_u32 vcc, 0, v180
  s_cbranch_vccnz L_wf_169
L_yvxok_168:
  s_sleep 5
  s_branch L_yloop_159
L_ydone_160:
  s_cmp_eq_u32 s46, 1
  s_cbranch_scc1 L_yback_133
  s_mov_b32 s30, 67100672
  buffer_store_dword v176, v169, s[4:7], s30 offen sc1
  s_branch L_fin_20
L_ypA_162:
  v_smfmac_f32_16x16x64_bf16 v[184:187], v[124:127], v[92:99], v160
  v_smfmac_f32_16x16x64_bf16 v[188:191], v[124:127], v[100:107], v160
  v_smfmac_f32_16x16x64_bf16 v[184:187], v[128:131], v[108:115], v160
  v_smfmac_f32_16x16x64_bf16 v[188:191], v[128:131], v[112:119], v160
  s_nop 7
  v_permlane32_swap_b32 v184, v188
  v_permlane32_swap_b32 v185, v189
  v_pk_add_f32 v[184:185], v[184:185], v[188:189]
  ds_write2_b32 v167, v184, v185 offset0:0 offset1:36
  v_permlane32_swap_b32 v186, v190
  v_permlane32_swap_b32 v187, v191
  v_pk_add_f32 v[186:187], v[186:187], v[190:191]
  ds_write2_b32 v167, v186, v187 offset0:72 offset1:108
  s_branch L_ypJ_163
L_yskip_167:
  s_waitcnt lgkmcnt(0)
  s_barrier
  s_branch L_yskip_166
L_fin_20:
  s_endpgm
L_fail:
  s_waitcnt vmcnt(0) lgkmcnt(0)
  s_load_dwordx2 s[14:15], s[0:1], 96
  v_mov_b32 v0, 8
  v_mov_b32 v1, 1
  s_mov_b64 exec, 1
  s_waitcnt lgkmcnt(0)
  global_atomic_add v0, v1, s[14:15] sc1
L_end:
  s_endpgm
.section .rodata,"a"
.p2align 6
.amdhsa_kernel recurrent_scan__memory_aug_recurrent_mem_tr__glu_gated_glu__prompt_kernel
  .amdhsa_next_free_vgpr 512
  .amdhsa_next_free_sgpr 102
  .amdhsa_accum_offset 256
  .amdhsa_group_segment_fixed_size 0
  .amdhsa_kernarg_size 112
  .amdhsa_user_sgpr_count 2
  .amdhsa_user_sgpr_kernarg_segment_ptr 1
  .amdhsa_system_sgpr_workgroup_id_x 1
  .amdhsa_float_denorm_mode_32 3
.end_amdhsa_kernel
```
